```python
import torch

def _softmax(x, axis=-1):
    return torch.softmax(x, dim=axis)

def _gelu(x):
    return torch.nn.functional.gelu(x, approximate='tanh')

def _silu(x):
    return torch.nn.functional.silu(x)

def _sigmoid(x):
    return torch.sigmoid(x)

def _layernorm(x, axis=-1, eps=1e-05):
    m = x.mean(dim=axis, keepdim=True)
    v = x.var(dim=axis, keepdim=True, unbiased=False)
    return (x - m) / torch.sqrt(v + eps)

def _scatter_add(tgt, idx, src, axis=0):
    return tgt.clone().index_add_(axis, idx, src)

def _segment_sum(src, seg, n):
    out = torch.zeros((n,) + src.shape[1:], dtype=src.dtype)
    return out.index_add_(0, seg, src)

def _pad(x, pw):
    flat = tuple((v for pair in reversed(pw) for v in pair))
    return torch.nn.functional.pad(x, flat)
kernel_name = 'adaLN_cond__sliding_block__dense_activation_squared_relu__prompt'

def setup_inputs():

    _w = lambda a: (lambda t: t.to(torch.bfloat16) if t.is_floating_point() else t)(torch.as_tensor(a))

    def _A_setup():
        B, S, D = (1, 2048, 448)
        return {'x': _w((lambda *s: torch.randn(*s, dtype=torch.bfloat16) * 0.05)(B, S, D)), 'wqkv': _w((lambda *s: torch.randn(*s, dtype=torch.bfloat16) * 0.05)(D, 3 * D)), 'wo': _w((lambda *s: torch.randn(*s, dtype=torch.bfloat16) * 0.05)(D, D))}
    _A_in = _A_setup()

    def _B_setup():
        B, S, D, F = (1, 2048, 448, 1792)
        return {'x': _w((lambda *s: torch.randn(*s, dtype=torch.bfloat16) * 0.05)(B, S, D)), 'w1': _w((lambda *s: torch.randn(*s, dtype=torch.bfloat16) * 0.05)(D, F)), 'b1': _w((lambda *s: torch.randn(*s, dtype=torch.bfloat16) * 0.4)(F)), 'w2': _w((lambda *s: torch.randn(*s, dtype=torch.bfloat16) * 0.05)(F, D)), 'b2': _w((lambda *s: torch.randn(*s, dtype=torch.bfloat16) * 3.2)(D))}
    _B_in = _B_setup()
    return {'A_x': _A_in['x'], 'A_wqkv': _A_in['wqkv'], 'A_wo': _A_in['wo'], 'B_x': _B_in['x'], 'B_w1': _B_in['w1'], 'B_b1': _B_in['b1'], 'B_w2': _B_in['w2'], 'B_b2': _B_in['b2'], 'c': _w((lambda *s: torch.randn(*s, dtype=torch.bfloat16) * 0.1)(1, 448) * 8.0), 'w_mod': _w((lambda *s: torch.randn(*s, dtype=torch.bfloat16) * 0.1)(448, 6 * 448) * 448 ** (-0.5) * 8.0)}

def reference(A_x, A_wqkv, A_wo, B_x, B_w1, B_b1, B_w2, B_b2, c, w_mod):

    def _A_ref(x, wqkv, wo):
        B, S, D = x.shape
        H = 16
        Dh = D // H
        W = 256
        qkv = (lambda x, *d: x.permute(*d))((x @ wqkv).reshape(B, S, 3, H, Dh), 2, 0, 3, 1, 4)
        q, k, v = (qkv[0], qkv[1], qkv[2])
        scores = torch.einsum('bhqd,bhkd->bhqk', q, k) * Dh ** (-0.5)
        idx = torch.arange(S)
        mask = (idx[:, None] - idx[None, :] >= 0) & (idx[:, None] - idx[None, :] < W)
        scores = torch.where(mask[None, None], scores, -1000000000.0)
        p = _softmax(scores, axis=-1)
        o = torch.einsum('bhqk,bhkd->bhqd', p, v)
        return (lambda x, *d: x.permute(*d))(o, 0, 2, 1, 3).reshape(B, S, D) @ wo

    def _B_ref(x, w1, b1, w2, b2):
        h = torch.einsum('bsd,df->bsf', x, w1) + b1
        zero = torch.zeros_like(h)
        r = torch.where(h > zero, h, zero)
        h = r * r
        out = torch.einsum('bsf,fd->bsd', h, w2) + b2
        return out
    x = A_x
    mod = (_silu(c) @ w_mod).reshape(c.shape[0], 6, 1, -1)
    sa, ca, ga, sb, cb, gb = (mod[:, 0].clone(), mod[:, 1].clone(), mod[:, 2].clone(), mod[:, 3].clone(), mod[:, 4].clone(), mod[:, 5].clone())
    h = _layernorm(x, axis=-1) * (1 + ca) + sa
    x = x + ga * _A_ref(h, A_wqkv, A_wo)
    h = _layernorm(x, axis=-1) * (1 + cb) + sb
    x = x + gb * _B_ref(h, B_w1, B_b1, B_w2, B_b2)
    return x
```

```asm
; @launch grid=(256,1,1) block=(256,1,1) lds=163840
.amdgcn_target "amdgcn-amd-amdhsa--gfx950"
.text
.globl adaLN_cond__sliding_block__dense_activation_squared_relu__prompt_kernel
.p2align 8
.type adaLN_cond__sliding_block__dense_activation_squared_relu__prompt_kernel,@function
adaLN_cond__sliding_block__dense_activation_squared_relu__prompt_kernel:
    s_load_dwordx2 s[28:29], s[0:1], 72
    s_load_dwordx2 s[44:45], s[0:1], 64
    s_load_dwordx2 s[8:9], s[0:1], 0
    v_readfirstlane_b32 s3, v0
    s_mov_b32 s30, 2408448
    s_mov_b32 s31, 0x20000
    s_mov_b32 s68, 0
    s_sub_u32 s95, s2, 224
    s_cmp_ge_u32 s95, 32
    s_cbranch_scc1 L_w0
    s_mov_b32 s68, 1
    v_lshrrev_b32 v1, 3, v0
    v_and_b32 v2, 6, v1
    v_xor_b32 v2, v2, v0
    v_and_b32 v2, 7, v2
    v_mul_u32_u24 v1, 5376, v1
    v_lshl_add_u32 v4, v2, 4, v1
    v_min_u32 v2, 223, v0
    v_lshlrev_b32 v3, 2, v2
    s_lshl_b32 s61, s3, 4
    s_add_u32 m0, s61, 57344
    s_lshr_b32 s61, s95, 1
    s_lshl_b32 s61, s61, 7
    s_bitcmp1_b32 s95, 0
    s_cselect_b32 s62, 1204224, 0
    s_add_u32 s61, s61, s62
    s_cmp_ge_u32 s95, 28
    s_cselect_b32 s61, 2.0, s61
    s_mov_b32 s62, 7
    s_waitcnt lgkmcnt(0)
    global_load_dword v8, v3, s[44:45]
L_m0:
    buffer_load_dwordx4 v4, s[28:31], s61 offen lds
    s_addk_i32 m0, 4096
    s_add_u32 s61, s61, 172032
    s_sub_u32 s62, s62, 1
    s_cmp_lg_u32 s62, 0
    s_cbranch_scc1 L_m0
L_w0:
    s_lshr_b32 s5, s2, 3
    v_min_u32 v5, 12, v0
    v_lshl_add_u32 v5, v5, 5, s5
    s_getpc_b64 s[62:63]
L_pc:
    v_min_u32 v5, (CODE_END-L_pc-4)>>7, v5
    v_lshlrev_b32 v5, 7, v5
    global_load_dword v238, v5, s[62:63]
    s_cmp_ge_u32 s2, 256
    s_cbranch_scc1 L_exit
    s_lshr_b32 s3, s3, 6
    v_and_b32 v255, 63, v0
    s_and_b32 s4, s2, 7
    s_mov_b32 s10, 1835008
    s_mov_b32 s11, s31
    s_load_dwordx2 s[36:37], s[0:1], 96
    s_load_dwordx2 s[12:13], s[0:1], 8
    s_load_dwordx2 s[32:33], s[0:1], 80
    s_load_dwordx2 s[24:25], s[0:1], 48
    s_load_dwordx2 s[16:17], s[0:1], 16
    s_load_dwordx2 s[20:21], s[0:1], 32
    s_load_dwordx2 s[40:41], s[0:1], 40
    s_load_dwordx2 s[42:43], s[0:1], 56
    v_lshrrev_b32 v9, 3, v255
    v_xor_b32 v10, v9, v255
    v_and_b32 v10, 7, v10
    v_mul_u32_u24 v9, 896, v9
    v_lshl_add_u32 v9, v10, 4, v9
    s_lshl_b32 s61, s4, 5
    s_add_u32 s57, s61, s5
    s_mul_i32 s61, s57, 7168
    s_lshl_b32 s62, s3, 7
    s_add_u32 s61, s61, s62
    s_lshl_b32 s62, s3, 10
    s_add_u32 m0, s62, 151552
    s_add_u32 s63, s61, 512
    s_cmp_eq_u32 s3, 3
    s_cselect_b32 s63, s61, s63
    s_cselect_b32 s64, 0, 4096
    s_waitcnt lgkmcnt(0)
    s_load_dword s6, s[36:37], 0
    buffer_load_dwordx4 v9, s[8:11], s61 offen lds
    s_add_u32 m0, m0, s64
    s_nop 0
    buffer_load_dwordx4 v9, s[8:11], s63 offen lds
    s_mov_b32 s14, 1204224
    s_mov_b32 s15, s31
    s_mov_b32 s38, 16777216
    s_mov_b32 s39, s31
    s_mov_b32 s34, 1835008
    s_mov_b32 s35, s31
    s_mov_b32 s18, 401408
    s_mov_b32 s19, s31
    s_mov_b32 s22, 1605632
    s_mov_b32 s23, s31
    s_mov_b32 s26, 1605632
    s_mov_b32 s27, s31
    v_lshrrev_b32 v239, 3, v255
    v_and_b32 v240, 7, v255
    v_bfe_u32 v241, v255, 4, 1
    v_lshlrev_b32 v241, 2, v241
    v_xor_b32 v240, v240, v241
    v_mul_u32_u24 v239, 2688, v239
    v_lshl_add_u32 v12, v240, 4, v239
    v_add_u32 v13, 20480, v12
    v_add_u32 v14, 40960, v12
    v_add_u32 v15, 61440, v12
    s_cmp_ge_u32 s5, 14
    s_cselect_b32 s65, 14, 0
    s_cselect_b32 s96, 1, 0
    s_sub_u32 s48, s5, s65
    s_sub_u32 s65, s5, 14
    s_cmp_ge_u32 s65, 14
    s_cbranch_scc1 L_rl
    s_mov_b32 s68, 2
L_rl:
    s_lshr_b32 s65, s57, 2
    s_mul_i32 s98, s65, 28672
    s_and_b32 s65, s5, 3
    s_lshl_b32 s65, s65, 7
    s_add_u32 s98, s98, s65
    s_lshl_b32 s62, s3, 12
    s_add_u32 s98, s98, s62
    s_add_u32 s99, s98, 16384
    s_cmp_eq_u32 s3, 3
    s_cselect_b32 s99, 1073741824, s99
    s_cselect_b32 s61, 0, 16384
    v_bfe_u32 v77, v255, 3, 1
    v_mul_u32_u24 v77, s61, v77
    v_and_b32 v30, 7, v255
    v_lshl_add_u32 v77, v30, 9, v77
    v_accvgpr_write_b32 a233, v9
    v_lshlrev_b32 v254, 4, v255
    v_lshrrev_b32 v244, 5, v255
    v_and_b32 v243, 31, v255
    s_getreg_b32 s46, hwreg(HW_REG_XCC_ID, 0, 4)
    s_mov_b32 s7, 0
    s_lshl_b32 s47, s4, 12
    s_add_u32 s47, s47, 16384
    v_and_b32 v30, 7, v255
    v_lshrrev_b32 v31, 3, v255
    v_xor_b32 v32, v30, v31
    v_lshlrev_b32 v32, 4, v32
    v_lshl_add_u32 v32, v30, 7, v32
    v_add_u32 v32, 151552, v32
    s_lshl_b32 s61, s3, 10
    v_add_u32 v33, s61, v32
    s_mov_b32 s86, 0x07060500
    s_mov_b32 s87, 0x07060501
    s_mov_b32 s88, 0x07060502
    s_mov_b32 s89, 0x07060503
    s_add_u32 s61, s46, 1
    v_cvt_f32_u32 v18, s61
    s_lshl_b32 s61, s57, 7
    s_add_u32 s90, s61, 81920
    s_mov_b32 s66, 0xffff0000
    s_cmp_eq_u32 s68, 1
    s_cbranch_scc1 L_h2
    buffer_load_dword v238, v77, s[32:35], s98 offen sc1
    s_lshl_b32 s61, s4, 1
    s_add_u32 s62, s61, s96
    s_lshl_b32 s49, s62, 2
    s_add_u32 s49, s49, s3
    s_and_b32 s50, s5, 15
    s_lshr_b32 s62, s5, 4
    s_add_u32 s51, s61, s62
    s_lshl_b32 s52, s51, 2
    s_add_u32 s52, s52, s3
    s_mul_i32 s61, s5, 37
    s_lshr_b32 s56, s61, 8
    s_mul_i32 s62, s56, 7
    s_sub_u32 s53, s5, s62
    s_lshl_b32 s59, s53, 7
    s_and_b32 s61, s3, 1
    s_lshr_b32 s55, s3, 1
    s_lshl_b32 s54, s4, 2
    s_and_b32 s56, s56, 1
    s_add_u32 s54, s54, s56
    s_lshl_b32 s54, s54, 1
    s_add_u32 s54, s54, s61
    s_lshl_b32 s78, s3, 12
    v_lshrrev_b32 v239, 3, v255
    v_and_b32 v240, 7, v255
    v_bfe_u32 v241, v255, 4, 1
    v_lshlrev_b32 v241, 2, v241
    v_xor_b32 v240, v240, v241
    v_mul_u32_u24 v239, 896, v239
    v_lshl_add_u32 v246, v240, 4, v239
    v_add_u32 v247, 6144, v246
    v_add_u32 v248, 12288, v246
    v_add_u32 v249, 18432, v246
    v_and_b32 v239, 3, v255
    v_lshlrev_b32 v239, 3, v239
    v_bfe_u32 v240, v255, 4, 1
    v_lshl_add_u32 v239, v240, 5, v239
    v_bfe_u32 v240, v255, 2, 2
    v_lshl_add_u32 v16, v240, 6, v239
    v_lshl_add_u32 v16, v244, 9, v16
    v_lshl_add_u32 v239, v240, 7, v239
    v_bfe_u32 v240, v255, 3, 1
    v_lshl_add_u32 v239, v240, 6, v239
    v_lshl_add_u32 v253, v244, 10, v239
    v_lshl_add_u32 v251, v244, 9, v239
    v_xor_b32 v252, 64, v253
    v_xor_b32 v250, 64, v251
    s_lshl_b32 s62, s55, 6
    v_xor_b32 v233, s62, v251
    v_xor_b32 v234, s62, v250
    v_add_u32 v228, 122880, v16
    v_lshrrev_b32 v229, 2, v255
    v_mul_u32_u24 v229, 2688, v229
    v_and_b32 v17, 3, v255
    v_lshl_add_u32 v229, v17, 4, v229
    v_add_u32 v230, 41984, v229
    v_add_u32 v231, 83968, v229
    v_add_u32 v232, 125952, v229
    s_xor_b32 s65, s96, s4
    s_and_b32 s65, s65, 1
    s_lshl_b32 s66, s3, 1
    s_add_u32 s65, s65, s66
    s_mul_i32 m0, s65, 7168
    s_mul_i32 s67, s65, 150528
    s_lshl_b32 s65, s48, 7
    s_add_u32 s67, s67, s65
    s_add_u32 s67, s67, 896
    buffer_load_dwordx4 v12, s[12:15], s67 offen offset:0 lds
    buffer_load_dwordx4 v13, s[12:15], s67 offen offset:1024 lds
    buffer_load_dwordx4 v14, s[12:15], s67 offen offset:2048 lds
    buffer_load_dwordx4 v15, s[12:15], s67 offen offset:3072 lds
    s_add_u32 m0, m0, 4096
    s_add_u32 s67, s67, 86016
    buffer_load_dwordx4 v12, s[12:15], s67 offen offset:0 lds
    buffer_load_dwordx4 v13, s[12:15], s67 offen offset:1024 lds
    buffer_load_dwordx4 v14, s[12:15], s67 offen offset:2048 lds
    s_waitcnt lgkmcnt(0)
    s_mul_i32 s6, s6, 0x9E3779B1
    s_add_u32 s6, s6, 0x7F4A7C15
    v_mov_b32 v245, s6
    s_branch L_pg
    .p2align 12
L_pg:
    s_waitcnt vmcnt(8)
    s_barrier
    s_cmp_lg_u32 s3, 0
    s_cbranch_scc1 L_nx2
    v_perm_b32 v136, v18, v245, s86
    v_perm_b32 v137, v18, v245, s87
    v_perm_b32 v138, v18, v245, s88
    v_perm_b32 v139, v18, v245, s89
    s_mov_b64 exec, 1
    buffer_store_dwordx4 v[136:139], v254, s[36:39], s90 offen sc1
    s_mov_b64 exec, -1
L_nx2:
    s_lshl_b32 s65, s5, 2
    s_add_u32 s65, s65, s3
    s_mul_i32 s65, s65, 10752
    v_and_b32 v240, 7, v255
    v_min_u32 v240, 6, v240
    v_bfe_u32 v239, v255, 3, 2
    v_mul_u32_u24 v239, 2688, v239
    v_lshl_add_u32 v239, v240, 7, v239
    buffer_load_dword v238, v239, s[12:15], s65 offen
L_w3:
    s_mov_b32 s66, 0xffff0000
    ds_read_b128 v[40:43], v32 offset:0
    ds_read_b128 v[44:47], v32 offset:1024
    ds_read_b128 v[48:51], v32 offset:2048
    ds_read_b128 v[52:55], v32 offset:3072
    ds_read_b128 v[56:59], v32 offset:4096
    ds_read_b128 v[60:63], v32 offset:5120
    ds_read_b128 v[64:67], v32 offset:6144
    ds_read_b128 v[68:71], v33
    ds_read_b128 v[72:75], v33 offset:4096
    s_waitcnt lgkmcnt(8)
    v_lshlrev_b32 v80, 16, v40
    v_and_b32 v81, s66, v40
    v_lshlrev_b32 v82, 16, v41
    v_and_b32 v83, s66, v41
    v_lshlrev_b32 v84, 16, v42
    v_and_b32 v85, s66, v42
    v_lshlrev_b32 v86, 16, v43
    v_and_b32 v87, s66, v43
    s_waitcnt lgkmcnt(7)
    v_lshlrev_b32 v88, 16, v44
    v_and_b32 v89, s66, v44
    v_lshlrev_b32 v90, 16, v45
    v_and_b32 v91, s66, v45
    v_lshlrev_b32 v92, 16, v46
    v_and_b32 v93, s66, v46
    v_lshlrev_b32 v94, 16, v47
    v_and_b32 v95, s66, v47
    s_waitcnt lgkmcnt(6)
    v_lshlrev_b32 v96, 16, v48
    v_and_b32 v97, s66, v48
    v_lshlrev_b32 v98, 16, v49
    v_and_b32 v99, s66, v49
    v_lshlrev_b32 v100, 16, v50
    v_and_b32 v101, s66, v50
    v_lshlrev_b32 v102, 16, v51
    v_and_b32 v103, s66, v51
    s_waitcnt lgkmcnt(5)
    v_lshlrev_b32 v104, 16, v52
    v_and_b32 v105, s66, v52
    v_lshlrev_b32 v106, 16, v53
    v_and_b32 v107, s66, v53
    v_lshlrev_b32 v108, 16, v54
    v_and_b32 v109, s66, v54
    v_lshlrev_b32 v110, 16, v55
    v_and_b32 v111, s66, v55
    s_waitcnt lgkmcnt(4)
    v_lshlrev_b32 v112, 16, v56
    v_and_b32 v113, s66, v56
    v_lshlrev_b32 v114, 16, v57
    v_and_b32 v115, s66, v57
    v_lshlrev_b32 v116, 16, v58
    v_and_b32 v117, s66, v58
    v_lshlrev_b32 v118, 16, v59
    v_and_b32 v119, s66, v59
    s_waitcnt lgkmcnt(3)
    v_lshlrev_b32 v120, 16, v60
    v_and_b32 v121, s66, v60
    v_lshlrev_b32 v122, 16, v61
    v_and_b32 v123, s66, v61
    v_lshlrev_b32 v124, 16, v62
    v_and_b32 v125, s66, v62
    v_lshlrev_b32 v126, 16, v63
    v_and_b32 v127, s66, v63
    s_waitcnt lgkmcnt(2)
    v_lshlrev_b32 v128, 16, v64
    v_and_b32 v129, s66, v64
    v_lshlrev_b32 v130, 16, v65
    v_and_b32 v131, s66, v65
    v_lshlrev_b32 v132, 16, v66
    v_and_b32 v133, s66, v66
    v_lshlrev_b32 v134, 16, v67
    v_and_b32 v135, s66, v67
    .p2align 3
    v_pk_add_f32 v[34:35], v[80:81], v[82:83]
    v_pk_add_f32 v[34:35], v[34:35], v[84:85]
    v_pk_add_f32 v[34:35], v[34:35], v[86:87]
    v_pk_add_f32 v[34:35], v[34:35], v[88:89]
    v_pk_add_f32 v[34:35], v[34:35], v[90:91]
    v_pk_add_f32 v[34:35], v[34:35], v[92:93]
    v_pk_add_f32 v[34:35], v[34:35], v[94:95]
    v_pk_add_f32 v[34:35], v[34:35], v[96:97]
    v_pk_add_f32 v[34:35], v[34:35], v[98:99]
    v_pk_add_f32 v[34:35], v[34:35], v[100:101]
    v_pk_add_f32 v[34:35], v[34:35], v[102:103]
    v_pk_add_f32 v[34:35], v[34:35], v[104:105]
    v_pk_add_f32 v[34:35], v[34:35], v[106:107]
    v_pk_add_f32 v[34:35], v[34:35], v[108:109]
    v_pk_add_f32 v[34:35], v[34:35], v[110:111]
    v_pk_add_f32 v[34:35], v[34:35], v[112:113]
    v_pk_add_f32 v[34:35], v[34:35], v[114:115]
    v_pk_add_f32 v[34:35], v[34:35], v[116:117]
    v_pk_add_f32 v[34:35], v[34:35], v[118:119]
    v_pk_add_f32 v[34:35], v[34:35], v[120:121]
    v_pk_add_f32 v[34:35], v[34:35], v[122:123]
    v_pk_add_f32 v[34:35], v[34:35], v[124:125]
    v_pk_add_f32 v[34:35], v[34:35], v[126:127]
    v_pk_add_f32 v[34:35], v[34:35], v[128:129]
    v_pk_add_f32 v[34:35], v[34:35], v[130:131]
    v_pk_add_f32 v[34:35], v[34:35], v[132:133]
    v_pk_add_f32 v[34:35], v[34:35], v[134:135]
    v_add_f32 v34, v34, v35
    s_nop 1
    v_add_f32_dpp v34, v34, v34 row_ror:8 row_mask:0xf bank_mask:0xf
    v_mov_b32 v239, v34
    s_nop 1
    v_permlane16_swap_b32 v34, v239
    v_add_f32 v34, v34, v239
    v_mov_b32 v239, v34
    s_nop 1
    v_permlane32_swap_b32 v34, v239
    v_add_f32 v34, v34, v239
    v_mul_f32 v34, 0xbb124925, v34
    v_mov_b32 v35, v34
    .p2align 3
    v_pk_add_f32 v[80:81], v[80:81], v[34:35]
    v_pk_add_f32 v[82:83], v[82:83], v[34:35]
    v_pk_add_f32 v[84:85], v[84:85], v[34:35]
    v_pk_add_f32 v[86:87], v[86:87], v[34:35]
    v_pk_add_f32 v[88:89], v[88:89], v[34:35]
    v_pk_add_f32 v[90:91], v[90:91], v[34:35]
    v_pk_add_f32 v[92:93], v[92:93], v[34:35]
    v_pk_add_f32 v[94:95], v[94:95], v[34:35]
    v_pk_add_f32 v[96:97], v[96:97], v[34:35]
    v_pk_add_f32 v[98:99], v[98:99], v[34:35]
    v_pk_add_f32 v[100:101], v[100:101], v[34:35]
    v_pk_add_f32 v[102:103], v[102:103], v[34:35]
    v_pk_add_f32 v[104:105], v[104:105], v[34:35]
    v_pk_add_f32 v[106:107], v[106:107], v[34:35]
    v_pk_add_f32 v[108:109], v[108:109], v[34:35]
    v_pk_add_f32 v[110:111], v[110:111], v[34:35]
    v_pk_add_f32 v[112:113], v[112:113], v[34:35]
    v_pk_add_f32 v[114:115], v[114:115], v[34:35]
    v_pk_add_f32 v[116:117], v[116:117], v[34:35]
    v_pk_add_f32 v[118:119], v[118:119], v[34:35]
    v_pk_add_f32 v[120:121], v[120:121], v[34:35]
    v_pk_add_f32 v[122:123], v[122:123], v[34:35]
    v_pk_add_f32 v[124:125], v[124:125], v[34:35]
    v_pk_add_f32 v[126:127], v[126:127], v[34:35]
    v_pk_add_f32 v[128:129], v[128:129], v[34:35]
    v_pk_add_f32 v[130:131], v[130:131], v[34:35]
    v_pk_add_f32 v[132:133], v[132:133], v[34:35]
    v_pk_add_f32 v[134:135], v[134:135], v[34:35]
    v_pk_mul_f32 v[36:37], v[80:81], v[80:81]
    v_pk_fma_f32 v[36:37], v[82:83], v[82:83], v[36:37]
    v_pk_fma_f32 v[36:37], v[84:85], v[84:85], v[36:37]
    v_pk_fma_f32 v[36:37], v[86:87], v[86:87], v[36:37]
    v_pk_fma_f32 v[36:37], v[88:89], v[88:89], v[36:37]
    v_pk_fma_f32 v[36:37], v[90:91], v[90:91], v[36:37]
    v_pk_fma_f32 v[36:37], v[92:93], v[92:93], v[36:37]
    v_pk_fma_f32 v[36:37], v[94:95], v[94:95], v[36:37]
    v_pk_fma_f32 v[36:37], v[96:97], v[96:97], v[36:37]
    v_pk_fma_f32 v[36:37], v[98:99], v[98:99], v[36:37]
    v_pk_fma_f32 v[36:37], v[100:101], v[100:101], v[36:37]
    v_pk_fma_f32 v[36:37], v[102:103], v[102:103], v[36:37]
    v_pk_fma_f32 v[36:37], v[104:105], v[104:105], v[36:37]
    v_pk_fma_f32 v[36:37], v[106:107], v[106:107], v[36:37]
    v_pk_fma_f32 v[36:37], v[108:109], v[108:109], v[36:37]
    v_pk_fma_f32 v[36:37], v[110:111], v[110:111], v[36:37]
    v_pk_fma_f32 v[36:37], v[112:113], v[112:113], v[36:37]
    v_pk_fma_f32 v[36:37], v[114:115], v[114:115], v[36:37]
    v_pk_fma_f32 v[36:37], v[116:117], v[116:117], v[36:37]
    v_pk_fma_f32 v[36:37], v[118:119], v[118:119], v[36:37]
    v_pk_fma_f32 v[36:37], v[120:121], v[120:121], v[36:37]
    v_pk_fma_f32 v[36:37], v[122:123], v[122:123], v[36:37]
    v_pk_fma_f32 v[36:37], v[124:125], v[124:125], v[36:37]
    v_pk_fma_f32 v[36:37], v[126:127], v[126:127], v[36:37]
    v_pk_fma_f32 v[36:37], v[128:129], v[128:129], v[36:37]
    v_pk_fma_f32 v[36:37], v[130:131], v[130:131], v[36:37]
    v_pk_fma_f32 v[36:37], v[132:133], v[132:133], v[36:37]
    v_pk_fma_f32 v[36:37], v[134:135], v[134:135], v[36:37]
    v_add_f32 v36, v36, v37
    s_nop 1
    v_add_f32_dpp v36, v36, v36 row_ror:8 row_mask:0xf bank_mask:0xf
    v_mov_b32 v239, v36
    s_nop 1
    v_permlane16_swap_b32 v36, v239
    v_add_f32 v36, v36, v239
    v_mov_b32 v239, v36
    s_nop 1
    v_permlane32_swap_b32 v36, v239
    v_add_f32 v36, v36, v239
    v_mov_b32 v37, 0x3727c5ac
    v_fmac_f32 v37, 0x3b124925, v36
    v_rsq_f32 v36, v37
    s_waitcnt lgkmcnt(0)
    v_lshlrev_b32 v40, 16, v68
    v_and_b32 v41, s66, v68
    v_lshlrev_b32 v42, 16, v69
    v_and_b32 v43, s66, v69
    v_lshlrev_b32 v44, 16, v70
    v_and_b32 v45, s66, v70
    v_lshlrev_b32 v46, 16, v71
    v_and_b32 v47, s66, v71
    v_lshlrev_b32 v48, 16, v72
    v_and_b32 v49, s66, v72
    v_lshlrev_b32 v50, 16, v73
    v_and_b32 v51, s66, v73
    v_lshlrev_b32 v52, 16, v74
    v_and_b32 v53, s66, v74
    v_lshlrev_b32 v54, 16, v75
    v_and_b32 v55, s66, v75
    v_mov_b32 v37, v36
    v_pk_add_f32 v[40:41], v[40:41], v[34:35]
    v_pk_add_f32 v[42:43], v[42:43], v[34:35]
    v_pk_add_f32 v[44:45], v[44:45], v[34:35]
    v_pk_add_f32 v[46:47], v[46:47], v[34:35]
    v_pk_add_f32 v[48:49], v[48:49], v[34:35]
    v_pk_add_f32 v[50:51], v[50:51], v[34:35]
    v_pk_add_f32 v[52:53], v[52:53], v[34:35]
    v_pk_add_f32 v[54:55], v[54:55], v[34:35]
    v_pk_mul_f32 v[40:41], v[40:41], v[36:37]
    v_pk_mul_f32 v[42:43], v[42:43], v[36:37]
    v_pk_mul_f32 v[44:45], v[44:45], v[36:37]
    v_pk_mul_f32 v[46:47], v[46:47], v[36:37]
    v_pk_mul_f32 v[48:49], v[48:49], v[36:37]
    v_pk_mul_f32 v[50:51], v[50:51], v[36:37]
    v_pk_mul_f32 v[52:53], v[52:53], v[36:37]
    v_pk_mul_f32 v[54:55], v[54:55], v[36:37]
    v_lshrrev_b32 v62, 2, v0
    v_lshlrev_b32 v62, 7, v62
    v_and_b32 v56, 3, v0
    v_lshl_add_u32 v62, v56, 4, v62
    v_add_u32 v56, 7168, v62
    s_lshl_b32 s61, s4, 12
    s_add_u32 s61, s61, 16384
    v_lshl_add_u32 v57, v243, 7, s61
    v_cmp_gt_u32 vcc, 224, v0
    s_nop 1
    v_cndmask_b32 v62, v57, v62, vcc
    v_cndmask_b32 v56, v57, v56, vcc
    v_lshlrev_b32 v57, 4, v0
    v_add_u32 v57, 159744, v57
    v_cmp_le_u32 vcc, 112, v0
    s_nop 1
    v_cndmask_b32 v63, 0, 1.0, vcc
    s_lshl_b32 s61, s3, 8
    s_add_u32 s61, s61, 159744
    v_lshl_add_u32 v58, v31, 5, s61
    v_lshlrev_b32 v59, 4, v243
    v_add_u32 v59, 163328, v59
    v_lshlrev_b32 v60, 9, v31
    v_lshl_add_u32 v60, v30, 4, v60
    v_fma_f32 v76, v18, 2.0, 1.0
    s_lshl_b32 s46, s5, 2
    s_add_u32 s46, s46, s3
    s_lshl_b32 s46, s46, 2
    s_add_u32 s46, s46, s47
    s_cmp_eq_u32 s68, 1
    s_cbranch_scc1 L_w4
    s_xor_b32 s65, s96, s4
    s_and_b32 s65, s65, 1
    s_xor_b32 s65, s65, 1
    s_lshl_b32 s66, s3, 1
    s_add_u32 s65, s65, s66
    s_mul_i32 m0, s65, 7168
    s_mul_i32 s67, s65, 150528
    s_lshl_b32 s65, s48, 7
    s_add_u32 s67, s67, s65
    s_add_u32 s67, s67, 896
    buffer_load_dwordx4 v12, s[12:15], s67 offen offset:0 lds
    buffer_load_dwordx4 v13, s[12:15], s67 offen offset:1024 lds
    buffer_load_dwordx4 v14, s[12:15], s67 offen offset:2048 lds
    buffer_load_dwordx4 v15, s[12:15], s67 offen offset:3072 lds
    s_add_u32 m0, m0, 4096
    s_add_u32 s67, s67, 86016
    buffer_load_dwordx4 v12, s[12:15], s67 offen offset:0 lds
    buffer_load_dwordx4 v13, s[12:15], s67 offen offset:1024 lds
    buffer_load_dwordx4 v14, s[12:15], s67 offen offset:2048 lds
    s_and_b32 s61, s49, 7
    s_lshl_b32 s61, s61, 6
    s_add_u32 s85, s61, s47
    s_lshl_b32 s62, s48, 2
    s_add_u32 s62, s62, s85
    s_add_u32 s84, s62, 512
    s_mul_i32 s82, s49, 28672
    s_mul_i32 s80, s49, 1792
    s_lshl_b32 s81, s49, 15
    s_add_u32 s81, s81, 1048576
    s_mul_i32 s83, s49, 14
    s_add_u32 s83, s83, s48
    s_lshl_b32 s83, s83, 7
    s_add_u32 s83, s83, 655360
    s_mul_i32 s86, s3, 6144
    s_add_u32 s86, s86, 98304
    s_lshl_b32 s61, s50, 6
    s_lshl_b32 s62, s51, 2
    s_mul_i32 s63, s3, 3
    s_add_u32 s62, s62, s63
    s_sub_u32 s62, s62, 8
    s_add_u32 s63, s62, 0
    s_add_u32 s64, s63, s61
    s_mul_i32 s64, s64, 1792
    s_add_u32 s64, s64, 3145728
    s_cmp_lt_i32 s63, 0
    s_cselect_b32 s87, 1073741824, s64
    s_add_u32 s63, s62, 1
    s_add_u32 s64, s63, s61
    s_mul_i32 s64, s64, 1792
    s_add_u32 s64, s64, 3145728
    s_cmp_lt_i32 s63, 0
    s_cselect_b32 s88, 1073741824, s64
    s_add_u32 s63, s62, 2
    s_add_u32 s64, s63, s61
    s_mul_i32 s64, s64, 1792
    s_add_u32 s64, s64, 3145728
    s_cmp_lt_i32 s63, 0
    s_cselect_b32 s89, 1073741824, s64
    v_lshlrev_b32 v239, 9, v244
    v_lshl_add_u32 v239, v243, 3, v239
    v_accvgpr_write_b32 a224, v239
    s_lshl_b32 s61, s3, 11
    s_add_u32 s61, s61, 98304
    v_add_u32 v239, s61, v239
    v_accvgpr_write_b32 a225, v239
    v_mul_u32_u24 v239, 448, v244
    v_lshl_add_u32 v239, v243, 4, v239
    v_accvgpr_write_b32 a226, v239
    s_lshl_b32 s90, s52, 4
    s_add_u32 s90, s90, s50
    s_and_b32 s61, s90, 127
    s_lshl_b32 s61, s61, 2
    s_add_u32 s61, s61, s47
    s_add_u32 s91, s61, 1024
    s_lshl_b32 s90, s90, 11
    s_add_u32 s90, s90, 1048576
    v_min_u32 v239, 13, v255
    v_and_b32 v240, 1, v239
    v_mul_u32_u24 v240, 27, v240
    s_mul_i32 s61, s50, 28
    v_add_u32 v240, s61, v240
    v_lshrrev_b32 v241, 6, v240
    v_bfe_u32 v242, v239, 1, 1
    v_mad_u32_u24 v241, v242, 7, v241
    v_lshrrev_b32 v242, 2, v239
    v_add_u32 v242, s62, v242
    v_max_i32 v242, 0, v242
    v_mad_u32_u24 v241, v242, 14, v241
    v_lshlrev_b32 v241, 7, v241
    v_add_u32 v241, 655360, v241
    v_lshrrev_b32 v240, 5, v240
    s_and_b32 s61, s52, 7
    s_lshl_b32 s61, s61, 6
    s_add_u32 s61, s61, s47
    s_add_u32 s61, s61, 512
    v_lshl_add_u32 v240, v240, 2, s61
    v_cmp_gt_u32 vcc, 12, v239
    s_nop 1
    v_cndmask_b32 v239, v240, v241, vcc
    v_accvgpr_write_b32 a227, v239
    v_lshrrev_b32 v239, 3, v255
    v_and_b32 v240, 7, v255
    v_bfe_u32 v241, v255, 4, 1
    v_lshlrev_b32 v241, 2, v241
    v_xor_b32 v240, v240, v241
    v_mul_u32_u24 v239, 3584, v239
    v_lshl_add_u32 v120, v240, 4, v239
    v_add_u32 v121, 27648, v120
    v_add_u32 v122, 55296, v120
    v_add_u32 v123, 82944, v120
    v_accvgpr_write_b32 a228, v120
    v_accvgpr_write_b32 a229, v121
    v_accvgpr_write_b32 a230, v122
    v_accvgpr_write_b32 a231, v123
    s_mul_i32 s92, s3, 14336
    s_bfe_u32 s61, s48, 0x10001
    s_lshl_b32 s93, s48, 1
    s_add_u32 s93, s93, s61
    s_lshl_b32 s93, s93, 7
    s_xor_b32 s94, s93, 128
    s_mov_b32 s97, 0
    s_lshl_b32 s61, s53, 1
    s_add_u32 s69, s61, s55
    s_lshl_b32 s61, s69, 7
    s_add_u32 s45, s61, 458752
    v_and_b32 v239, 7, v255
    v_bfe_u32 v240, v255, 3, 2
    v_min_u32 v240, 2, v240
    v_min_u32 v241, 1, v240
    v_add_u32 v240, v240, v241
    v_mul_u32_u24 v240, 1792, v240
    v_lshl_add_u32 v240, v239, 4, v240
    v_accvgpr_write_b32 a232, v240
    v_mov_b32 v121, 0
    v_lshl_add_u32 v122, v243, 3, s86
    s_mov_b32 exec_hi, 0
    s_cmp_eq_u32 s87, 1073741824
    s_cselect_b32 s64, 0xf149, 0
    v_mov_b32 v120, s64
    ds_write_b64 v122, v[120:121] offset:1792
    s_cmp_eq_u32 s88, 1073741824
    s_cselect_b32 s64, 0xf149, 0
    v_mov_b32 v120, s64
    ds_write_b64 v122, v[120:121] offset:3840
    s_cmp_eq_u32 s89, 1073741824
    s_cselect_b32 s64, 0xf149, 0
    v_mov_b32 v120, s64
    ds_write_b64 v122, v[120:121] offset:5888
    s_mov_b64 exec, -1
L_w4:
    s_mov_b64 exec, 0
    s_cmp_eq_u32 s3, 0
    s_cbranch_scc1 L_sb0
    s_cmp_eq_u32 s3, 1
    s_cbranch_scc1 L_sb1
    s_cmp_eq_u32 s3, 2
    s_cbranch_scc1 L_sb2
    s_branch L_sb3
L_wza:
    s_mov_b64 exec, -1
    s_mov_b32 s60, 0
    s_mov_b32 s61, 65536
    s_mov_b32 s64, 0x0c0c0400
    s_mov_b32 s65, 0x05040100
L_s0:
    buffer_load_dwordx4 v[64:67], v62, s[36:39], s61 offen sc1
    buffer_load_dwordx4 v[68:71], v56, s[36:39], s61 offen sc1
    s_add_u32 s60, s60, 1
    s_cmp_ge_u32 s60, 60000
    s_cbranch_scc1 L_s0d
    s_waitcnt vmcnt(1)
    v_perm_b32 v72, v65, v64, s64
    v_perm_b32 v73, v67, v66, s64
    v_perm_b32 v72, v73, v72, s65
    v_cmp_ne_u32 s[62:63], s6, v72
    s_waitcnt vmcnt(0)
    v_perm_b32 v74, v69, v68, s64
    v_perm_b32 v75, v71, v70, s64
    v_perm_b32 v74, v75, v74, s65
    v_cmp_ne_u32 vcc, s6, v74
    s_nop 0
    s_or_b64 vcc, vcc, s[62:63]
    s_cbranch_vccnz L_s0
L_s0d:
    s_waitcnt vmcnt(0)
    v_and_b32 v64, 0xffffff00, v64
    v_and_b32 v65, 0xffffff00, v65
    v_and_b32 v66, 0xffffff00, v66
    v_and_b32 v67, 0xffffff00, v67
    v_and_b32 v68, 0xffffff00, v68
    v_and_b32 v69, 0xffffff00, v69
    v_and_b32 v70, 0xffffff00, v70
    v_and_b32 v71, 0xffffff00, v71
    v_pk_add_f32 v[64:65], v[64:65], v[68:69]
    v_pk_add_f32 v[66:67], v[66:67], v[70:71]
    v_cvt_pk_bf16_f32 v68, v64, v65
    v_cvt_pk_bf16_f32 v69, v66, v67
    v_lshlrev_b32 v64, 16, v68
    v_and_b32 v65, 0xffff0000, v68
    v_lshlrev_b32 v66, 16, v69
    v_and_b32 v67, 0xffff0000, v69
    v_add_f32 v64, v64, v63
    v_add_f32 v65, v65, v63
    v_add_f32 v66, v66, v63
    v_add_f32 v67, v67, v63
    v_cvt_pk_bf16_f32 v68, v64, v65
    v_cvt_pk_bf16_f32 v69, v66, v67
    v_lshlrev_b32 v64, 16, v68
    v_and_b32 v65, 0xffff0000, v68
    v_lshlrev_b32 v66, 16, v69
    v_and_b32 v67, 0xffff0000, v69
    ds_write_b128 v57, v[64:67]
    s_waitcnt lgkmcnt(0)
    s_barrier
    ds_read_b128 v[80:83], v58 offset:1792
    ds_read_b128 v[88:91], v58 offset:0
    ds_read_b128 v[84:87], v58 offset:1808
    ds_read_b128 v[92:95], v58 offset:16
    ds_read_b128 v[96:99], v58 offset:2816
    ds_read_b128 v[104:107], v58 offset:1024
    ds_read_b128 v[100:103], v58 offset:2832
    ds_read_b128 v[108:111], v58 offset:1040
    ds_read_b32 v61, v59
    s_waitcnt lgkmcnt(7)
    v_pk_fma_f32 v[40:41], v[40:41], v[80:81], v[88:89]
    v_pk_fma_f32 v[42:43], v[42:43], v[82:83], v[90:91]
    s_waitcnt lgkmcnt(5)
    v_pk_fma_f32 v[44:45], v[44:45], v[84:85], v[92:93]
    v_pk_fma_f32 v[46:47], v[46:47], v[86:87], v[94:95]
    v_cvt_pk_bf16_f32 v112, v40, v41
    v_cvt_pk_bf16_f32 v113, v42, v43
    v_cvt_pk_bf16_f32 v114, v44, v45
    v_cvt_pk_bf16_f32 v115, v46, v47
    buffer_store_dwordx4 v[112:115], v60, s[32:35], s98 offen
    s_waitcnt lgkmcnt(3)
    v_pk_fma_f32 v[48:49], v[48:49], v[96:97], v[104:105]
    v_pk_fma_f32 v[50:51], v[50:51], v[98:99], v[106:107]
    s_waitcnt lgkmcnt(1)
    v_pk_fma_f32 v[52:53], v[52:53], v[100:101], v[108:109]
    v_pk_fma_f32 v[54:55], v[54:55], v[102:103], v[110:111]
    v_cvt_pk_bf16_f32 v116, v48, v49
    v_cvt_pk_bf16_f32 v117, v50, v51
    v_cvt_pk_bf16_f32 v118, v52, v53
    v_cvt_pk_bf16_f32 v119, v54, v55
    buffer_store_dwordx4 v[116:119], v60, s[32:35], s99 offen
    s_waitcnt lgkmcnt(0)
    v_cmp_neq_f32 vcc, v76, v61
    s_nop 0
    s_cmp_eq_u64 vcc, 0
    s_cselect_b32 s7, 1, 0
    s_cmp_eq_u32 s68, 1
    s_cbranch_scc1 L_help
    s_mul_i32 s65, s3, 7168
    s_add_u32 m0, s65, 122880
    s_mul_i32 s67, s65, 42
    s_lshl_b32 s65, s48, 6
    s_add_u32 s67, s67, s65
    buffer_load_dwordx4 v229, s[12:15], s67 offen offset:0 lds
    buffer_load_dwordx4 v230, s[12:15], s67 offen offset:1024 lds
    buffer_load_dwordx4 v231, s[12:15], s67 offen offset:2048 lds
    buffer_load_dwordx4 v232, s[12:15], s67 offen offset:3072 lds
    s_add_u32 m0, m0, 4096
    s_add_u32 s67, s67, 172032
    buffer_load_dwordx4 v229, s[12:15], s67 offen offset:0 lds
    buffer_load_dwordx4 v230, s[12:15], s67 offen offset:1024 lds
    buffer_load_dwordx4 v231, s[12:15], s67 offen offset:2048 lds
    ds_read_b64_tr_b16 v[160:161], v253 offset:0
    ds_read_b64_tr_b16 v[162:163], v253 offset:512
    ds_read_b64_tr_b16 v[164:165], v252 offset:0
    ds_read_b64_tr_b16 v[166:167], v252 offset:512
    ds_read_b64_tr_b16 v[168:169], v253 offset:2048
    ds_read_b64_tr_b16 v[170:171], v253 offset:2560
    ds_read_b64_tr_b16 v[172:173], v252 offset:2048
    ds_read_b64_tr_b16 v[174:175], v252 offset:2560
    ds_read_b64_tr_b16 v[176:177], v253 offset:4096
    ds_read_b64_tr_b16 v[178:179], v253 offset:4608
    ds_read_b64_tr_b16 v[180:181], v252 offset:4096
    ds_read_b64_tr_b16 v[182:183], v252 offset:4608
    s_waitcnt vmcnt(7)
    s_mov_b64 exec, 1
    s_cmp_eq_u32 s7, 0
    s_cbranch_scc1 L_fs1
    buffer_store_dword v245, off, s[36:39], s46
L_fj2:
    s_mov_b64 exec, -1
    s_cmp_eq_u32 s68, 2
    s_cbranch_scc1 L_wc
    s_mov_b64 exec, 0
    s_cmp_eq_u32 s3, 0
    s_cbranch_scc1 L_sb10
    s_cmp_eq_u32 s3, 1
    s_cbranch_scc1 L_sb11
    s_cmp_eq_u32 s3, 2
    s_cbranch_scc1 L_sb12
    s_branch L_wzb
L_wzb:
    s_mov_b64 exec, -1
    s_branch L_wd
L_wc:
    v_mul_u32_u24 v236, 896, v243
    v_lshl_add_u32 v236, v244, 4, v236
    s_mul_i32 s62, s54, 28672
    s_lshl_b32 s61, s69, 6
    s_add_u32 s77, s62, s61
    s_lshl_b32 s61, s3, 9
    s_add_u32 s61, s61, 159744
    v_lshl_add_u32 v235, v244, 4, s61
    v_lshl_add_u32 v239, v243, 4, s61
    v_accvgpr_write_b32 a234, v239
    s_and_b32 s61, s54, 7
    s_lshl_b32 s61, s61, 6
    s_add_u32 s61, s61, s47
    s_lshl_b32 s62, s55, 5
    s_add_u32 s61, s61, s62
    s_add_u32 s0, s61, 1024
    s_lshl_b32 s62, s54, 1
    s_add_u32 s62, s62, s55
    s_lshl_b32 s62, s62, 14
    s_add_u32 s1, s62, 1048576
    s_mul_i32 s44, s54, 3584
    s_lshl_b32 s61, s53, 9
    s_add_u32 s44, s44, s61
    s_lshl_b32 s61, s55, 3
    s_add_u32 s44, s44, s61
    s_add_u32 s44, s44, 163840
    s_mul_i32 s98, s54, 28672
    s_lshl_b32 s61, s69, 11
    s_add_u32 s98, s98, s61
    s_and_b32 s61, s54, 7
    s_lshl_b32 s61, s61, 4
    s_add_u32 s61, s61, s69
    s_lshl_b32 s61, s61, 2
    s_add_u32 s61, s61, s47
    s_add_u32 s99, s61, 1536
    s_lshl_b32 s62, s56, 1
    s_add_u32 s62, s62, s53
    s_lshl_b32 s62, s62, 1
    s_add_u32 s62, s62, s4
    s_mul_i32 s64, s62, 37
    s_lshr_b32 s64, s64, 8
    s_mul_i32 s64, s64, 7
    s_sub_u32 s62, s62, s64
    s_mul_i32 s63, s3, 7
    s_add_u32 s64, s62, 0
    s_cmp_ge_u32 s64, 7
    s_cselect_b32 s65, 7, 0
    s_sub_u32 s64, s64, s65
    s_add_u32 s64, s64, s63
    s_and_b32 s65, s64, 0xfe
    s_lshr_b32 s66, s64, 1
    s_and_b32 s66, s66, 2
    s_add_u32 s64, s64, s66
    s_add_u32 s70, s64, s65
    s_add_u32 s64, s62, 1
    s_cmp_ge_u32 s64, 7
    s_cselect_b32 s65, 7, 0
    s_sub_u32 s64, s64, s65
    s_add_u32 s64, s64, s63
    s_and_b32 s65, s64, 0xfe
    s_lshr_b32 s66, s64, 1
    s_and_b32 s66, s66, 2
    s_add_u32 s64, s64, s66
    s_add_u32 s71, s64, s65
    s_add_u32 s64, s62, 2
    s_cmp_ge_u32 s64, 7
    s_cselect_b32 s65, 7, 0
    s_sub_u32 s64, s64, s65
    s_add_u32 s64, s64, s63
    s_and_b32 s65, s64, 0xfe
    s_lshr_b32 s66, s64, 1
    s_and_b32 s66, s66, 2
    s_add_u32 s64, s64, s66
    s_add_u32 s72, s64, s65
    s_add_u32 s64, s62, 3
    s_cmp_ge_u32 s64, 7
    s_cselect_b32 s65, 7, 0
    s_sub_u32 s64, s64, s65
    s_add_u32 s64, s64, s63
    s_and_b32 s65, s64, 0xfe
    s_lshr_b32 s66, s64, 1
    s_and_b32 s66, s66, 2
    s_add_u32 s64, s64, s66
    s_add_u32 s73, s64, s65
    s_add_u32 s64, s62, 4
    s_cmp_ge_u32 s64, 7
    s_cselect_b32 s65, 7, 0
    s_sub_u32 s64, s64, s65
    s_add_u32 s64, s64, s63
    s_and_b32 s65, s64, 0xfe
    s_lshr_b32 s66, s64, 1
    s_and_b32 s66, s66, 2
    s_add_u32 s64, s64, s66
    s_add_u32 s74, s64, s65
    s_add_u32 s64, s62, 5
    s_cmp_ge_u32 s64, 7
    s_cselect_b32 s65, 7, 0
    s_sub_u32 s64, s64, s65
    s_add_u32 s64, s64, s63
    s_and_b32 s65, s64, 0xfe
    s_lshr_b32 s66, s64, 1
    s_and_b32 s66, s66, 2
    s_add_u32 s64, s64, s66
    s_add_u32 s75, s64, s65
    s_add_u32 s64, s62, 6
    s_cmp_ge_u32 s64, 7
    s_cselect_b32 s65, 7, 0
    s_sub_u32 s64, s64, s65
    s_add_u32 s64, s64, s63
    s_and_b32 s65, s64, 0xfe
    s_lshr_b32 s66, s64, 1
    s_and_b32 s66, s66, 2
    s_add_u32 s64, s64, s66
    s_add_u32 s76, s64, s65
    s_mov_b64 exec, 0
    s_cmp_eq_u32 s3, 0
    s_cbranch_scc1 L_sb13
    s_cmp_eq_u32 s3, 1
    s_cbranch_scc1 L_sb14
    s_cmp_eq_u32 s3, 2
    s_cbranch_scc1 L_sb15
    s_branch L_sb16
L_wzc:
    s_mov_b64 exec, -1
L_wd:
    v_and_b32 v242, 15, v255
    v_lshlrev_b32 v242, 2, v242
    s_mov_b32 s60, 0
L_p3:
    buffer_load_dword v238, v242, s[36:39], s85 offen sc1
    s_add_u32 s60, s60, 1
    s_cmp_ge_u32 s60, 60000
    s_cbranch_scc1 L_pd4
    s_cmp_eq_u32 s7, 0
    s_waitcnt vmcnt(0)
    v_cmp_ne_u32 vcc, s6, v238
    s_cbranch_vccnz L_p3
L_pd4:
    s_cbranch_scc1 L_pi5
L_pj6:
    buffer_load_dwordx4 v[0:3], v254, s[32:35], s82 offen offset:0 sc1
    buffer_load_dwordx4 v[4:7], v254, s[32:35], s82 offen offset:1024 sc1
    buffer_load_dwordx4 v[8:11], v254, s[32:35], s82 offen offset:2048 sc1
    buffer_load_dwordx4 v[12:15], v254, s[32:35], s82 offen offset:3072 sc1
    s_add_u32 s82, s82, 4096
    buffer_load_dwordx4 v[16:19], v254, s[32:35], s82 offen offset:0 sc1
    buffer_load_dwordx4 v[20:23], v254, s[32:35], s82 offen offset:1024 sc1
    buffer_load_dwordx4 v[24:27], v254, s[32:35], s82 offen offset:2048 sc1
    buffer_load_dwordx4 v[28:31], v254, s[32:35], s82 offen offset:3072 sc1
L_sb0:
    s_cbranch_execz L_sb4
    s_add_u32 s82, s82, 4096
    buffer_load_dwordx4 v[32:35], v254, s[32:35], s82 offen offset:0 sc1
    buffer_load_dwordx4 v[36:39], v254, s[32:35], s82 offen offset:1024 sc1
    s_lshl_b32 s61, s48, 3
    v_add3_u32 v239, v244, s61, 0
    v_mul_u32_u24 v240, 147, v239
    v_lshrrev_b32 v240, 10, v240
    v_add_lshl_u32 v239, v239, v240, 8
    v_lshl_add_u32 v224, v243, 3, v239
    v_add3_u32 v239, v244, s61, 2
    v_mul_u32_u24 v240, 147, v239
    v_lshrrev_b32 v240, 10, v240
    v_add_lshl_u32 v239, v239, v240, 8
    v_lshl_add_u32 v225, v243, 3, v239
    v_add3_u32 v239, v244, s61, 4
    v_mul_u32_u24 v240, 147, v239
    v_lshrrev_b32 v240, 10, v240
    v_add_lshl_u32 v239, v239, v240, 8
    v_lshl_add_u32 v226, v243, 3, v239
    v_add3_u32 v239, v244, s61, 6
    v_mul_u32_u24 v240, 147, v239
    v_lshrrev_b32 v240, 10, v240
    v_add_lshl_u32 v239, v239, v240, 8
    v_lshl_add_u32 v227, v243, 3, v239
    s_cmp_ge_u32 s48, 7
    s_cbranch_scc1 L_va
    s_lshl_b32 s61, s48, 4
    s_add_u32 s80, s80, 3145728
    v_add3_u32 v239, v244, s61, 0
    v_mul_u32_u24 v240, 147, v239
    v_lshrrev_b32 v240, 10, v240
    v_mul_u32_u24 v240, 112896, v240
    v_lshl_add_u32 v239, v239, 8, v240
    v_lshl_add_u32 v216, v243, 3, v239
    v_add3_u32 v239, v244, s61, 2
    v_mul_u32_u24 v240, 147, v239
    v_lshrrev_b32 v240, 10, v240
    v_mul_u32_u24 v240, 112896, v240
    v_lshl_add_u32 v239, v239, 8, v240
    v_lshl_add_u32 v217, v243, 3, v239
    v_add3_u32 v239, v244, s61, 4
    v_mul_u32_u24 v240, 147, v239
    v_lshrrev_b32 v240, 10, v240
    v_mul_u32_u24 v240, 112896, v240
    v_lshl_add_u32 v239, v239, 8, v240
    v_lshl_add_u32 v218, v243, 3, v239
    v_add3_u32 v239, v244, s61, 6
    v_mul_u32_u24 v240, 147, v239
    v_lshrrev_b32 v240, 10, v240
    v_mul_u32_u24 v240, 112896, v240
    v_lshl_add_u32 v239, v239, 8, v240
    v_lshl_add_u32 v219, v243, 3, v239
    v_add3_u32 v239, v244, s61, 8
    v_mul_u32_u24 v240, 147, v239
    v_lshrrev_b32 v240, 10, v240
    v_mul_u32_u24 v240, 112896, v240
    v_lshl_add_u32 v239, v239, 8, v240
    v_lshl_add_u32 v220, v243, 3, v239
    v_add3_u32 v239, v244, s61, 10
    v_mul_u32_u24 v240, 147, v239
    v_lshrrev_b32 v240, 10, v240
    v_mul_u32_u24 v240, 112896, v240
    v_lshl_add_u32 v239, v239, 8, v240
    v_lshl_add_u32 v221, v243, 3, v239
    v_add3_u32 v239, v244, s61, 12
    v_mul_u32_u24 v240, 147, v239
    v_lshrrev_b32 v240, 10, v240
    v_mul_u32_u24 v240, 112896, v240
    v_lshl_add_u32 v239, v239, 8, v240
    v_lshl_add_u32 v222, v243, 3, v239
    v_add3_u32 v239, v244, s61, 14
    v_mul_u32_u24 v240, 147, v239
    v_lshrrev_b32 v240, 10, v240
    v_mul_u32_u24 v240, 112896, v240
    v_lshl_add_u32 v239, v239, 8, v240
    v_lshl_add_u32 v223, v243, 3, v239
    s_branch L_vb
L_va:
L_sb1:
    s_cbranch_execz L_sb5
    s_sub_u32 s61, s48, 7
    s_lshl_b32 s61, s61, 6
    s_add_u32 s80, s80, 5242880
    v_add3_u32 v239, v243, s61, 0
    v_lshrrev_b32 v240, 2, v239
    v_mul_u32_u24 v240, 147, v240
    v_lshrrev_b32 v240, 10, v240
    v_mul_u32_u24 v240, 114240, v240
    v_lshl_add_u32 v239, v239, 4, v240
    v_mul_u32_u24 v240, 448, v244
    v_add_u32 v216, v239, v240
    v_add3_u32 v239, v243, s61, 32
    v_lshrrev_b32 v240, 2, v239
    v_mul_u32_u24 v240, 147, v240
    v_lshrrev_b32 v240, 10, v240
    v_mul_u32_u24 v240, 114240, v240
    v_lshl_add_u32 v239, v239, 4, v240
    v_mul_u32_u24 v240, 448, v244
    v_add_u32 v217, v239, v240
    v_mov_b32 v218, 0
    v_mov_b32 v219, 0
    v_mov_b32 v220, 0
    v_mov_b32 v221, 0
    v_mov_b32 v222, 0
    v_mov_b32 v223, 0
L_vb:
L_sb2:
    s_cbranch_execz L_sb6
    s_cmp_ge_u32 s48, 7
    s_cbranch_scc1 L_kvV
    s_waitcnt vmcnt(9)
    s_waitcnt lgkmcnt(8)
    v_mfma_f32_32x32x16_bf16 v[112:127], v[160:163], v[0:3], 0
    buffer_load_dwordx4 v[40:43], v254, s[32:35], s82 offen offset:2048 sc1
    ds_read_b64_tr_b16 v[184:185], v253 offset:6144
    v_mfma_f32_32x32x16_bf16 v[128:143], v[164:167], v[0:3], 0
    ds_read_b64_tr_b16 v[186:187], v253 offset:6656
    ds_read_b64_tr_b16 v[188:189], v252 offset:6144
    ds_read_b64_tr_b16 v[190:191], v252 offset:6656
    s_waitcnt vmcnt(9)
    s_waitcnt lgkmcnt(8)
    v_mfma_f32_32x32x16_bf16 v[112:127], v[168:171], v[4:7], v[112:127]
    buffer_load_dwordx4 v[44:47], v254, s[32:35], s82 offen offset:3072 sc1
    ds_read_b64_tr_b16 v[160:161], v253 offset:8192
    v_mfma_f32_32x32x16_bf16 v[128:143], v[172:175], v[4:7], v[128:143]
    ds_read_b64_tr_b16 v[162:163], v253 offset:8704
    ds_read_b64_tr_b16 v[164:165], v252 offset:8192
    ds_read_b64_tr_b16 v[166:167], v252 offset:8704
    s_waitcnt vmcnt(9)
    s_waitcnt lgkmcnt(8)
    v_mfma_f32_32x32x16_bf16 v[112:127], v[176:179], v[8:11], v[112:127]
    s_add_u32 s82, s82, 4096
    buffer_load_dwordx4 v[48:51], v254, s[32:35], s82 offen offset:0 sc1
    ds_read_b64_tr_b16 v[168:169], v253 offset:10240
    v_mfma_f32_32x32x16_bf16 v[128:143], v[180:183], v[8:11], v[128:143]
    ds_read_b64_tr_b16 v[170:171], v253 offset:10752
    ds_read_b64_tr_b16 v[172:173], v252 offset:10240
    ds_read_b64_tr_b16 v[174:175], v252 offset:10752
    s_waitcnt vmcnt(9)
    s_waitcnt lgkmcnt(8)
    v_mfma_f32_32x32x16_bf16 v[112:127], v[184:187], v[12:15], v[112:127]
    buffer_load_dwordx4 v[52:55], v254, s[32:35], s82 offen offset:1024 sc1
    ds_read_b64_tr_b16 v[176:177], v253 offset:12288
    v_mfma_f32_32x32x16_bf16 v[128:143], v[188:191], v[12:15], v[128:143]
    ds_read_b64_tr_b16 v[178:179], v253 offset:12800
    ds_read_b64_tr_b16 v[180:181], v252 offset:12288
    ds_read_b64_tr_b16 v[182:183], v252 offset:12800
    s_waitcnt vmcnt(9)
    s_waitcnt lgkmcnt(8)
    v_mfma_f32_32x32x16_bf16 v[112:127], v[160:163], v[16:19], v[112:127]
    buffer_load_dwordx4 v[56:59], v254, s[32:35], s82 offen offset:2048 sc1
    ds_read_b64_tr_b16 v[184:185], v253 offset:14336
    v_mfma_f32_32x32x16_bf16 v[128:143], v[164:167], v[16:19], v[128:143]
    ds_read_b64_tr_b16 v[186:187], v253 offset:14848
    ds_read_b64_tr_b16 v[188:189], v252 offset:14336
    ds_read_b64_tr_b16 v[190:191], v252 offset:14848
    s_waitcnt vmcnt(9)
    s_waitcnt lgkmcnt(8)
    v_mfma_f32_32x32x16_bf16 v[112:127], v[168:171], v[20:23], v[112:127]
    buffer_load_dwordx4 v[60:63], v254, s[32:35], s82 offen offset:3072 sc1
    ds_read_b64_tr_b16 v[160:161], v253 offset:16384
    v_mfma_f32_32x32x16_bf16 v[128:143], v[172:175], v[20:23], v[128:143]
    ds_read_b64_tr_b16 v[162:163], v253 offset:16896
    ds_read_b64_tr_b16 v[164:165], v252 offset:16384
    ds_read_b64_tr_b16 v[166:167], v252 offset:16896
    s_waitcnt vmcnt(9)
    s_waitcnt lgkmcnt(8)
    v_mfma_f32_32x32x16_bf16 v[112:127], v[176:179], v[24:27], v[112:127]
    s_add_u32 s82, s82, 4096
    buffer_load_dwordx4 v[64:67], v254, s[32:35], s82 offen offset:0 sc1
    ds_read_b64_tr_b16 v[168:169], v253 offset:18432
    v_mfma_f32_32x32x16_bf16 v[128:143], v[180:183], v[24:27], v[128:143]
    ds_read_b64_tr_b16 v[170:171], v253 offset:18944
    ds_read_b64_tr_b16 v[172:173], v252 offset:18432
    ds_read_b64_tr_b16 v[174:175], v252 offset:18944
    s_waitcnt vmcnt(9)
    s_waitcnt lgkmcnt(8)
    v_mfma_f32_32x32x16_bf16 v[112:127], v[184:187], v[28:31], v[112:127]
    buffer_load_dwordx4 v[68:71], v254, s[32:35], s82 offen offset:1024 sc1
    ds_read_b64_tr_b16 v[176:177], v253 offset:20480
    v_mfma_f32_32x32x16_bf16 v[128:143], v[188:191], v[28:31], v[128:143]
    ds_read_b64_tr_b16 v[178:179], v253 offset:20992
    ds_read_b64_tr_b16 v[180:181], v252 offset:20480
    ds_read_b64_tr_b16 v[182:183], v252 offset:20992
    s_waitcnt vmcnt(9)
    s_waitcnt lgkmcnt(8)
    v_mfma_f32_32x32x16_bf16 v[112:127], v[160:163], v[32:35], v[112:127]
    buffer_load_dwordx4 v[72:75], v254, s[32:35], s82 offen offset:2048 sc1
    ds_read_b64_tr_b16 v[184:185], v253 offset:22528
    v_mfma_f32_32x32x16_bf16 v[128:143], v[164:167], v[32:35], v[128:143]
    ds_read_b64_tr_b16 v[186:187], v253 offset:23040
    ds_read_b64_tr_b16 v[188:189], v252 offset:22528
    ds_read_b64_tr_b16 v[190:191], v252 offset:23040
    s_waitcnt vmcnt(9)
    s_waitcnt lgkmcnt(8)
    v_mfma_f32_32x32x16_bf16 v[112:127], v[168:171], v[36:39], v[112:127]
    buffer_load_dwordx4 v[76:79], v254, s[32:35], s82 offen offset:3072 sc1
    ds_read_b64_tr_b16 v[160:161], v253 offset:24576
    v_mfma_f32_32x32x16_bf16 v[128:143], v[172:175], v[36:39], v[128:143]
    ds_read_b64_tr_b16 v[162:163], v253 offset:25088
    ds_read_b64_tr_b16 v[164:165], v252 offset:24576
    ds_read_b64_tr_b16 v[166:167], v252 offset:25088
    s_waitcnt vmcnt(9)
    s_waitcnt lgkmcnt(8)
    v_mfma_f32_32x32x16_bf16 v[112:127], v[176:179], v[40:43], v[112:127]
    s_add_u32 s82, s82, 4096
    buffer_load_dwordx4 v[80:83], v254, s[32:35], s82 offen offset:0 sc1
    ds_read_b64_tr_b16 v[168:169], v253 offset:26624
    v_mfma_f32_32x32x16_bf16 v[128:143], v[180:183], v[40:43], v[128:143]
    ds_read_b64_tr_b16 v[170:171], v253 offset:27136
    ds_read_b64_tr_b16 v[172:173], v252 offset:26624
    ds_read_b64_tr_b16 v[174:175], v252 offset:27136
    s_waitcnt vmcnt(9)
    s_waitcnt lgkmcnt(8)
    v_mfma_f32_32x32x16_bf16 v[112:127], v[184:187], v[44:47], v[112:127]
    buffer_load_dwordx4 v[84:87], v254, s[32:35], s82 offen offset:1024 sc1
    ds_read_b64_tr_b16 v[176:177], v253 offset:28672
    v_mfma_f32_32x32x16_bf16 v[128:143], v[188:191], v[44:47], v[128:143]
    ds_read_b64_tr_b16 v[178:179], v253 offset:29184
    ds_read_b64_tr_b16 v[180:181], v252 offset:28672
    ds_read_b64_tr_b16 v[182:183], v252 offset:29184
    s_waitcnt vmcnt(9)
    s_waitcnt lgkmcnt(8)
    v_mfma_f32_32x32x16_bf16 v[112:127], v[160:163], v[48:51], v[112:127]
    buffer_load_dwordx4 v[88:91], v254, s[32:35], s82 offen offset:2048 sc1
    ds_read_b64_tr_b16 v[184:185], v253 offset:30720
    v_mfma_f32_32x32x16_bf16 v[128:143], v[164:167], v[48:51], v[128:143]
    ds_read_b64_tr_b16 v[186:187], v253 offset:31232
    ds_read_b64_tr_b16 v[188:189], v252 offset:30720
    ds_read_b64_tr_b16 v[190:191], v252 offset:31232
    s_waitcnt vmcnt(9)
    s_waitcnt lgkmcnt(8)
    v_mfma_f32_32x32x16_bf16 v[112:127], v[168:171], v[52:55], v[112:127]
    buffer_load_dwordx4 v[92:95], v254, s[32:35], s82 offen offset:3072 sc1
    ds_read_b64_tr_b16 v[160:161], v253 offset:32768
    v_mfma_f32_32x32x16_bf16 v[128:143], v[172:175], v[52:55], v[128:143]
    ds_read_b64_tr_b16 v[162:163], v253 offset:33280
    ds_read_b64_tr_b16 v[164:165], v252 offset:32768
    ds_read_b64_tr_b16 v[166:167], v252 offset:33280
    s_waitcnt vmcnt(9)
    s_waitcnt lgkmcnt(8)
    v_mfma_f32_32x32x16_bf16 v[112:127], v[176:179], v[56:59], v[112:127]
    s_add_u32 s82, s82, 4096
    buffer_load_dwordx4 v[96:99], v254, s[32:35], s82 offen offset:0 sc1
    ds_read_b64_tr_b16 v[168:169], v253 offset:34816
    v_mfma_f32_32x32x16_bf16 v[128:143], v[180:183], v[56:59], v[128:143]
    ds_read_b64_tr_b16 v[170:171], v253 offset:35328
    ds_read_b64_tr_b16 v[172:173], v252 offset:34816
    ds_read_b64_tr_b16 v[174:175], v252 offset:35328
    s_waitcnt vmcnt(9)
    s_waitcnt lgkmcnt(8)
    v_mfma_f32_32x32x16_bf16 v[112:127], v[184:187], v[60:63], v[112:127]
    buffer_load_dwordx4 v[100:103], v254, s[32:35], s82 offen offset:1024 sc1
    ds_read_b64_tr_b16 v[176:177], v253 offset:36864
    v_mfma_f32_32x32x16_bf16 v[128:143], v[188:191], v[60:63], v[128:143]
    ds_read_b64_tr_b16 v[178:179], v253 offset:37376
    ds_read_b64_tr_b16 v[180:181], v252 offset:36864
    ds_read_b64_tr_b16 v[182:183], v252 offset:37376
    s_waitcnt vmcnt(9)
    s_waitcnt lgkmcnt(8)
    v_mfma_f32_32x32x16_bf16 v[112:127], v[160:163], v[64:67], v[112:127]
    buffer_load_dwordx4 v[104:107], v254, s[32:35], s82 offen offset:2048 sc1
    ds_read_b64_tr_b16 v[184:185], v253 offset:38912
    v_mfma_f32_32x32x16_bf16 v[128:143], v[164:167], v[64:67], v[128:143]
    ds_read_b64_tr_b16 v[186:187], v253 offset:39424
    ds_read_b64_tr_b16 v[188:189], v252 offset:38912
    ds_read_b64_tr_b16 v[190:191], v252 offset:39424
    s_waitcnt vmcnt(9)
    s_waitcnt lgkmcnt(8)
    v_mfma_f32_32x32x16_bf16 v[112:127], v[168:171], v[68:71], v[112:127]
    buffer_load_dwordx4 v[108:111], v254, s[32:35], s82 offen offset:3072 sc1
    ds_read_b64_tr_b16 v[160:161], v253 offset:40960
    v_mfma_f32_32x32x16_bf16 v[128:143], v[172:175], v[68:71], v[128:143]
    ds_read_b64_tr_b16 v[162:163], v253 offset:41472
    ds_read_b64_tr_b16 v[164:165], v252 offset:40960
    ds_read_b64_tr_b16 v[166:167], v252 offset:41472
    s_waitcnt vmcnt(9)
    s_waitcnt lgkmcnt(8)
    v_mfma_f32_32x32x16_bf16 v[112:127], v[176:179], v[72:75], v[112:127]
    s_lshl_b32 s65, s69, 6
    v_and_b32 v239, 7, v255
    v_lshl_add_u32 v239, v239, 3, s65
    global_load_dwordx2 a[246:247], v239, s[42:43]
    ds_read_b64_tr_b16 v[168:169], v253 offset:43008
    v_mfma_f32_32x32x16_bf16 v[128:143], v[180:183], v[72:75], v[128:143]
    ds_read_b64_tr_b16 v[170:171], v253 offset:43520
    ds_read_b64_tr_b16 v[172:173], v252 offset:43008
    ds_read_b64_tr_b16 v[174:175], v252 offset:43520
    s_waitcnt vmcnt(9)
    s_waitcnt lgkmcnt(8)
    v_mfma_f32_32x32x16_bf16 v[112:127], v[184:187], v[76:79], v[112:127]
    v_accvgpr_read_b32 v240, a233
    s_and_b32 s65, s54, 0xfe
    s_lshl_b32 s65, s65, 1
    s_add_u32 s65, s65, s3
    s_mul_i32 s65, s65, 14336
    s_add_u32 s65, s65, s59
    s_lshl_b32 s66, s3, 11
    s_add_u32 m0, s66, 81920
    s_nop 0
    buffer_load_dwordx4 v240, s[8:11], s65 offen lds
    ds_read_b64_tr_b16 v[176:177], v253 offset:45056
    v_mfma_f32_32x32x16_bf16 v[128:143], v[188:191], v[76:79], v[128:143]
    ds_read_b64_tr_b16 v[178:179], v253 offset:45568
    ds_read_b64_tr_b16 v[180:181], v252 offset:45056
    ds_read_b64_tr_b16 v[182:183], v252 offset:45568
    s_waitcnt vmcnt(9)
    s_waitcnt lgkmcnt(8)
    v_mfma_f32_32x32x16_bf16 v[112:127], v[160:163], v[80:83], v[112:127]
    s_add_u32 s65, s65, 6144
    buffer_load_dwordx4 v240, s[8:11], s65 offen offset:1024 lds
    ds_read_b64_tr_b16 v[184:185], v253 offset:47104
    v_mfma_f32_32x32x16_bf16 v[128:143], v[164:167], v[80:83], v[128:143]
    ds_read_b64_tr_b16 v[186:187], v253 offset:47616
    ds_read_b64_tr_b16 v[188:189], v252 offset:47104
    ds_read_b64_tr_b16 v[190:191], v252 offset:47616
    s_waitcnt vmcnt(9)
    s_waitcnt lgkmcnt(8)
    v_mfma_f32_32x32x16_bf16 v[112:127], v[168:171], v[84:87], v[112:127]
    s_add_u32 m0, m0, 8192
    s_add_u32 s65, s65, 108544
    buffer_load_dwordx4 v240, s[8:11], s65 offen lds
    ds_read_b64_tr_b16 v[160:161], v253 offset:49152
    v_mfma_f32_32x32x16_bf16 v[128:143], v[172:175], v[84:87], v[128:143]
    ds_read_b64_tr_b16 v[162:163], v253 offset:49664
    ds_read_b64_tr_b16 v[164:165], v252 offset:49152
    ds_read_b64_tr_b16 v[166:167], v252 offset:49664
    s_waitcnt vmcnt(9)
    s_waitcnt lgkmcnt(8)
    v_mfma_f32_32x32x16_bf16 v[112:127], v[176:179], v[88:91], v[112:127]
    s_add_u32 s65, s65, 6144
    buffer_load_dwordx4 v240, s[8:11], s65 offen offset:1024 lds
    ds_read_b64_tr_b16 v[168:169], v253 offset:51200
    v_mfma_f32_32x32x16_bf16 v[128:143], v[180:183], v[88:91], v[128:143]
    ds_read_b64_tr_b16 v[170:171], v253 offset:51712
    ds_read_b64_tr_b16 v[172:173], v252 offset:51200
    ds_read_b64_tr_b16 v[174:175], v252 offset:51712
    s_waitcnt vmcnt(9)
    s_waitcnt lgkmcnt(8)
    v_mfma_f32_32x32x16_bf16 v[112:127], v[184:187], v[92:95], v[112:127]
    v_and_b32 v239, 15, v255
    v_lshlrev_b32 v239, 7, v239
    buffer_load_dword v238, v239, s[36:39], s90 offen sc1
    ds_read_b64_tr_b16 v[176:177], v253 offset:53248
    v_mfma_f32_32x32x16_bf16 v[128:143], v[188:191], v[92:95], v[128:143]
    ds_read_b64_tr_b16 v[178:179], v253 offset:53760
    ds_read_b64_tr_b16 v[180:181], v252 offset:53248
    ds_read_b64_tr_b16 v[182:183], v252 offset:53760
    s_waitcnt vmcnt(9)
    s_waitcnt lgkmcnt(8)
    v_mfma_f32_32x32x16_bf16 v[112:127], v[160:163], v[96:99], v[112:127]
    ds_read_b64_tr_b16 v[184:185], v253 offset:55296
    v_mfma_f32_32x32x16_bf16 v[128:143], v[164:167], v[96:99], v[128:143]
    ds_read_b64_tr_b16 v[186:187], v253 offset:55808
    ds_read_b64_tr_b16 v[188:189], v252 offset:55296
    ds_read_b64_tr_b16 v[190:191], v252 offset:55808
    s_waitcnt vmcnt(8)
    s_waitcnt lgkmcnt(8)
    v_mfma_f32_32x32x16_bf16 v[112:127], v[168:171], v[100:103], v[112:127]
    v_mfma_f32_32x32x16_bf16 v[128:143], v[172:175], v[100:103], v[128:143]
    s_waitcnt vmcnt(7)
    s_waitcnt lgkmcnt(4)
    s_barrier
    v_mfma_f32_32x32x16_bf16 v[112:127], v[176:179], v[104:107], v[112:127]
    ds_read_b64_tr_b16 v[160:161], v228 offset:0
    v_mfma_f32_32x32x16_bf16 v[128:143], v[180:183], v[104:107], v[128:143]
    ds_read_b64_tr_b16 v[162:163], v228 offset:256
    ds_read_b64_tr_b16 v[164:165], v228 offset:1024
    ds_read_b64_tr_b16 v[166:167], v228 offset:1280
    s_waitcnt vmcnt(6)
    s_waitcnt lgkmcnt(4)
    v_mfma_f32_32x32x16_bf16 v[112:127], v[184:187], v[108:111], v[112:127]
    ds_read_b64_tr_b16 v[168:169], v228 offset:2048
    v_mfma_f32_32x32x16_bf16 v[128:143], v[188:191], v[108:111], v[128:143]
    ds_read_b64_tr_b16 v[170:171], v228 offset:2304
    ds_read_b64_tr_b16 v[172:173], v228 offset:3072
    ds_read_b64_tr_b16 v[174:175], v228 offset:3328
    s_waitcnt lgkmcnt(6)
    v_mfma_f32_32x32x16_bf16 v[144:159], v[160:163], v[0:3], 0
    ds_read_b64_tr_b16 v[176:177], v228 offset:4096
    ds_read_b64_tr_b16 v[178:179], v228 offset:4352
    s_waitcnt lgkmcnt(6)
    v_mfma_f32_32x32x16_bf16 v[144:159], v[164:167], v[4:7], v[144:159]
    ds_read_b64_tr_b16 v[180:181], v228 offset:5120
    ds_read_b64_tr_b16 v[182:183], v228 offset:5376
    v_cvt_pk_bf16_f32 v192, v112, v113
    v_cvt_pk_bf16_f32 v193, v114, v115
    buffer_store_dwordx2 v[192:193], v216, s[36:39], s80 offen sc1
    v_cvt_pk_bf16_f32 v194, v116, v117
    v_cvt_pk_bf16_f32 v195, v118, v119
    buffer_store_dwordx2 v[194:195], v217, s[36:39], s80 offen sc1
    s_waitcnt lgkmcnt(6)
    v_mfma_f32_32x32x16_bf16 v[144:159], v[168:171], v[8:11], v[144:159]
    ds_read_b64_tr_b16 v[184:185], v228 offset:6144
    ds_read_b64_tr_b16 v[186:187], v228 offset:6400
    v_cvt_pk_bf16_f32 v196, v120, v121
    v_cvt_pk_bf16_f32 v197, v122, v123
    buffer_store_dwordx2 v[196:197], v218, s[36:39], s80 offen sc1
    v_cvt_pk_bf16_f32 v198, v124, v125
    v_cvt_pk_bf16_f32 v199, v126, v127
    buffer_store_dwordx2 v[198:199], v219, s[36:39], s80 offen sc1
    s_waitcnt lgkmcnt(6)
    v_mfma_f32_32x32x16_bf16 v[144:159], v[172:175], v[12:15], v[144:159]
    ds_read_b64_tr_b16 v[188:189], v228 offset:7168
    ds_read_b64_tr_b16 v[190:191], v228 offset:7424
    v_cvt_pk_bf16_f32 v200, v128, v129
    v_cvt_pk_bf16_f32 v201, v130, v131
    buffer_store_dwordx2 v[200:201], v220, s[36:39], s80 offen sc1
    v_cvt_pk_bf16_f32 v202, v132, v133
    v_cvt_pk_bf16_f32 v203, v134, v135
    buffer_store_dwordx2 v[202:203], v221, s[36:39], s80 offen sc1
    s_waitcnt lgkmcnt(6)
    v_mfma_f32_32x32x16_bf16 v[144:159], v[176:179], v[16:19], v[144:159]
    ds_read_b64_tr_b16 v[160:161], v228 offset:8192
    ds_read_b64_tr_b16 v[162:163], v228 offset:8448
    v_cvt_pk_bf16_f32 v204, v136, v137
    v_cvt_pk_bf16_f32 v205, v138, v139
    buffer_store_dwordx2 v[204:205], v222, s[36:39], s80 offen sc1
    v_cvt_pk_bf16_f32 v206, v140, v141
    v_cvt_pk_bf16_f32 v207, v142, v143
    buffer_store_dwordx2 v[206:207], v223, s[36:39], s80 offen sc1
    s_waitcnt lgkmcnt(6)
    v_mfma_f32_32x32x16_bf16 v[144:159], v[180:183], v[20:23], v[144:159]
    ds_read_b64_tr_b16 v[164:165], v228 offset:9216
    ds_read_b64_tr_b16 v[166:167], v228 offset:9472
    s_waitcnt lgkmcnt(6)
    v_mfma_f32_32x32x16_bf16 v[144:159], v[184:187], v[24:27], v[144:159]
    ds_read_b64_tr_b16 v[168:169], v228 offset:10240
    ds_read_b64_tr_b16 v[170:171], v228 offset:10496
    s_waitcnt lgkmcnt(6)
    v_mfma_f32_32x32x16_bf16 v[144:159], v[188:191], v[28:31], v[144:159]
    ds_read_b64_tr_b16 v[172:173], v228 offset:11264
    ds_read_b64_tr_b16 v[174:175], v228 offset:11520
    s_waitcnt lgkmcnt(6)
    v_mfma_f32_32x32x16_bf16 v[144:159], v[160:163], v[32:35], v[144:159]
    ds_read_b64_tr_b16 v[176:177], v228 offset:12288
    ds_read_b64_tr_b16 v[178:179], v228 offset:12544
    s_barrier
    s_waitcnt lgkmcnt(6)
    v_mfma_f32_32x32x16_bf16 v[144:159], v[164:167], v[36:39], v[144:159]
    ds_read_b64_tr_b16 v[180:181], v228 offset:13312
    ds_read_b64_tr_b16 v[182:183], v228 offset:13568
    s_waitcnt lgkmcnt(6)
    v_mfma_f32_32x32x16_bf16 v[144:159], v[168:171], v[40:43], v[144:159]
    ds_read_b64_tr_b16 v[184:185], v228 offset:14336
    ds_read_b64_tr_b16 v[186:187], v228 offset:14592
    s_waitcnt lgkmcnt(6)
    v_mfma_f32_32x32x16_bf16 v[144:159], v[172:175], v[44:47], v[144:159]
    ds_read_b64_tr_b16 v[188:189], v228 offset:15360
    ds_read_b64_tr_b16 v[190:191], v228 offset:15616
    s_waitcnt lgkmcnt(6)
    v_mfma_f32_32x32x16_bf16 v[144:159], v[176:179], v[48:51], v[144:159]
    ds_read_b64_tr_b16 v[160:161], v228 offset:16384
    ds_read_b64_tr_b16 v[162:163], v228 offset:16640
    s_waitcnt lgkmcnt(6)
    v_mfma_f32_32x32x16_bf16 v[144:159], v[180:183], v[52:55], v[144:159]
    ds_read_b64_tr_b16 v[164:165], v228 offset:17408
    ds_read_b64_tr_b16 v[166:167], v228 offset:17664
    s_waitcnt lgkmcnt(6)
    v_mfma_f32_32x32x16_bf16 v[144:159], v[184:187], v[56:59], v[144:159]
    ds_read_b64_tr_b16 v[168:169], v228 offset:18432
    ds_read_b64_tr_b16 v[170:171], v228 offset:18688
    s_waitcnt lgkmcnt(6)
    v_mfma_f32_32x32x16_bf16 v[144:159], v[188:191], v[60:63], v[144:159]
    ds_read_b64_tr_b16 v[172:173], v228 offset:19456
    ds_read_b64_tr_b16 v[174:175], v228 offset:19712
    s_waitcnt lgkmcnt(6)
    v_mfma_f32_32x32x16_bf16 v[144:159], v[160:163], v[64:67], v[144:159]
    ds_read_b64_tr_b16 v[176:177], v228 offset:20480
    ds_read_b64_tr_b16 v[178:179], v228 offset:20736
    s_waitcnt lgkmcnt(6)
    v_mfma_f32_32x32x16_bf16 v[144:159], v[164:167], v[68:71], v[144:159]
    ds_read_b64_tr_b16 v[180:181], v228 offset:21504
    ds_read_b64_tr_b16 v[182:183], v228 offset:21760
    s_waitcnt lgkmcnt(6)
    v_mfma_f32_32x32x16_bf16 v[144:159], v[168:171], v[72:75], v[144:159]
    ds_read_b64_tr_b16 v[184:185], v228 offset:22528
    ds_read_b64_tr_b16 v[186:187], v228 offset:22784
    s_waitcnt lgkmcnt(6)
    v_mfma_f32_32x32x16_bf16 v[144:159], v[172:175], v[76:79], v[144:159]
    ds_read_b64_tr_b16 v[188:189], v228 offset:23552
    ds_read_b64_tr_b16 v[190:191], v228 offset:23808
    s_waitcnt lgkmcnt(6)
    v_mfma_f32_32x32x16_bf16 v[144:159], v[176:179], v[80:83], v[144:159]
    ds_read_b64_tr_b16 v[160:161], v228 offset:24576
    ds_read_b64_tr_b16 v[162:163], v228 offset:24832
    s_waitcnt lgkmcnt(6)
    v_mfma_f32_32x32x16_bf16 v[144:159], v[180:183], v[84:87], v[144:159]
    ds_read_b64_tr_b16 v[164:165], v228 offset:25600
    ds_read_b64_tr_b16 v[166:167], v228 offset:25856
    s_waitcnt lgkmcnt(6)
    v_mfma_f32_32x32x16_bf16 v[144:159], v[184:187], v[88:91], v[144:159]
    ds_read_b64_tr_b16 v[168:169], v228 offset:26624
    ds_read_b64_tr_b16 v[170:171], v228 offset:26880
    s_waitcnt vmcnt(0)
    s_mov_b64 exec, 1
    buffer_store_dword v245, off, s[36:39], s83 sc1
    s_mov_b64 exec, -1
    s_waitcnt lgkmcnt(6)
    v_mfma_f32_32x32x16_bf16 v[144:159], v[188:191], v[92:95], v[144:159]
    ds_read_b64_tr_b16 v[172:173], v228 offset:27648
    ds_read_b64_tr_b16 v[174:175], v228 offset:27904
    s_waitcnt lgkmcnt(6)
    v_mfma_f32_32x32x16_bf16 v[144:159], v[160:163], v[96:99], v[144:159]
    s_waitcnt lgkmcnt(4)
    v_mfma_f32_32x32x16_bf16 v[144:159], v[164:167], v[100:103], v[144:159]
    s_waitcnt lgkmcnt(2)
    v_mfma_f32_32x32x16_bf16 v[144:159], v[168:171], v[104:107], v[144:159]
    s_waitcnt lgkmcnt(0)
    v_mfma_f32_32x32x16_bf16 v[144:159], v[172:175], v[108:111], v[144:159]
    s_mov_b32 s61, 0x3e8b97f6
    s_nop 10
    v_mul_f32 v144, s61, v144
    v_mul_f32 v145, s61, v145
    v_cvt_pk_bf16_f32 v208, v144, v145
    v_mul_f32 v146, s61, v146
    v_mul_f32 v147, s61, v147
    v_cvt_pk_bf16_f32 v209, v146, v147
    buffer_store_dwordx2 v[208:209], v224, s[36:39], s81 offen
    v_mul_f32 v148, s61, v148
    v_mul_f32 v149, s61, v149
    v_cvt_pk_bf16_f32 v210, v148, v149
    v_mul_f32 v150, s61, v150
    v_mul_f32 v151, s61, v151
    v_cvt_pk_bf16_f32 v211, v150, v151
    buffer_store_dwordx2 v[210:211], v225, s[36:39], s81 offen
    v_mul_f32 v152, s61, v152
    v_mul_f32 v153, s61, v153
    v_cvt_pk_bf16_f32 v212, v152, v153
    v_mul_f32 v154, s61, v154
    v_mul_f32 v155, s61, v155
    v_cvt_pk_bf16_f32 v213, v154, v155
    buffer_store_dwordx2 v[212:213], v226, s[36:39], s81 offen
    v_mul_f32 v156, s61, v156
    v_mul_f32 v157, s61, v157
    v_cvt_pk_bf16_f32 v214, v156, v157
    v_mul_f32 v158, s61, v158
    v_mul_f32 v159, s61, v159
    v_cvt_pk_bf16_f32 v215, v158, v159
    buffer_store_dwordx2 v[214:215], v227, s[36:39], s81 offen
    s_waitcnt vmcnt(0)
    s_mov_b64 exec, 1
    s_cmp_eq_u32 s7, 0
    s_cbranch_scc1 L_fs7
    buffer_store_dword v245, off, s[36:39], s84
L_fj8:
    s_mov_b64 exec, -1
    s_branch L_kvE
L_kvV:
L_sb3:
    s_cbranch_execz L_sb7
    s_waitcnt vmcnt(9)
    s_waitcnt lgkmcnt(8)
    v_mfma_f32_32x32x16_bf16 v[112:127], v[0:3], v[160:163], 0
    buffer_load_dwordx4 v[40:43], v254, s[32:35], s82 offen offset:2048 sc1
    ds_read_b64_tr_b16 v[184:185], v253 offset:6144
    v_mfma_f32_32x32x16_bf16 v[128:143], v[0:3], v[164:167], 0
    ds_read_b64_tr_b16 v[186:187], v253 offset:6656
    ds_read_b64_tr_b16 v[188:189], v252 offset:6144
    ds_read_b64_tr_b16 v[190:191], v252 offset:6656
    s_waitcnt vmcnt(9)
    s_waitcnt lgkmcnt(8)
    v_mfma_f32_32x32x16_bf16 v[112:127], v[4:7], v[168:171], v[112:127]
    buffer_load_dwordx4 v[44:47], v254, s[32:35], s82 offen offset:3072 sc1
    ds_read_b64_tr_b16 v[160:161], v253 offset:8192
    v_mfma_f32_32x32x16_bf16 v[128:143], v[4:7], v[172:175], v[128:143]
    ds_read_b64_tr_b16 v[162:163], v253 offset:8704
    ds_read_b64_tr_b16 v[164:165], v252 offset:8192
    ds_read_b64_tr_b16 v[166:167], v252 offset:8704
    s_waitcnt vmcnt(9)
    s_waitcnt lgkmcnt(8)
    v_mfma_f32_32x32x16_bf16 v[112:127], v[8:11], v[176:179], v[112:127]
    s_add_u32 s82, s82, 4096
    buffer_load_dwordx4 v[48:51], v254, s[32:35], s82 offen offset:0 sc1
    ds_read_b64_tr_b16 v[168:169], v253 offset:10240
    v_mfma_f32_32x32x16_bf16 v[128:143], v[8:11], v[180:183], v[128:143]
    ds_read_b64_tr_b16 v[170:171], v253 offset:10752
    ds_read_b64_tr_b16 v[172:173], v252 offset:10240
    ds_read_b64_tr_b16 v[174:175], v252 offset:10752
    s_waitcnt vmcnt(9)
    s_waitcnt lgkmcnt(8)
    v_mfma_f32_32x32x16_bf16 v[112:127], v[12:15], v[184:187], v[112:127]
    buffer_load_dwordx4 v[52:55], v254, s[32:35], s82 offen offset:1024 sc1
    ds_read_b64_tr_b16 v[176:177], v253 offset:12288
    v_mfma_f32_32x32x16_bf16 v[128:143], v[12:15], v[188:191], v[128:143]
    ds_read_b64_tr_b16 v[178:179], v253 offset:12800
    ds_read_b64_tr_b16 v[180:181], v252 offset:12288
    ds_read_b64_tr_b16 v[182:183], v252 offset:12800
    s_waitcnt vmcnt(9)
    s_waitcnt lgkmcnt(8)
    v_mfma_f32_32x32x16_bf16 v[112:127], v[16:19], v[160:163], v[112:127]
    buffer_load_dwordx4 v[56:59], v254, s[32:35], s82 offen offset:2048 sc1
    ds_read_b64_tr_b16 v[184:185], v253 offset:14336
    v_mfma_f32_32x32x16_bf16 v[128:143], v[16:19], v[164:167], v[128:143]
    ds_read_b64_tr_b16 v[186:187], v253 offset:14848
    ds_read_b64_tr_b16 v[188:189], v252 offset:14336
    ds_read_b64_tr_b16 v[190:191], v252 offset:14848
    s_waitcnt vmcnt(9)
    s_waitcnt lgkmcnt(8)
    v_mfma_f32_32x32x16_bf16 v[112:127], v[20:23], v[168:171], v[112:127]
    buffer_load_dwordx4 v[60:63], v254, s[32:35], s82 offen offset:3072 sc1
    ds_read_b64_tr_b16 v[160:161], v253 offset:16384
    v_mfma_f32_32x32x16_bf16 v[128:143], v[20:23], v[172:175], v[128:143]
L_sb4:
    s_cbranch_execz L_sb8
    ds_read_b64_tr_b16 v[162:163], v253 offset:16896
    ds_read_b64_tr_b16 v[164:165], v252 offset:16384
    ds_read_b64_tr_b16 v[166:167], v252 offset:16896
    s_waitcnt vmcnt(9)
    s_waitcnt lgkmcnt(8)
    v_mfma_f32_32x32x16_bf16 v[112:127], v[24:27], v[176:179], v[112:127]
    s_add_u32 s82, s82, 4096
    buffer_load_dwordx4 v[64:67], v254, s[32:35], s82 offen offset:0 sc1
    ds_read_b64_tr_b16 v[168:169], v253 offset:18432
    v_mfma_f32_32x32x16_bf16 v[128:143], v[24:27], v[180:183], v[128:143]
    ds_read_b64_tr_b16 v[170:171], v253 offset:18944
    ds_read_b64_tr_b16 v[172:173], v252 offset:18432
    ds_read_b64_tr_b16 v[174:175], v252 offset:18944
    s_waitcnt vmcnt(9)
    s_waitcnt lgkmcnt(8)
    v_mfma_f32_32x32x16_bf16 v[112:127], v[28:31], v[184:187], v[112:127]
    buffer_load_dwordx4 v[68:71], v254, s[32:35], s82 offen offset:1024 sc1
    ds_read_b64_tr_b16 v[176:177], v253 offset:20480
    v_mfma_f32_32x32x16_bf16 v[128:143], v[28:31], v[188:191], v[128:143]
    ds_read_b64_tr_b16 v[178:179], v253 offset:20992
    ds_read_b64_tr_b16 v[180:181], v252 offset:20480
    ds_read_b64_tr_b16 v[182:183], v252 offset:20992
    s_waitcnt vmcnt(9)
    s_waitcnt lgkmcnt(8)
    v_mfma_f32_32x32x16_bf16 v[112:127], v[32:35], v[160:163], v[112:127]
    buffer_load_dwordx4 v[72:75], v254, s[32:35], s82 offen offset:2048 sc1
    ds_read_b64_tr_b16 v[184:185], v253 offset:22528
    v_mfma_f32_32x32x16_bf16 v[128:143], v[32:35], v[164:167], v[128:143]
    ds_read_b64_tr_b16 v[186:187], v253 offset:23040
    ds_read_b64_tr_b16 v[188:189], v252 offset:22528
    ds_read_b64_tr_b16 v[190:191], v252 offset:23040
    s_waitcnt vmcnt(9)
    s_waitcnt lgkmcnt(8)
    v_mfma_f32_32x32x16_bf16 v[112:127], v[36:39], v[168:171], v[112:127]
    buffer_load_dwordx4 v[76:79], v254, s[32:35], s82 offen offset:3072 sc1
    ds_read_b64_tr_b16 v[160:161], v253 offset:24576
    v_mfma_f32_32x32x16_bf16 v[128:143], v[36:39], v[172:175], v[128:143]
    ds_read_b64_tr_b16 v[162:163], v253 offset:25088
    ds_read_b64_tr_b16 v[164:165], v252 offset:24576
    ds_read_b64_tr_b16 v[166:167], v252 offset:25088
    s_waitcnt vmcnt(9)
    s_waitcnt lgkmcnt(8)
    v_mfma_f32_32x32x16_bf16 v[112:127], v[40:43], v[176:179], v[112:127]
    s_add_u32 s82, s82, 4096
    buffer_load_dwordx4 v[80:83], v254, s[32:35], s82 offen offset:0 sc1
    ds_read_b64_tr_b16 v[168:169], v253 offset:26624
    v_mfma_f32_32x32x16_bf16 v[128:143], v[40:43], v[180:183], v[128:143]
    ds_read_b64_tr_b16 v[170:171], v253 offset:27136
    ds_read_b64_tr_b16 v[172:173], v252 offset:26624
    ds_read_b64_tr_b16 v[174:175], v252 offset:27136
    s_waitcnt vmcnt(9)
    s_waitcnt lgkmcnt(8)
    v_mfma_f32_32x32x16_bf16 v[112:127], v[44:47], v[184:187], v[112:127]
    buffer_load_dwordx4 v[84:87], v254, s[32:35], s82 offen offset:1024 sc1
    ds_read_b64_tr_b16 v[176:177], v253 offset:28672
    v_mfma_f32_32x32x16_bf16 v[128:143], v[44:47], v[188:191], v[128:143]
    ds_read_b64_tr_b16 v[178:179], v253 offset:29184
    ds_read_b64_tr_b16 v[180:181], v252 offset:28672
    ds_read_b64_tr_b16 v[182:183], v252 offset:29184
    s_waitcnt vmcnt(9)
    s_waitcnt lgkmcnt(8)
    v_mfma_f32_32x32x16_bf16 v[112:127], v[48:51], v[160:163], v[112:127]
    buffer_load_dwordx4 v[88:91], v254, s[32:35], s82 offen offset:2048 sc1
    ds_read_b64_tr_b16 v[184:185], v253 offset:30720
    v_mfma_f32_32x32x16_bf16 v[128:143], v[48:51], v[164:167], v[128:143]
    ds_read_b64_tr_b16 v[186:187], v253 offset:31232
    ds_read_b64_tr_b16 v[188:189], v252 offset:30720
    ds_read_b64_tr_b16 v[190:191], v252 offset:31232
    s_waitcnt vmcnt(9)
    s_waitcnt lgkmcnt(8)
    v_mfma_f32_32x32x16_bf16 v[112:127], v[52:55], v[168:171], v[112:127]
    buffer_load_dwordx4 v[92:95], v254, s[32:35], s82 offen offset:3072 sc1
    ds_read_b64_tr_b16 v[160:161], v253 offset:32768
    v_mfma_f32_32x32x16_bf16 v[128:143], v[52:55], v[172:175], v[128:143]
    ds_read_b64_tr_b16 v[162:163], v253 offset:33280
    ds_read_b64_tr_b16 v[164:165], v252 offset:32768
    ds_read_b64_tr_b16 v[166:167], v252 offset:33280
    s_waitcnt vmcnt(9)
    s_waitcnt lgkmcnt(8)
    v_mfma_f32_32x32x16_bf16 v[112:127], v[56:59], v[176:179], v[112:127]
    s_add_u32 s82, s82, 4096
    buffer_load_dwordx4 v[96:99], v254, s[32:35], s82 offen offset:0 sc1
    ds_read_b64_tr_b16 v[168:169], v253 offset:34816
    v_mfma_f32_32x32x16_bf16 v[128:143], v[56:59], v[180:183], v[128:143]
    ds_read_b64_tr_b16 v[170:171], v253 offset:35328
    ds_read_b64_tr_b16 v[172:173], v252 offset:34816
    ds_read_b64_tr_b16 v[174:175], v252 offset:35328
    s_waitcnt vmcnt(9)
    s_waitcnt lgkmcnt(8)
    v_mfma_f32_32x32x16_bf16 v[112:127], v[60:63], v[184:187], v[112:127]
    buffer_load_dwordx4 v[100:103], v254, s[32:35], s82 offen offset:1024 sc1
    ds_read_b64_tr_b16 v[176:177], v253 offset:36864
    v_mfma_f32_32x32x16_bf16 v[128:143], v[60:63], v[188:191], v[128:143]
    ds_read_b64_tr_b16 v[178:179], v253 offset:37376
    ds_read_b64_tr_b16 v[180:181], v252 offset:36864
    ds_read_b64_tr_b16 v[182:183], v252 offset:37376
    s_waitcnt vmcnt(9)
    s_waitcnt lgkmcnt(8)
    v_mfma_f32_32x32x16_bf16 v[112:127], v[64:67], v[160:163], v[112:127]
    buffer_load_dwordx4 v[104:107], v254, s[32:35], s82 offen offset:2048 sc1
    ds_read_b64_tr_b16 v[184:185], v253 offset:38912
    v_mfma_f32_32x32x16_bf16 v[128:143], v[64:67], v[164:167], v[128:143]
    ds_read_b64_tr_b16 v[186:187], v253 offset:39424
    ds_read_b64_tr_b16 v[188:189], v252 offset:38912
    ds_read_b64_tr_b16 v[190:191], v252 offset:39424
    s_waitcnt vmcnt(9)
    s_waitcnt lgkmcnt(8)
    v_mfma_f32_32x32x16_bf16 v[112:127], v[68:71], v[168:171], v[112:127]
    buffer_load_dwordx4 v[108:111], v254, s[32:35], s82 offen offset:3072 sc1
    ds_read_b64_tr_b16 v[160:161], v253 offset:40960
    v_mfma_f32_32x32x16_bf16 v[128:143], v[68:71], v[172:175], v[128:143]
    ds_read_b64_tr_b16 v[162:163], v253 offset:41472
    ds_read_b64_tr_b16 v[164:165], v252 offset:40960
    ds_read_b64_tr_b16 v[166:167], v252 offset:41472
    s_waitcnt vmcnt(9)
    s_waitcnt lgkmcnt(8)
    v_mfma_f32_32x32x16_bf16 v[112:127], v[72:75], v[176:179], v[112:127]
    s_lshl_b32 s65, s69, 6
    v_and_b32 v239, 7, v255
    v_lshl_add_u32 v239, v239, 3, s65
    global_load_dwordx2 a[246:247], v239, s[42:43]
    ds_read_b64_tr_b16 v[168:169], v253 offset:43008
    v_mfma_f32_32x32x16_bf16 v[128:143], v[72:75], v[180:183], v[128:143]
    ds_read_b64_tr_b16 v[170:171], v253 offset:43520
    ds_read_b64_tr_b16 v[172:173], v252 offset:43008
    ds_read_b64_tr_b16 v[174:175], v252 offset:43520
    s_waitcnt vmcnt(9)
    s_waitcnt lgkmcnt(8)
    v_mfma_f32_32x32x16_bf16 v[112:127], v[76:79], v[184:187], v[112:127]
    v_accvgpr_read_b32 v240, a233
    s_and_b32 s65, s54, 0xfe
    s_lshl_b32 s65, s65, 1
    s_add_u32 s65, s65, s3
    s_mul_i32 s65, s65, 14336
    s_add_u32 s65, s65, s59
    s_lshl_b32 s66, s3, 11
    s_add_u32 m0, s66, 81920
    s_nop 0
    buffer_load_dwordx4 v240, s[8:11], s65 offen lds
    ds_read_b64_tr_b16 v[176:177], v253 offset:45056
    v_mfma_f32_32x32x16_bf16 v[128:143], v[76:79], v[188:191], v[128:143]
    ds_read_b64_tr_b16 v[178:179], v253 offset:45568
    ds_read_b64_tr_b16 v[180:181], v252 offset:45056
    ds_read_b64_tr_b16 v[182:183], v252 offset:45568
    s_waitcnt vmcnt(9)
    s_waitcnt lgkmcnt(8)
    v_mfma_f32_32x32x16_bf16 v[112:127], v[80:83], v[160:163], v[112:127]
    s_add_u32 s65, s65, 6144
    buffer_load_dwordx4 v240, s[8:11], s65 offen offset:1024 lds
    ds_read_b64_tr_b16 v[184:185], v253 offset:47104
    v_mfma_f32_32x32x16_bf16 v[128:143], v[80:83], v[164:167], v[128:143]
    ds_read_b64_tr_b16 v[186:187], v253 offset:47616
    ds_read_b64_tr_b16 v[188:189], v252 offset:47104
    ds_read_b64_tr_b16 v[190:191], v252 offset:47616
    s_waitcnt vmcnt(9)
    s_waitcnt lgkmcnt(8)
    v_mfma_f32_32x32x16_bf16 v[112:127], v[84:87], v[168:171], v[112:127]
    s_add_u32 m0, m0, 8192
    s_add_u32 s65, s65, 108544
    buffer_load_dwordx4 v240, s[8:11], s65 offen lds
    ds_read_b64_tr_b16 v[160:161], v253 offset:49152
    v_mfma_f32_32x32x16_bf16 v[128:143], v[84:87], v[172:175], v[128:143]
    ds_read_b64_tr_b16 v[162:163], v253 offset:49664
    ds_read_b64_tr_b16 v[164:165], v252 offset:49152
    ds_read_b64_tr_b16 v[166:167], v252 offset:49664
    s_waitcnt vmcnt(9)
    s_waitcnt lgkmcnt(8)
    v_mfma_f32_32x32x16_bf16 v[112:127], v[88:91], v[176:179], v[112:127]
    s_add_u32 s65, s65, 6144
    buffer_load_dwordx4 v240, s[8:11], s65 offen offset:1024 lds
    ds_read_b64_tr_b16 v[168:169], v253 offset:51200
    v_mfma_f32_32x32x16_bf16 v[128:143], v[88:91], v[180:183], v[128:143]
    ds_read_b64_tr_b16 v[170:171], v253 offset:51712
    ds_read_b64_tr_b16 v[172:173], v252 offset:51200
    ds_read_b64_tr_b16 v[174:175], v252 offset:51712
    s_waitcnt vmcnt(9)
    s_waitcnt lgkmcnt(8)
    v_mfma_f32_32x32x16_bf16 v[112:127], v[92:95], v[184:187], v[112:127]
    v_and_b32 v239, 15, v255
    v_lshlrev_b32 v239, 7, v239
    buffer_load_dword v238, v239, s[36:39], s90 offen sc1
    ds_read_b64_tr_b16 v[176:177], v253 offset:53248
    v_mfma_f32_32x32x16_bf16 v[128:143], v[92:95], v[188:191], v[128:143]
    ds_read_b64_tr_b16 v[178:179], v253 offset:53760
    ds_read_b64_tr_b16 v[180:181], v252 offset:53248
    ds_read_b64_tr_b16 v[182:183], v252 offset:53760
    s_waitcnt vmcnt(9)
    s_waitcnt lgkmcnt(8)
    v_mfma_f32_32x32x16_bf16 v[112:127], v[96:99], v[160:163], v[112:127]
    ds_read_b64_tr_b16 v[184:185], v253 offset:55296
    v_mfma_f32_32x32x16_bf16 v[128:143], v[96:99], v[164:167], v[128:143]
    ds_read_b64_tr_b16 v[186:187], v253 offset:55808
    ds_read_b64_tr_b16 v[188:189], v252 offset:55296
    ds_read_b64_tr_b16 v[190:191], v252 offset:55808
    s_waitcnt vmcnt(8)
    s_waitcnt lgkmcnt(8)
    v_mfma_f32_32x32x16_bf16 v[112:127], v[100:103], v[168:171], v[112:127]
    v_mfma_f32_32x32x16_bf16 v[128:143], v[100:103], v[172:175], v[128:143]
    s_waitcnt vmcnt(7)
    s_waitcnt lgkmcnt(4)
    s_barrier
    v_mfma_f32_32x32x16_bf16 v[112:127], v[104:107], v[176:179], v[112:127]
    ds_read_b64_tr_b16 v[160:161], v228 offset:0
    v_mfma_f32_32x32x16_bf16 v[128:143], v[104:107], v[180:183], v[128:143]
    ds_read_b64_tr_b16 v[162:163], v228 offset:256
    ds_read_b64_tr_b16 v[164:165], v228 offset:1024
    ds_read_b64_tr_b16 v[166:167], v228 offset:1280
    s_waitcnt vmcnt(6)
    s_waitcnt lgkmcnt(4)
    v_mfma_f32_32x32x16_bf16 v[112:127], v[108:111], v[184:187], v[112:127]
    ds_read_b64_tr_b16 v[168:169], v228 offset:2048
    v_mfma_f32_32x32x16_bf16 v[128:143], v[108:111], v[188:191], v[128:143]
    ds_read_b64_tr_b16 v[170:171], v228 offset:2304
    ds_read_b64_tr_b16 v[172:173], v228 offset:3072
    ds_read_b64_tr_b16 v[174:175], v228 offset:3328
    s_waitcnt lgkmcnt(6)
    v_mfma_f32_32x32x16_bf16 v[144:159], v[160:163], v[0:3], 0
    ds_read_b64_tr_b16 v[176:177], v228 offset:4096
    ds_read_b64_tr_b16 v[178:179], v228 offset:4352
    s_waitcnt lgkmcnt(6)
    v_mfma_f32_32x32x16_bf16 v[144:159], v[164:167], v[4:7], v[144:159]
    ds_read_b64_tr_b16 v[180:181], v228 offset:5120
    ds_read_b64_tr_b16 v[182:183], v228 offset:5376
    v_cvt_pk_bf16_f32 v192, v112, v113
    v_cvt_pk_bf16_f32 v193, v114, v115
    v_cvt_pk_bf16_f32 v194, v116, v117
    v_cvt_pk_bf16_f32 v195, v118, v119
    buffer_store_dwordx4 v[192:195], v216, s[36:39], s80 offen offset:0 sc1
    v_cvt_pk_bf16_f32 v196, v120, v121
    s_waitcnt lgkmcnt(6)
    v_mfma_f32_32x32x16_bf16 v[144:159], v[168:171], v[8:11], v[144:159]
    ds_read_b64_tr_b16 v[184:185], v228 offset:6144
    ds_read_b64_tr_b16 v[186:187], v228 offset:6400
    v_cvt_pk_bf16_f32 v197, v122, v123
    v_cvt_pk_bf16_f32 v198, v124, v125
    v_cvt_pk_bf16_f32 v199, v126, v127
    buffer_store_dwordx4 v[196:199], v216, s[36:39], s80 offen offset:896 sc1
    v_cvt_pk_bf16_f32 v200, v128, v129
    v_cvt_pk_bf16_f32 v201, v130, v131
    s_waitcnt lgkmcnt(6)
    v_mfma_f32_32x32x16_bf16 v[144:159], v[172:175], v[12:15], v[144:159]
    ds_read_b64_tr_b16 v[188:189], v228 offset:7168
    ds_read_b64_tr_b16 v[190:191], v228 offset:7424
    v_cvt_pk_bf16_f32 v202, v132, v133
    v_cvt_pk_bf16_f32 v203, v134, v135
    buffer_store_dwordx4 v[200:203], v217, s[36:39], s80 offen offset:0 sc1
    v_cvt_pk_bf16_f32 v204, v136, v137
    v_cvt_pk_bf16_f32 v205, v138, v139
    v_cvt_pk_bf16_f32 v206, v140, v141
    s_waitcnt lgkmcnt(6)
    v_mfma_f32_32x32x16_bf16 v[144:159], v[176:179], v[16:19], v[144:159]
    ds_read_b64_tr_b16 v[160:161], v228 offset:8192
    ds_read_b64_tr_b16 v[162:163], v228 offset:8448
    v_cvt_pk_bf16_f32 v207, v142, v143
    buffer_store_dwordx4 v[204:207], v217, s[36:39], s80 offen offset:896 sc1
    s_waitcnt lgkmcnt(6)
    v_mfma_f32_32x32x16_bf16 v[144:159], v[180:183], v[20:23], v[144:159]
    ds_read_b64_tr_b16 v[164:165], v228 offset:9216
    ds_read_b64_tr_b16 v[166:167], v228 offset:9472
    s_waitcnt lgkmcnt(6)
    v_mfma_f32_32x32x16_bf16 v[144:159], v[184:187], v[24:27], v[144:159]
    ds_read_b64_tr_b16 v[168:169], v228 offset:10240
    ds_read_b64_tr_b16 v[170:171], v228 offset:10496
    s_waitcnt lgkmcnt(6)
    v_mfma_f32_32x32x16_bf16 v[144:159], v[188:191], v[28:31], v[144:159]
    ds_read_b64_tr_b16 v[172:173], v228 offset:11264
    ds_read_b64_tr_b16 v[174:175], v228 offset:11520
    s_waitcnt lgkmcnt(6)
    v_mfma_f32_32x32x16_bf16 v[144:159], v[160:163], v[32:35], v[144:159]
    ds_read_b64_tr_b16 v[176:177], v228 offset:12288
    ds_read_b64_tr_b16 v[178:179], v228 offset:12544
    s_barrier
    s_waitcnt lgkmcnt(6)
    v_mfma_f32_32x32x16_bf16 v[144:159], v[164:167], v[36:39], v[144:159]
    ds_read_b64_tr_b16 v[180:181], v228 offset:13312
    ds_read_b64_tr_b16 v[182:183], v228 offset:13568
    s_waitcnt lgkmcnt(6)
    v_mfma_f32_32x32x16_bf16 v[144:159], v[168:171], v[40:43], v[144:159]
    ds_read_b64_tr_b16 v[184:185], v228 offset:14336
    ds_read_b64_tr_b16 v[186:187], v228 offset:14592
    s_waitcnt lgkmcnt(6)
    v_mfma_f32_32x32x16_bf16 v[144:159], v[172:175], v[44:47], v[144:159]
    ds_read_b64_tr_b16 v[188:189], v228 offset:15360
    ds_read_b64_tr_b16 v[190:191], v228 offset:15616
    s_waitcnt lgkmcnt(6)
    v_mfma_f32_32x32x16_bf16 v[144:159], v[176:179], v[48:51], v[144:159]
    ds_read_b64_tr_b16 v[160:161], v228 offset:16384
    ds_read_b64_tr_b16 v[162:163], v228 offset:16640
    s_waitcnt lgkmcnt(6)
    v_mfma_f32_32x32x16_bf16 v[144:159], v[180:183], v[52:55], v[144:159]
    ds_read_b64_tr_b16 v[164:165], v228 offset:17408
    ds_read_b64_tr_b16 v[166:167], v228 offset:17664
    s_waitcnt lgkmcnt(6)
    v_mfma_f32_32x32x16_bf16 v[144:159], v[184:187], v[56:59], v[144:159]
    ds_read_b64_tr_b16 v[168:169], v228 offset:18432
    ds_read_b64_tr_b16 v[170:171], v228 offset:18688
    s_waitcnt lgkmcnt(6)
    v_mfma_f32_32x32x16_bf16 v[144:159], v[188:191], v[60:63], v[144:159]
    ds_read_b64_tr_b16 v[172:173], v228 offset:19456
    ds_read_b64_tr_b16 v[174:175], v228 offset:19712
    s_waitcnt lgkmcnt(6)
    v_mfma_f32_32x32x16_bf16 v[144:159], v[160:163], v[64:67], v[144:159]
    ds_read_b64_tr_b16 v[176:177], v228 offset:20480
    ds_read_b64_tr_b16 v[178:179], v228 offset:20736
    s_waitcnt lgkmcnt(6)
    v_mfma_f32_32x32x16_bf16 v[144:159], v[164:167], v[68:71], v[144:159]
    ds_read_b64_tr_b16 v[180:181], v228 offset:21504
    ds_read_b64_tr_b16 v[182:183], v228 offset:21760
    s_waitcnt lgkmcnt(6)
    v_mfma_f32_32x32x16_bf16 v[144:159], v[168:171], v[72:75], v[144:159]
    ds_read_b64_tr_b16 v[184:185], v228 offset:22528
    ds_read_b64_tr_b16 v[186:187], v228 offset:22784
    s_waitcnt lgkmcnt(6)
    v_mfma_f32_32x32x16_bf16 v[144:159], v[172:175], v[76:79], v[144:159]
    ds_read_b64_tr_b16 v[188:189], v228 offset:23552
    ds_read_b64_tr_b16 v[190:191], v228 offset:23808
    s_waitcnt lgkmcnt(6)
    v_mfma_f32_32x32x16_bf16 v[144:159], v[176:179], v[80:83], v[144:159]
    ds_read_b64_tr_b16 v[160:161], v228 offset:24576
    ds_read_b64_tr_b16 v[162:163], v228 offset:24832
    s_waitcnt lgkmcnt(6)
    v_mfma_f32_32x32x16_bf16 v[144:159], v[180:183], v[84:87], v[144:159]
    ds_read_b64_tr_b16 v[164:165], v228 offset:25600
    ds_read_b64_tr_b16 v[166:167], v228 offset:25856
    s_waitcnt lgkmcnt(6)
    v_mfma_f32_32x32x16_bf16 v[144:159], v[184:187], v[88:91], v[144:159]
    ds_read_b64_tr_b16 v[168:169], v228 offset:26624
    ds_read_b64_tr_b16 v[170:171], v228 offset:26880
    s_waitcnt vmcnt(0)
    s_mov_b64 exec, 1
    buffer_store_dword v245, off, s[36:39], s83 sc1
    s_mov_b64 exec, -1
    s_waitcnt lgkmcnt(6)
    v_mfma_f32_32x32x16_bf16 v[144:159], v[188:191], v[92:95], v[144:159]
    ds_read_b64_tr_b16 v[172:173], v228 offset:27648
    ds_read_b64_tr_b16 v[174:175], v228 offset:27904
    s_waitcnt lgkmcnt(6)
    v_mfma_f32_32x32x16_bf16 v[144:159], v[160:163], v[96:99], v[144:159]
    s_waitcnt lgkmcnt(4)
    v_mfma_f32_32x32x16_bf16 v[144:159], v[164:167], v[100:103], v[144:159]
    s_waitcnt lgkmcnt(2)
    v_mfma_f32_32x32x16_bf16 v[144:159], v[168:171], v[104:107], v[144:159]
    s_waitcnt lgkmcnt(0)
    v_mfma_f32_32x32x16_bf16 v[144:159], v[172:175], v[108:111], v[144:159]
    s_mov_b32 s61, 0x3e8b97f6
    s_nop 10
    v_mul_f32 v144, s61, v144
    v_mul_f32 v145, s61, v145
    v_cvt_pk_bf16_f32 v208, v144, v145
    v_mul_f32 v146, s61, v146
    v_mul_f32 v147, s61, v147
    v_cvt_pk_bf16_f32 v209, v146, v147
    buffer_store_dwordx2 v[208:209], v224, s[36:39], s81 offen
    v_mul_f32 v148, s61, v148
    v_mul_f32 v149, s61, v149
    v_cvt_pk_bf16_f32 v210, v148, v149
    v_mul_f32 v150, s61, v150
    v_mul_f32 v151, s61, v151
    v_cvt_pk_bf16_f32 v211, v150, v151
    buffer_store_dwordx2 v[210:211], v225, s[36:39], s81 offen
    v_mul_f32 v152, s61, v152
    v_mul_f32 v153, s61, v153
    v_cvt_pk_bf16_f32 v212, v152, v153
    v_mul_f32 v154, s61, v154
    v_mul_f32 v155, s61, v155
    v_cvt_pk_bf16_f32 v213, v154, v155
    buffer_store_dwordx2 v[212:213], v226, s[36:39], s81 offen
    v_mul_f32 v156, s61, v156
    v_mul_f32 v157, s61, v157
    v_cvt_pk_bf16_f32 v214, v156, v157
    v_mul_f32 v158, s61, v158
    v_mul_f32 v159, s61, v159
    v_cvt_pk_bf16_f32 v215, v158, v159
    buffer_store_dwordx2 v[214:215], v227, s[36:39], s81 offen
    s_waitcnt vmcnt(0)
    s_mov_b64 exec, 1
    s_cmp_eq_u32 s7, 0
    s_cbranch_scc1 L_fs9
    buffer_store_dword v245, off, s[36:39], s84
L_fj10:
    s_mov_b64 exec, -1
L_kvE:
L_sb5:
    s_cbranch_execz L_sb9
    s_cmp_eq_u32 s68, 2
    s_cbranch_scc1 L_p42
    s_branch L_att
L_p42:
L_sb6:
    s_cbranch_execz L_wza
    s_branch L_att
L_help:
L_sb7:
    s_cbranch_execz L_wza
    s_waitcnt vmcnt(0)
    s_mov_b64 exec, 1
    s_cmp_eq_u32 s7, 0
    s_cbranch_scc1 L_fs11
    buffer_store_dword v245, off, s[36:39], s46
L_fj12:
    s_mov_b64 exec, -1
    s_lshl_b32 s85, s58, 2
    s_add_u32 s85, s85, s3
    s_mul_i32 s61, s85, 896
    s_add_u32 s61, s61, 655360
    v_min_u32 v11, 6, v255
    v_lshlrev_b32 v11, 7, v11
    buffer_load_dword v238, v11, s[36:39], s61 offen sc1
    v_lshrrev_b32 v239, 3, v255
    v_and_b32 v240, 7, v255
    v_bfe_u32 v241, v255, 4, 2
    v_lshlrev_b32 v241, 1, v241
    v_xor_b32 v240, v240, v241
    v_mul_u32_u24 v239, 5376, v239
    v_lshl_add_u32 v4, v240, 4, v239
    v_add_u32 v5, 41984, v4
    v_add_u32 v6, 83968, v4
    v_add_u32 v7, 125952, v4
    s_add_u32 s62, s58, 14
    s_lshl_b32 s67, s62, 7
    s_mul_i32 s63, s3, 602112
    s_add_u32 s67, s67, s63
    s_cmp_eq_u32 s4, 7
    s_cselect_b32 s67, 1073741824, s67
    s_mul_i32 s63, s3, 14336
    s_add_u32 m0, s63, 57344
    s_nop 0
    buffer_load_dwordx4 v4, s[28:31], s67 offen offset:0 lds
    buffer_load_dwordx4 v5, s[28:31], s67 offen offset:1024 lds
    buffer_load_dwordx4 v6, s[28:31], s67 offen offset:2048 lds
    buffer_load_dwordx4 v7, s[28:31], s67 offen offset:3072 lds
    s_add_u32 m0, m0, 4096
    s_add_u32 s67, s67, 172032
    buffer_load_dwordx4 v4, s[28:31], s67 offen offset:0 lds
    buffer_load_dwordx4 v5, s[28:31], s67 offen offset:1024 lds
    buffer_load_dwordx4 v6, s[28:31], s67 offen offset:2048 lds
    buffer_load_dwordx4 v7, s[28:31], s67 offen offset:3072 lds
    s_lshl_b32 s61, s4, 1
    s_add_u32 s62, s61, s96
    s_lshl_b32 s49, s62, 2
    s_add_u32 s49, s49, s3
    s_and_b32 s50, s5, 15
    s_lshr_b32 s62, s5, 4
    s_add_u32 s51, s61, s62
    s_lshl_b32 s52, s51, 2
    s_add_u32 s52, s52, s3
    s_mul_i32 s61, s5, 37
    s_lshr_b32 s56, s61, 8
    s_mul_i32 s62, s56, 7
    s_sub_u32 s53, s5, s62
    s_lshl_b32 s59, s53, 7
    s_and_b32 s61, s3, 1
    s_lshr_b32 s55, s3, 1
    s_lshl_b32 s54, s4, 2
    s_and_b32 s56, s56, 1
    s_add_u32 s54, s54, s56
    s_lshl_b32 s54, s54, 1
    s_add_u32 s54, s54, s61
    s_lshl_b32 s78, s3, 12
    v_lshrrev_b32 v239, 3, v255
    v_and_b32 v240, 7, v255
    v_bfe_u32 v241, v255, 4, 1
    v_lshlrev_b32 v241, 2, v241
    v_xor_b32 v240, v240, v241
    v_mul_u32_u24 v239, 896, v239
    v_lshl_add_u32 v246, v240, 4, v239
    v_add_u32 v247, 6144, v246
    v_add_u32 v248, 12288, v246
    v_add_u32 v249, 18432, v246
    v_and_b32 v239, 3, v255
    v_lshlrev_b32 v239, 3, v239
    v_bfe_u32 v240, v255, 4, 1
    v_lshl_add_u32 v239, v240, 5, v239
    v_bfe_u32 v240, v255, 2, 2
    v_lshl_add_u32 v16, v240, 6, v239
    v_lshl_add_u32 v16, v244, 9, v16
    v_lshl_add_u32 v239, v240, 7, v239
    v_bfe_u32 v240, v255, 3, 1
    v_lshl_add_u32 v239, v240, 6, v239
    v_lshl_add_u32 v253, v244, 10, v239
    v_lshl_add_u32 v251, v244, 9, v239
    v_xor_b32 v252, 64, v253
    v_xor_b32 v250, 64, v251
    s_lshl_b32 s62, s55, 6
    v_xor_b32 v233, s62, v251
    v_xor_b32 v234, s62, v250
    s_mul_i32 s86, s3, 6144
    s_add_u32 s86, s86, 98304
    s_lshl_b32 s61, s50, 6
    s_lshl_b32 s62, s51, 2
    s_mul_i32 s63, s3, 3
    s_add_u32 s62, s62, s63
    s_sub_u32 s62, s62, 8
    s_add_u32 s63, s62, 0
    s_add_u32 s64, s63, s61
    s_mul_i32 s64, s64, 1792
    s_add_u32 s64, s64, 3145728
    s_cmp_lt_i32 s63, 0
    s_cselect_b32 s87, 1073741824, s64
    s_add_u32 s63, s62, 1
    s_add_u32 s64, s63, s61
    s_mul_i32 s64, s64, 1792
    s_add_u32 s64, s64, 3145728
    s_cmp_lt_i32 s63, 0
    s_cselect_b32 s88, 1073741824, s64
    s_add_u32 s63, s62, 2
    s_add_u32 s64, s63, s61
    s_mul_i32 s64, s64, 1792
    s_add_u32 s64, s64, 3145728
    s_cmp_lt_i32 s63, 0
    s_cselect_b32 s89, 1073741824, s64
    v_lshlrev_b32 v239, 9, v244
    v_lshl_add_u32 v239, v243, 3, v239
    v_accvgpr_write_b32 a224, v239
    s_lshl_b32 s61, s3, 11
    s_add_u32 s61, s61, 98304
    v_add_u32 v239, s61, v239
    v_accvgpr_write_b32 a225, v239
    v_mul_u32_u24 v239, 448, v244
    v_lshl_add_u32 v239, v243, 4, v239
    v_accvgpr_write_b32 a226, v239
    s_lshl_b32 s90, s52, 4
    s_add_u32 s90, s90, s50
    s_and_b32 s61, s90, 127
    s_lshl_b32 s61, s61, 2
    s_add_u32 s61, s61, s47
    s_add_u32 s91, s61, 1024
    s_lshl_b32 s90, s90, 11
    s_add_u32 s90, s90, 1048576
    v_min_u32 v239, 13, v255
    v_and_b32 v240, 1, v239
    v_mul_u32_u24 v240, 27, v240
    s_mul_i32 s61, s50, 28
    v_add_u32 v240, s61, v240
    v_lshrrev_b32 v241, 6, v240
    v_bfe_u32 v242, v239, 1, 1
    v_mad_u32_u24 v241, v242, 7, v241
    v_lshrrev_b32 v242, 2, v239
    v_add_u32 v242, s62, v242
    v_max_i32 v242, 0, v242
    v_mad_u32_u24 v241, v242, 14, v241
    v_lshlrev_b32 v241, 7, v241
    v_add_u32 v241, 655360, v241
    v_lshrrev_b32 v240, 5, v240
    s_and_b32 s61, s52, 7
    s_lshl_b32 s61, s61, 6
    s_add_u32 s61, s61, s47
    s_add_u32 s61, s61, 512
    v_lshl_add_u32 v240, v240, 2, s61
    v_cmp_gt_u32 vcc, 12, v239
    s_nop 1
    v_cndmask_b32 v239, v240, v241, vcc
    v_accvgpr_write_b32 a227, v239
    v_lshrrev_b32 v239, 3, v255
    v_and_b32 v240, 7, v255
    v_bfe_u32 v241, v255, 4, 1
    v_lshlrev_b32 v241, 2, v241
    v_xor_b32 v240, v240, v241
    v_mul_u32_u24 v239, 3584, v239
    v_lshl_add_u32 v120, v240, 4, v239
    v_add_u32 v121, 27648, v120
    v_add_u32 v122, 55296, v120
    v_add_u32 v123, 82944, v120
    v_accvgpr_write_b32 a228, v120
    v_accvgpr_write_b32 a229, v121
    v_accvgpr_write_b32 a230, v122
    v_accvgpr_write_b32 a231, v123
    s_mul_i32 s92, s3, 14336
    s_bfe_u32 s61, s48, 0x10001
    s_lshl_b32 s93, s48, 1
    s_add_u32 s93, s93, s61
    s_lshl_b32 s93, s93, 7
    s_xor_b32 s94, s93, 128
    s_mov_b32 s97, 0
    s_lshl_b32 s61, s53, 1
    s_add_u32 s69, s61, s55
    s_lshl_b32 s61, s69, 7
    s_add_u32 s45, s61, 458752
    v_and_b32 v239, 7, v255
    v_bfe_u32 v240, v255, 3, 2
    v_min_u32 v240, 2, v240
    v_min_u32 v241, 1, v240
    v_add_u32 v240, v240, v241
    v_mul_u32_u24 v240, 1792, v240
    v_lshl_add_u32 v240, v239, 4, v240
    v_accvgpr_write_b32 a232, v240
    v_and_b32 v239, 15, v255
    v_lshlrev_b32 v239, 7, v239
    buffer_load_dword v238, v239, s[36:39], s90 offen sc1
    s_add_u32 m0, m0, 4096
    s_add_u32 s67, s67, 172032
    buffer_load_dwordx4 v4, s[28:31], s67 offen offset:0 lds
    buffer_load_dwordx4 v5, s[28:31], s67 offen offset:1024 lds
    buffer_load_dwordx4 v6, s[28:31], s67 offen offset:2048 lds
    buffer_load_dwordx4 v7, s[28:31], s67 offen offset:3072 lds
    s_add_u32 m0, m0, 4096
    s_add_u32 s67, s67, 172032
    buffer_load_dwordx4 v4, s[28:31], s67 offen offset:0 lds
    buffer_load_dwordx4 v5, s[28:31], s67 offen offset:1024 lds
    s_mov_b32 s94, 1073741824
    s_mov_b32 s93, 1073741824
    s_mov_b32 s97, 57344
    s_cmp_eq_u32 s4, 7
    s_cbranch_scc1 L_hn
    v_lshrrev_b32 v239, 3, v255
    v_and_b32 v240, 7, v255
    v_bfe_u32 v241, v255, 4, 2
    v_lshlrev_b32 v241, 1, v241
    v_xor_b32 v240, v240, v241
    v_mul_u32_u24 v239, 3584, v239
    v_lshl_add_u32 v4, v240, 4, v239
    v_add_u32 v5, 27648, v4
    v_add_u32 v6, 55296, v4
    v_add_u32 v7, 82944, v4
    s_lshl_b32 s67, s58, 7
    s_mul_i32 s63, s3, 401408
    s_add_u32 s67, s67, s63
    s_mul_i32 m0, s3, 14336
    s_nop 0
    buffer_load_dwordx4 v4, s[20:23], s67 offen offset:0 lds
    buffer_load_dwordx4 v5, s[20:23], s67 offen offset:1024 lds
    buffer_load_dwordx4 v6, s[20:23], s67 offen offset:2048 lds
    buffer_load_dwordx4 v7, s[20:23], s67 offen offset:3072 lds
    s_add_u32 m0, m0, 4096
    s_add_u32 s67, s67, 114688
    buffer_load_dwordx4 v4, s[20:23], s67 offen offset:0 lds
    buffer_load_dwordx4 v5, s[20:23], s67 offen offset:1024 lds
    buffer_load_dwordx4 v6, s[20:23], s67 offen offset:2048 lds
    buffer_load_dwordx4 v7, s[20:23], s67 offen offset:3072 lds
    v_add_u32 v21, 158720, v22
    s_waitcnt vmcnt(8)
    s_barrier
    ds_read_b128 v[32:35], v21 offset:0
    ds_read_b64_tr_b16 v[36:37], v20 offset:0
    ds_read_b64_tr_b16 v[38:39], v20 offset:2048
    ds_read_b128 v[40:43], v21 offset:64
    ds_read_b64_tr_b16 v[44:45], v20 offset:4096
    ds_read_b64_tr_b16 v[46:47], v20 offset:6144
    ds_read_b128 v[48:51], v21 offset:128
L_sb8:
    s_cbranch_execz L_wza
    ds_read_b64_tr_b16 v[52:53], v20 offset:8192
    ds_read_b64_tr_b16 v[54:55], v20 offset:10240
    ds_read_b128 v[56:59], v21 offset:192
    ds_read_b64_tr_b16 v[60:61], v20 offset:12288
    ds_read_b64_tr_b16 v[62:63], v20 offset:14336
    s_waitcnt lgkmcnt(9)
    v_mfma_f32_16x16x32_bf16 v[24:27], v[32:35], v[36:39], 0
    ds_read_b128 v[64:67], v21 offset:256
    ds_read_b64_tr_b16 v[68:69], v20 offset:16384
    ds_read_b64_tr_b16 v[70:71], v20 offset:18432
    s_waitcnt lgkmcnt(9)
    v_mfma_f32_16x16x32_bf16 v[24:27], v[40:43], v[44:47], v[24:27]
    ds_read_b128 v[32:35], v21 offset:320
    ds_read_b64_tr_b16 v[36:37], v20 offset:20480
    ds_read_b64_tr_b16 v[38:39], v20 offset:22528
    s_waitcnt lgkmcnt(9)
    v_mfma_f32_16x16x32_bf16 v[24:27], v[48:51], v[52:55], v[24:27]
    ds_read_b128 v[40:43], v21 offset:384
    ds_read_b64_tr_b16 v[44:45], v20 offset:24576
    ds_read_b64_tr_b16 v[46:47], v20 offset:26624
    s_waitcnt lgkmcnt(9)
    v_mfma_f32_16x16x32_bf16 v[24:27], v[56:59], v[60:63], v[24:27]
    ds_read_b128 v[48:51], v21 offset:448
    ds_read_b64_tr_b16 v[52:53], v20 offset:28672
    ds_read_b64_tr_b16 v[54:55], v20 offset:30720
    s_waitcnt lgkmcnt(9)
    v_mfma_f32_16x16x32_bf16 v[24:27], v[64:67], v[68:71], v[24:27]
    ds_read_b128 v[56:59], v21 offset:512
    ds_read_b64_tr_b16 v[60:61], v20 offset:32768
    ds_read_b64_tr_b16 v[62:63], v20 offset:34816
    s_waitcnt lgkmcnt(9)
    v_mfma_f32_16x16x32_bf16 v[24:27], v[32:35], v[36:39], v[24:27]
    ds_read_b128 v[64:67], v21 offset:576
    ds_read_b64_tr_b16 v[68:69], v20 offset:36864
    ds_read_b64_tr_b16 v[70:71], v20 offset:38912
    s_waitcnt lgkmcnt(9)
    v_mfma_f32_16x16x32_bf16 v[24:27], v[40:43], v[44:47], v[24:27]
    ds_read_b128 v[32:35], v21 offset:640
    ds_read_b64_tr_b16 v[36:37], v20 offset:40960
    ds_read_b64_tr_b16 v[38:39], v20 offset:43008
    s_waitcnt lgkmcnt(9)
    v_mfma_f32_16x16x32_bf16 v[24:27], v[48:51], v[52:55], v[24:27]
    ds_read_b128 v[40:43], v21 offset:704
    ds_read_b64_tr_b16 v[44:45], v20 offset:45056
    ds_read_b64_tr_b16 v[46:47], v20 offset:47104
    s_waitcnt lgkmcnt(9)
    v_mfma_f32_16x16x32_bf16 v[24:27], v[56:59], v[60:63], v[24:27]
    ds_read_b128 v[48:51], v21 offset:768
    ds_read_b64_tr_b16 v[52:53], v20 offset:49152
    ds_read_b64_tr_b16 v[54:55], v20 offset:51200
    s_waitcnt lgkmcnt(9)
    v_mfma_f32_16x16x32_bf16 v[24:27], v[64:67], v[68:71], v[24:27]
    ds_read_b128 v[56:59], v21 offset:832
    ds_read_b64_tr_b16 v[60:61], v20 offset:53248
    ds_read_b64_tr_b16 v[62:63], v20 offset:55296
    s_waitcnt lgkmcnt(9)
    v_mfma_f32_16x16x32_bf16 v[24:27], v[32:35], v[36:39], v[24:27]
    s_waitcnt lgkmcnt(6)
    v_mfma_f32_16x16x32_bf16 v[24:27], v[40:43], v[44:47], v[24:27]
    s_waitcnt lgkmcnt(3)
    v_mfma_f32_16x16x32_bf16 v[24:27], v[48:51], v[52:55], v[24:27]
    s_waitcnt lgkmcnt(0)
    v_mfma_f32_16x16x32_bf16 v[24:27], v[56:59], v[60:63], v[24:27]
    s_sub_u32 s61, s58, 14
    s_cmp_lt_u32 s61, 7
    s_cselect_b32 s62, 1.0, 0
    s_lshl_b32 s61, s58, 8
    s_lshl_b32 s63, s3, 6
    s_add_u32 s61, s61, s63
    s_add_u32 s61, s61, 458752
    v_lshlrev_b32 v23, 2, v255
    v_cvt_pk_bf16_f32 v24, v24, v24
    v_and_b32 v24, 0xffff0000, v24
    v_add_f32 v24, s62, v24
    v_mov_b32 v29, s6
    s_nop 0
    v_mov_b32_dpp v25, v24 quad_perm:[1,0,3,2] row_mask:0xf bank_mask:0xf
    v_cvt_pk_bf16_f32 v28, v24, v25
    s_mov_b64 exec, 0x5555
    buffer_store_dwordx2 v[28:29], v23, s[36:39], s61 offen sc1
    s_mov_b64 exec, -1
    s_add_u32 m0, m0, 4096
    s_add_u32 s67, s67, 114688
    buffer_load_dwordx4 v4, s[20:23], s67 offen offset:0 lds
    buffer_load_dwordx4 v5, s[20:23], s67 offen offset:1024 lds
    buffer_load_dwordx4 v6, s[20:23], s67 offen offset:2048 lds
    buffer_load_dwordx4 v7, s[20:23], s67 offen offset:3072 lds
    s_add_u32 m0, m0, 4096
    s_add_u32 s67, s67, 114688
    buffer_load_dwordx4 v4, s[20:23], s67 offen offset:0 lds
    buffer_load_dwordx4 v5, s[20:23], s67 offen offset:1024 lds
    s_branch L_hn2
L_hn:
    s_waitcnt vmcnt(0)
L_hn2:
    s_barrier
    v_mov_b32 v121, 0
    v_lshl_add_u32 v122, v243, 3, s86
    s_mov_b32 exec_hi, 0
    s_cmp_eq_u32 s87, 1073741824
    s_cselect_b32 s64, 0xf149, 0
    v_mov_b32 v120, s64
    ds_write_b64 v122, v[120:121] offset:1792
    s_cmp_eq_u32 s88, 1073741824
    s_cselect_b32 s64, 0xf149, 0
    v_mov_b32 v120, s64
    ds_write_b64 v122, v[120:121] offset:3840
    s_cmp_eq_u32 s89, 1073741824
    s_cselect_b32 s64, 0xf149, 0
    v_mov_b32 v120, s64
    ds_write_b64 v122, v[120:121] offset:5888
    s_mov_b64 exec, -1
    s_mul_i32 s61, s85, 1792
    s_add_u32 s61, s61, 163840
    v_min_u32 v11, 13, v255
    v_lshlrev_b32 v11, 7, v11
    buffer_load_dword v238, v11, s[36:39], s61 offen sc1
L_att:
L_sb9:
    s_cbranch_execz L_wza
    v_accvgpr_read_b32 v242, a227
    v_accvgpr_read_b32 v219, a224
    v_accvgpr_read_b32 v218, a226
    v_lshlrev_b32 v239, 2, v244
    v_sub_u32 v239, v243, v239
    v_mov_b32 v240, 0xf149f2ca
    v_cmp_gt_i32 s[62:63], 0, v239
    v_cmp_gt_i32 s[64:65], 1, v239
    v_cmp_gt_i32 s[80:81], 2, v239
    v_cmp_gt_i32 s[100:101], 3, v239
    v_cndmask_b32 v128, 0, v240, s[62:63]
    v_cndmask_b32 v0, v240, 0, s[62:63]
    v_cndmask_b32 v129, 0, v240, s[64:65]
    v_cndmask_b32 v1, v240, 0, s[64:65]
    v_cndmask_b32 v130, 0, v240, s[80:81]
    v_cndmask_b32 v2, v240, 0, s[80:81]
    v_cndmask_b32 v131, 0, v240, s[100:101]
    v_cndmask_b32 v3, v240, 0, s[100:101]
    v_cmp_gt_i32 s[62:63], 8, v239
    v_cmp_gt_i32 s[64:65], 9, v239
    v_cmp_gt_i32 s[80:81], 10, v239
    v_cmp_gt_i32 s[100:101], 11, v239
    v_cndmask_b32 v132, 0, v240, s[62:63]
    v_cndmask_b32 v4, v240, 0, s[62:63]
    v_cndmask_b32 v133, 0, v240, s[64:65]
    v_cndmask_b32 v5, v240, 0, s[64:65]
    v_cndmask_b32 v134, 0, v240, s[80:81]
    v_cndmask_b32 v6, v240, 0, s[80:81]
    v_cndmask_b32 v135, 0, v240, s[100:101]
    v_cndmask_b32 v7, v240, 0, s[100:101]
    v_cmp_gt_i32 s[62:63], 16, v239
    v_cmp_gt_i32 s[64:65], 17, v239
    v_cmp_gt_i32 s[80:81], 18, v239
    v_cmp_gt_i32 s[100:101], 19, v239
    v_cndmask_b32 v136, 0, v240, s[62:63]
    v_cndmask_b32 v8, v240, 0, s[62:63]
    v_cndmask_b32 v137, 0, v240, s[64:65]
    v_cndmask_b32 v9, v240, 0, s[64:65]
    v_cndmask_b32 v138, 0, v240, s[80:81]
    v_cndmask_b32 v10, v240, 0, s[80:81]
    v_cndmask_b32 v139, 0, v240, s[100:101]
    v_cndmask_b32 v11, v240, 0, s[100:101]
    v_cmp_gt_i32 s[62:63], 24, v239
    v_cmp_gt_i32 s[64:65], 25, v239
    v_cmp_gt_i32 s[80:81], 26, v239
    v_cmp_gt_i32 s[100:101], 27, v239
    v_cndmask_b32 v140, 0, v240, s[62:63]
    v_cndmask_b32 v12, v240, 0, s[62:63]
    v_cndmask_b32 v141, 0, v240, s[64:65]
    v_cndmask_b32 v13, v240, 0, s[64:65]
    v_cndmask_b32 v142, 0, v240, s[80:81]
    v_cndmask_b32 v14, v240, 0, s[80:81]
    v_cndmask_b32 v143, 0, v240, s[100:101]
    v_cndmask_b32 v15, v240, 0, s[100:101]
    s_mov_b32 s62, 0x07060302
    v_perm_b32 v192, v1, v0, s62
    v_pk_ashrrev_i16 v192, 15, v192 op_sel_hi:[0,1]
    v_perm_b32 v193, v3, v2, s62
    v_pk_ashrrev_i16 v193, 15, v193 op_sel_hi:[0,1]
    v_perm_b32 v194, v5, v4, s62
    v_pk_ashrrev_i16 v194, 15, v194 op_sel_hi:[0,1]
    v_perm_b32 v195, v7, v6, s62
    v_pk_ashrrev_i16 v195, 15, v195 op_sel_hi:[0,1]
    v_perm_b32 v196, v9, v8, s62
    v_pk_ashrrev_i16 v196, 15, v196 op_sel_hi:[0,1]
    v_perm_b32 v197, v11, v10, s62
    v_pk_ashrrev_i16 v197, 15, v197 op_sel_hi:[0,1]
    v_perm_b32 v198, v13, v12, s62
    v_pk_ashrrev_i16 v198, 15, v198 op_sel_hi:[0,1]
    v_perm_b32 v199, v15, v14, s62
    v_pk_ashrrev_i16 v199, 15, v199 op_sel_hi:[0,1]
    s_mov_b32 s60, 0
L_p13:
    buffer_load_dword v238, v242, s[36:39], 0 offen sc1
    s_add_u32 s60, s60, 1
    s_cmp_ge_u32 s60, 60000
    s_cbranch_scc1 L_pd14
    s_cmp_eq_u32 s7, 0
    s_waitcnt vmcnt(0)
    v_cmp_ne_u32 vcc, s6, v238
    s_cbranch_vccnz L_p13
L_pd14:
    s_cbranch_scc1 L_pi15
L_pj16:
    s_add_u32 m0, s86, 0
    s_nop 0
    buffer_load_dwordx4 v254, s[36:39], s87 offen sc1 lds
    s_add_u32 m0, s86, 2048
    s_nop 0
    buffer_load_dwordx4 v254, s[36:39], s88 offen sc1 lds
    s_add_u32 m0, s86, 4096
    s_nop 0
    buffer_load_dwordx4 v254, s[36:39], s89 offen sc1 lds
    s_mov_b32 exec_hi, 0xffff
    s_add_u32 m0, s86, 0
    s_nop 0
    buffer_load_dwordx4 v254, s[36:39], s87 offen offset:1024 sc1 lds
    s_add_u32 m0, s86, 2048
    s_nop 0
    buffer_load_dwordx4 v254, s[36:39], s88 offen offset:1024 sc1 lds
    s_add_u32 m0, s86, 4096
    s_nop 0
    buffer_load_dwordx4 v254, s[36:39], s89 offen offset:1024 sc1 lds
    s_mov_b64 exec, -1
    buffer_load_dwordx2 v[144:145], v219, s[36:39], s90 offen offset:0 sc1
    buffer_load_dwordx2 v[146:147], v219, s[36:39], s90 offen offset:256 sc1
    buffer_load_dwordx2 v[148:149], v219, s[36:39], s90 offen offset:1024 sc1
    buffer_load_dwordx2 v[150:151], v219, s[36:39], s90 offen offset:1280 sc1
    s_barrier
    s_mov_b32 exec_lo, 0x0fffffff
    s_mov_b32 exec_hi, 0x0fffffff
    s_add_u32 m0, s86, 24576
    s_add_u32 s61, s87, 2097152
    buffer_load_dwordx4 v218, s[36:39], s61 offen sc1 lds
    s_add_u32 s62, s87, 2097024
    buffer_load_dwordx4 v218, s[36:39], s62 offen offset:1024 sc1 lds
    s_not_b64 exec, exec
    v_mov_b32 v152, 0x3f803f80
    v_mov_b32 v153, v152
    v_mov_b32 v154, v152
    v_mov_b32 v155, v152
    v_add_u32 v184, s86, v254
    ds_write_b128 v184, v[152:155] offset:24576
    ds_write_b128 v184, v[152:155] offset:25600
    ds_write_b128 v184, v[152:155] offset:26624
    ds_write_b128 v184, v[152:155] offset:27648
    ds_write_b128 v184, v[152:155] offset:28672
    ds_write_b128 v184, v[152:155] offset:29696
    s_mov_b64 exec, -1
    v_accvgpr_read_b32 v216, a225
    v_accvgpr_read_b32 v232, a232
    v_accvgpr_read_b32 v222, a228
    v_accvgpr_read_b32 v223, a229
    v_accvgpr_read_b32 v224, a230
    v_accvgpr_read_b32 v225, a231
    s_lshl_b32 s61, s3, 11
    s_add_u32 s61, s61, 122880
    v_add_u32 v217, s61, v254
    v_mov_b32 v239, 0x3f80
    v_cmp_eq_u32 vcc, 0, v244
    s_mov_b32 exec_lo, 0x0fffffff
    s_mov_b32 exec_hi, 0x0fffffff
    s_add_u32 m0, s86, 26624
    s_add_u32 s61, s88, 2097152
    buffer_load_dwordx4 v218, s[36:39], s61 offen sc1 lds
    s_add_u32 s62, s88, 2097024
    buffer_load_dwordx4 v218, s[36:39], s62 offen offset:1024 sc1 lds
    s_add_u32 m0, s86, 28672
    s_add_u32 s61, s89, 2097152
    buffer_load_dwordx4 v218, s[36:39], s61 offen sc1 lds
    s_add_u32 s62, s89, 2097024
    buffer_load_dwordx4 v218, s[36:39], s62 offen offset:1024 sc1 lds
    s_waitcnt lgkmcnt(0)
    s_waitcnt vmcnt(6)
    s_mov_b64 exec, -1
    v_cndmask_b32 v150, v239, v150, vcc
    v_cndmask_b32 v151, 0, v151, vcc
    s_barrier
    s_cmp_eq_u32 s68, 2
    s_cbranch_scc1 L_at2
L_at1:
    ds_read_b64 v[152:153], v216 offset:0
    ds_read_b64 v[154:155], v216 offset:256
    ds_read_b64 v[156:157], v216 offset:1024
    ds_read_b64 v[158:159], v216 offset:1280
    ds_read_b64 v[160:161], v216 offset:16384
    ds_read_b64 v[162:163], v216 offset:16640
    ds_read_b64 v[164:165], v216 offset:17408
    ds_read_b64 v[166:167], v216 offset:17664
    ds_read_b64 v[168:169], v216 offset:2048
    ds_read_b64 v[170:171], v216 offset:2304
    ds_read_b64 v[172:173], v216 offset:3072
    ds_read_b64 v[174:175], v216 offset:3328
    s_waitcnt lgkmcnt(8)
    v_mfma_f32_32x32x16_bf16 v[0:15], v[152:155], v[144:147], v[0:15]
    ds_read_b64 v[176:177], v216 offset:4096
    ds_read_b64 v[178:179], v216 offset:4352
    ds_read_b64 v[180:181], v216 offset:5120
    ds_read_b64 v[182:183], v216 offset:5376
    v_mfma_f32_32x32x16_bf16 v[0:15], v[156:159], v[148:151], v[0:15]
    s_waitcnt lgkmcnt(8)
    v_mfma_f32_32x32x16_bf16 v[128:143], v[160:163], v[144:147], v[128:143]
    ds_read_b64 v[152:153], v216 offset:6144
    ds_read_b64 v[154:155], v216 offset:6400
    ds_read_b64 v[156:157], v216 offset:7168
    ds_read_b64 v[158:159], v216 offset:7424
    v_mfma_f32_32x32x16_bf16 v[128:143], v[164:167], v[148:151], v[128:143]
    s_waitcnt lgkmcnt(8)
    v_mfma_f32_32x32x16_bf16 v[16:31], v[168:171], v[144:147], 0
    ds_read_b64 v[160:161], v216 offset:8192
    ds_read_b64 v[162:163], v216 offset:8448
    ds_read_b64 v[164:165], v216 offset:9216
    ds_read_b64 v[166:167], v216 offset:9472
    v_mfma_f32_32x32x16_bf16 v[16:31], v[172:175], v[148:151], v[16:31]
    s_waitcnt lgkmcnt(8)
    v_mfma_f32_32x32x16_bf16 v[32:47], v[176:179], v[144:147], 0
    ds_read_b64 v[168:169], v216 offset:10240
    ds_read_b64 v[170:171], v216 offset:10496
    ds_read_b64 v[172:173], v216 offset:11264
    ds_read_b64 v[174:175], v216 offset:11520
    v_max_f32 v0, v0, v128
    v_max_f32 v1, v1, v129
    v_mfma_f32_32x32x16_bf16 v[32:47], v[180:183], v[148:151], v[32:47]
    v_max_f32 v2, v2, v130
    v_max_f32 v3, v3, v131
    v_max_f32 v4, v4, v132
    v_max_f32 v5, v5, v133
    v_max_f32 v6, v6, v134
    v_max_f32 v7, v7, v135
    v_max_f32 v8, v8, v136
    s_waitcnt lgkmcnt(8)
    v_mfma_f32_32x32x16_bf16 v[48:63], v[152:155], v[144:147], 0
    ds_read_b64 v[176:177], v216 offset:12288
    ds_read_b64 v[178:179], v216 offset:12544
    ds_read_b64 v[180:181], v216 offset:13312
    ds_read_b64 v[182:183], v216 offset:13568
    v_max_f32 v9, v9, v137
    v_max_f32 v10, v10, v138
    v_mfma_f32_32x32x16_bf16 v[48:63], v[156:159], v[148:151], v[48:63]
    v_max_f32 v11, v11, v139
    v_max_f32 v12, v12, v140
    v_max_f32 v13, v13, v141
    v_max_f32 v14, v14, v142
    v_max_f32 v15, v15, v143
    v_max_f32 v226, v0, v1
    v_max3_f32 v226, v226, v2, v3
    s_waitcnt lgkmcnt(8)
    v_mfma_f32_32x32x16_bf16 v[64:79], v[160:163], v[144:147], 0
    ds_read_b64 v[152:153], v216 offset:14336
    ds_read_b64 v[154:155], v216 offset:14592
    ds_read_b64 v[156:157], v216 offset:15360
    ds_read_b64 v[158:159], v216 offset:15616
    v_max3_f32 v226, v226, v4, v5
    v_max3_f32 v226, v226, v6, v7
    v_mfma_f32_32x32x16_bf16 v[64:79], v[164:167], v[148:151], v[64:79]
    v_max3_f32 v226, v226, v8, v9
    v_max3_f32 v226, v226, v10, v11
    v_max3_f32 v226, v226, v12, v13
    v_max3_f32 v226, v226, v14, v15
    v_max3_f32 v226, v226, v16, v17
    v_max3_f32 v226, v226, v18, v19
    v_max3_f32 v226, v226, v20, v21
    s_waitcnt lgkmcnt(8)
    v_mfma_f32_32x32x16_bf16 v[80:95], v[168:171], v[144:147], 0
    v_max3_f32 v226, v226, v22, v23
    v_max3_f32 v226, v226, v24, v25
    v_max3_f32 v226, v226, v26, v27
    v_max3_f32 v226, v226, v28, v29
    v_mfma_f32_32x32x16_bf16 v[80:95], v[172:175], v[148:151], v[80:95]
    v_max3_f32 v226, v226, v30, v31
    v_max3_f32 v226, v226, v32, v33
    v_max3_f32 v226, v226, v34, v35
    v_max3_f32 v226, v226, v36, v37
    v_max3_f32 v226, v226, v38, v39
    v_max3_f32 v226, v226, v40, v41
    v_max3_f32 v226, v226, v42, v43
    s_waitcnt lgkmcnt(4)
    v_mfma_f32_32x32x16_bf16 v[96:111], v[176:179], v[144:147], 0
    v_max3_f32 v226, v226, v44, v45
    v_max3_f32 v226, v226, v46, v47
    v_max3_f32 v226, v226, v48, v49
    v_max3_f32 v226, v226, v50, v51
    v_mfma_f32_32x32x16_bf16 v[96:111], v[180:183], v[148:151], v[96:111]
    v_max3_f32 v226, v226, v52, v53
    v_max3_f32 v226, v226, v54, v55
    v_max3_f32 v226, v226, v56, v57
    v_max3_f32 v226, v226, v58, v59
    v_max3_f32 v226, v226, v60, v61
    v_max3_f32 v226, v226, v62, v63
    v_max3_f32 v226, v226, v64, v65
    s_waitcnt lgkmcnt(0)
    v_mfma_f32_32x32x16_bf16 v[112:127], v[152:155], v[144:147], 0
    v_max3_f32 v226, v226, v66, v67
    v_max3_f32 v226, v226, v68, v69
    v_max3_f32 v226, v226, v70, v71
    v_max3_f32 v226, v226, v72, v73
    v_mfma_f32_32x32x16_bf16 v[112:127], v[156:159], v[148:151], v[112:127]
    v_max3_f32 v226, v226, v74, v75
    v_max3_f32 v226, v226, v76, v77
    v_max3_f32 v226, v226, v78, v79
    v_max3_f32 v226, v226, v80, v81
    v_max3_f32 v226, v226, v82, v83
    v_max3_f32 v226, v226, v84, v85
    v_max3_f32 v226, v226, v86, v87
    v_max3_f32 v226, v226, v88, v89
    v_max3_f32 v226, v226, v90, v91
    v_max3_f32 v226, v226, v92, v93
    v_max3_f32 v226, v226, v94, v95
    v_max3_f32 v226, v226, v96, v97
    v_max3_f32 v226, v226, v98, v99
    v_max3_f32 v226, v226, v100, v101
    v_max3_f32 v226, v226, v102, v103
    v_max3_f32 v226, v226, v104, v105
    v_max3_f32 v226, v226, v106, v107
    v_max3_f32 v226, v226, v108, v109
    v_max3_f32 v226, v226, v110, v111
    v_mov_b32 v240, 0x3f803f80
    v_cndmask_b32 v160, 0, v240, vcc
    v_cndmask_b32 v161, 0, v239, vcc
    v_mov_b32 v162, 0
    v_mov_b32 v163, 0
    v_mov_b32 v166, 0
    v_mov_b32 v167, 0
    s_mul_i32 s67, s3, 10240
    s_add_u32 m0, s67, 57344
    s_mul_i32 s67, s67, 28
    s_add_u32 s67, s67, s94
    buffer_load_dwordx4 v222, s[20:23], s67 offen offset:0 lds
    v_max3_f32 v226, v226, v112, v113
    v_max3_f32 v226, v226, v114, v115
    v_max3_f32 v226, v226, v116, v117
    v_max3_f32 v226, v226, v118, v119
    v_max3_f32 v226, v226, v120, v121
    v_max3_f32 v226, v226, v122, v123
    v_max3_f32 v226, v226, v124, v125
    v_max3_f32 v226, v226, v126, v127
    v_mov_b32 v239, v226
    s_nop 1
    v_permlane32_swap_b32 v226, v239
    v_max_f32 v226, v226, v239
    v_pk_add_f32 v[0:1], v[0:1], v[226:227] op_sel_hi:[1,0] neg_lo:[0,1] neg_hi:[0,1]
    v_pk_add_f32 v[2:3], v[2:3], v[226:227] op_sel_hi:[1,0] neg_lo:[0,1] neg_hi:[0,1]
    v_pk_add_f32 v[4:5], v[4:5], v[226:227] op_sel_hi:[1,0] neg_lo:[0,1] neg_hi:[0,1]
    v_pk_add_f32 v[6:7], v[6:7], v[226:227] op_sel_hi:[1,0] neg_lo:[0,1] neg_hi:[0,1]
    v_pk_add_f32 v[8:9], v[8:9], v[226:227] op_sel_hi:[1,0] neg_lo:[0,1] neg_hi:[0,1]
    v_pk_add_f32 v[10:11], v[10:11], v[226:227] op_sel_hi:[1,0] neg_lo:[0,1] neg_hi:[0,1]
    v_pk_add_f32 v[12:13], v[12:13], v[226:227] op_sel_hi:[1,0] neg_lo:[0,1] neg_hi:[0,1]
    v_pk_add_f32 v[14:15], v[14:15], v[226:227] op_sel_hi:[1,0] neg_lo:[0,1] neg_hi:[0,1]
    v_and_b32 v239, 0xffff0000, v226
    v_sub_f32 v240, v226, v239
    v_and_b32 v241, 0xffff0000, v240
    v_sub_f32 v240, v240, v241
    v_cvt_pk_bf16_f32 v164, -v239, -v241
    v_cvt_pk_bf16_f32 v165, -v240, 0
    s_nop 1
    v_mfma_f32_32x32x16_bf16 v[16:31], v[160:163], v[164:167], v[16:31]
    v_exp_f32 v0, v0
    v_exp_f32 v1, v1
    v_exp_f32 v2, v2
    v_exp_f32 v3, v3
    v_exp_f32 v4, v4
    v_exp_f32 v5, v5
    v_exp_f32 v6, v6
    v_exp_f32 v7, v7
    v_cvt_pk_bf16_f32 v0, v0, v1
    v_cvt_pk_bf16_f32 v1, v2, v3
    v_cvt_pk_bf16_f32 v2, v4, v5
    v_cvt_pk_bf16_f32 v3, v6, v7
    v_and_b32 v128, v192, v0
    v_xor_b32 v0, v0, v128
    v_and_b32 v129, v193, v1
    v_xor_b32 v1, v1, v129
    v_and_b32 v130, v194, v2
    v_xor_b32 v2, v2, v130
    v_and_b32 v131, v195, v3
    v_xor_b32 v3, v3, v131
    s_waitcnt vmcnt(1)
    s_barrier
    ds_read_b128 v[200:203], v217 offset:0
    ds_read_b128 v[204:207], v217 offset:1024
    ds_read_b128 v[208:211], v217 offset:16384
    ds_read_b128 v[212:215], v217 offset:17408
    v_exp_f32 v8, v8
    v_exp_f32 v9, v9
    v_exp_f32 v10, v10
    v_exp_f32 v11, v11
    v_exp_f32 v12, v12
    v_exp_f32 v13, v13
    v_exp_f32 v14, v14
    v_exp_f32 v15, v15
    v_cvt_pk_bf16_f32 v8, v8, v9
    v_cvt_pk_bf16_f32 v9, v10, v11
    v_cvt_pk_bf16_f32 v10, v12, v13
    v_cvt_pk_bf16_f32 v11, v14, v15
    v_and_b32 v136, v196, v8
    v_xor_b32 v8, v8, v136
    v_and_b32 v137, v197, v9
    v_xor_b32 v9, v9, v137
    v_and_b32 v138, v198, v10
    v_xor_b32 v10, v10, v138
    v_and_b32 v139, v199, v11
    v_xor_b32 v11, v11, v139
    s_waitcnt lgkmcnt(2)
    v_mfma_f32_32x32x16_bf16 v[184:199], v[200:203], v[0:3], 0
    buffer_load_dwordx4 v223, s[20:23], s67 offen offset:1024 lds
    v_exp_f32 v16, v16
    v_exp_f32 v17, v17
    v_exp_f32 v18, v18
    v_exp_f32 v19, v19
    v_mfma_f32_32x32x16_bf16 v[32:47], v[160:163], v[164:167], v[32:47]
    v_exp_f32 v20, v20
    v_exp_f32 v21, v21
    v_exp_f32 v22, v22
    v_exp_f32 v23, v23
    v_cvt_pk_bf16_f32 v16, v16, v17
    v_cvt_pk_bf16_f32 v17, v18, v19
    v_cvt_pk_bf16_f32 v18, v20, v21
    v_cvt_pk_bf16_f32 v19, v22, v23
    v_mfma_f32_32x32x16_bf16 v[184:199], v[204:207], v[8:11], v[184:199]
    ds_read_b128 v[200:203], v217 offset:2048
    ds_read_b128 v[204:207], v217 offset:3072
    buffer_load_dwordx4 v224, s[20:23], s67 offen offset:2048 lds
    v_exp_f32 v24, v24
    v_exp_f32 v25, v25
    v_exp_f32 v26, v26
    v_exp_f32 v27, v27
    s_waitcnt lgkmcnt(2)
    v_mfma_f32_32x32x16_bf16 v[184:199], v[208:211], v[128:131], v[184:199]
    v_exp_f32 v28, v28
    v_exp_f32 v29, v29
    v_exp_f32 v30, v30
    v_exp_f32 v31, v31
    v_cvt_pk_bf16_f32 v24, v24, v25
    v_cvt_pk_bf16_f32 v25, v26, v27
    v_cvt_pk_bf16_f32 v26, v28, v29
    v_cvt_pk_bf16_f32 v27, v30, v31
    v_mfma_f32_32x32x16_bf16 v[184:199], v[212:215], v[136:139], v[184:199]
    ds_read_b128 v[208:211], v217 offset:4096
    ds_read_b128 v[212:215], v217 offset:5120
    buffer_load_dwordx4 v225, s[20:23], s67 offen offset:3072 lds
    v_exp_f32 v32, v32
    v_exp_f32 v33, v33
    v_exp_f32 v34, v34
    v_exp_f32 v35, v35
    v_mfma_f32_32x32x16_bf16 v[48:63], v[160:163], v[164:167], v[48:63]
    v_exp_f32 v36, v36
    v_exp_f32 v37, v37
    v_exp_f32 v38, v38
    v_exp_f32 v39, v39
    v_cvt_pk_bf16_f32 v32, v32, v33
    v_cvt_pk_bf16_f32 v33, v34, v35
    v_cvt_pk_bf16_f32 v34, v36, v37
    v_cvt_pk_bf16_f32 v35, v38, v39
    s_waitcnt lgkmcnt(2)
    v_mfma_f32_32x32x16_bf16 v[184:199], v[200:203], v[16:19], v[184:199]
    s_add_u32 m0, m0, 4096
    s_add_u32 s67, s67, 114688
    buffer_load_dwordx4 v222, s[20:23], s67 offen offset:0 lds
    v_exp_f32 v40, v40
    v_exp_f32 v41, v41
    v_exp_f32 v42, v42
    v_exp_f32 v43, v43
    v_mfma_f32_32x32x16_bf16 v[184:199], v[204:207], v[24:27], v[184:199]
    ds_read_b128 v[200:203], v217 offset:6144
    ds_read_b128 v[204:207], v217 offset:7168
    v_exp_f32 v44, v44
    v_exp_f32 v45, v45
    v_exp_f32 v46, v46
    v_exp_f32 v47, v47
    v_cvt_pk_bf16_f32 v40, v40, v41
    v_cvt_pk_bf16_f32 v41, v42, v43
    v_cvt_pk_bf16_f32 v42, v44, v45
    v_cvt_pk_bf16_f32 v43, v46, v47
    s_waitcnt lgkmcnt(2)
    v_mfma_f32_32x32x16_bf16 v[184:199], v[208:211], v[32:35], v[184:199]
    buffer_load_dwordx4 v223, s[20:23], s67 offen offset:1024 lds
    v_exp_f32 v48, v48
    v_exp_f32 v49, v49
    v_exp_f32 v50, v50
    v_exp_f32 v51, v51
    v_mfma_f32_32x32x16_bf16 v[64:79], v[160:163], v[164:167], v[64:79]
    v_exp_f32 v52, v52
    v_exp_f32 v53, v53
    v_exp_f32 v54, v54
    v_exp_f32 v55, v55
    v_cvt_pk_bf16_f32 v48, v48, v49
    v_cvt_pk_bf16_f32 v49, v50, v51
    v_cvt_pk_bf16_f32 v50, v52, v53
    v_cvt_pk_bf16_f32 v51, v54, v55
    v_mfma_f32_32x32x16_bf16 v[184:199], v[212:215], v[40:43], v[184:199]
    ds_read_b128 v[208:211], v217 offset:8192
    ds_read_b128 v[212:215], v217 offset:9216
    buffer_load_dwordx4 v224, s[20:23], s67 offen offset:2048 lds
    v_exp_f32 v56, v56
    v_exp_f32 v57, v57
    v_exp_f32 v58, v58
    v_exp_f32 v59, v59
    v_exp_f32 v60, v60
    v_exp_f32 v61, v61
    v_exp_f32 v62, v62
    v_exp_f32 v63, v63
    v_cvt_pk_bf16_f32 v56, v56, v57
    v_cvt_pk_bf16_f32 v57, v58, v59
    v_cvt_pk_bf16_f32 v58, v60, v61
    v_cvt_pk_bf16_f32 v59, v62, v63
    s_waitcnt lgkmcnt(2)
    v_mfma_f32_32x32x16_bf16 v[184:199], v[200:203], v[48:51], v[184:199]
    buffer_load_dwordx4 v225, s[20:23], s67 offen offset:3072 lds
    v_exp_f32 v64, v64
    v_exp_f32 v65, v65
    v_exp_f32 v66, v66
    v_exp_f32 v67, v67
    v_mfma_f32_32x32x16_bf16 v[80:95], v[160:163], v[164:167], v[80:95]
    v_exp_f32 v68, v68
    v_exp_f32 v69, v69
    v_exp_f32 v70, v70
    v_exp_f32 v71, v71
    v_cvt_pk_bf16_f32 v64, v64, v65
    v_cvt_pk_bf16_f32 v65, v66, v67
    v_cvt_pk_bf16_f32 v66, v68, v69
    v_cvt_pk_bf16_f32 v67, v70, v71
    v_mfma_f32_32x32x16_bf16 v[184:199], v[204:207], v[56:59], v[184:199]
    ds_read_b128 v[200:203], v217 offset:10240
    ds_read_b128 v[204:207], v217 offset:11264
    s_add_u32 m0, m0, 4096
    s_add_u32 s67, s67, 114688
L_sb10:
    s_cbranch_execz L_wzb
    buffer_load_dwordx4 v222, s[20:23], s67 offen offset:0 lds
    v_exp_f32 v72, v72
    v_exp_f32 v73, v73
    v_exp_f32 v74, v74
    v_exp_f32 v75, v75
    v_exp_f32 v76, v76
    v_exp_f32 v77, v77
    v_exp_f32 v78, v78
    v_exp_f32 v79, v79
    v_cvt_pk_bf16_f32 v72, v72, v73
    v_cvt_pk_bf16_f32 v73, v74, v75
    v_cvt_pk_bf16_f32 v74, v76, v77
    v_cvt_pk_bf16_f32 v75, v78, v79
    s_waitcnt lgkmcnt(2)
    v_mfma_f32_32x32x16_bf16 v[184:199], v[208:211], v[64:67], v[184:199]
    buffer_load_dwordx4 v223, s[20:23], s67 offen offset:1024 lds
    v_exp_f32 v80, v80
    v_exp_f32 v81, v81
    v_exp_f32 v82, v82
    v_exp_f32 v83, v83
    v_mfma_f32_32x32x16_bf16 v[96:111], v[160:163], v[164:167], v[96:111]
    v_exp_f32 v84, v84
    v_exp_f32 v85, v85
    v_exp_f32 v86, v86
    v_exp_f32 v87, v87
    v_cvt_pk_bf16_f32 v80, v80, v81
    v_cvt_pk_bf16_f32 v81, v82, v83
    v_cvt_pk_bf16_f32 v82, v84, v85
    v_cvt_pk_bf16_f32 v83, v86, v87
    v_mfma_f32_32x32x16_bf16 v[184:199], v[212:215], v[72:75], v[184:199]
    ds_read_b128 v[208:211], v217 offset:12288
    ds_read_b128 v[212:215], v217 offset:13312
    v_exp_f32 v88, v88
    v_exp_f32 v89, v89
    v_exp_f32 v90, v90
    v_exp_f32 v91, v91
    v_exp_f32 v92, v92
    v_exp_f32 v93, v93
    v_exp_f32 v94, v94
    v_exp_f32 v95, v95
    v_cvt_pk_bf16_f32 v88, v88, v89
    v_cvt_pk_bf16_f32 v89, v90, v91
    v_cvt_pk_bf16_f32 v90, v92, v93
    v_cvt_pk_bf16_f32 v91, v94, v95
    s_waitcnt lgkmcnt(2)
    v_mfma_f32_32x32x16_bf16 v[184:199], v[200:203], v[80:83], v[184:199]
    v_exp_f32 v96, v96
    v_exp_f32 v97, v97
    v_exp_f32 v98, v98
    v_exp_f32 v99, v99
    v_mfma_f32_32x32x16_bf16 v[112:127], v[160:163], v[164:167], v[112:127]
    v_exp_f32 v100, v100
    v_exp_f32 v101, v101
    v_exp_f32 v102, v102
    v_exp_f32 v103, v103
    v_cvt_pk_bf16_f32 v96, v96, v97
    v_cvt_pk_bf16_f32 v97, v98, v99
    v_cvt_pk_bf16_f32 v98, v100, v101
    v_cvt_pk_bf16_f32 v99, v102, v103
    v_mfma_f32_32x32x16_bf16 v[184:199], v[204:207], v[88:91], v[184:199]
    ds_read_b128 v[200:203], v217 offset:14336
    ds_read_b128 v[204:207], v217 offset:15360
    v_exp_f32 v104, v104
    v_exp_f32 v105, v105
    v_exp_f32 v106, v106
    v_exp_f32 v107, v107
    v_exp_f32 v108, v108
    v_exp_f32 v109, v109
    v_exp_f32 v110, v110
    v_exp_f32 v111, v111
    v_cvt_pk_bf16_f32 v104, v104, v105
    v_cvt_pk_bf16_f32 v105, v106, v107
    v_cvt_pk_bf16_f32 v106, v108, v109
    v_cvt_pk_bf16_f32 v107, v110, v111
    s_waitcnt lgkmcnt(2)
    v_mfma_f32_32x32x16_bf16 v[184:199], v[208:211], v[96:99], v[184:199]
    v_exp_f32 v112, v112
    v_exp_f32 v113, v113
    v_exp_f32 v114, v114
    v_exp_f32 v115, v115
    v_exp_f32 v116, v116
    v_exp_f32 v117, v117
    v_exp_f32 v118, v118
    v_exp_f32 v119, v119
    v_cvt_pk_bf16_f32 v112, v112, v113
    v_cvt_pk_bf16_f32 v113, v114, v115
    v_cvt_pk_bf16_f32 v114, v116, v117
    v_cvt_pk_bf16_f32 v115, v118, v119
    v_mfma_f32_32x32x16_bf16 v[184:199], v[212:215], v[104:107], v[184:199]
    v_exp_f32 v120, v120
    v_exp_f32 v121, v121
    v_exp_f32 v122, v122
    v_exp_f32 v123, v123
    v_exp_f32 v124, v124
    v_exp_f32 v125, v125
    v_exp_f32 v126, v126
    v_exp_f32 v127, v127
    v_cvt_pk_bf16_f32 v120, v120, v121
    v_cvt_pk_bf16_f32 v121, v122, v123
    v_cvt_pk_bf16_f32 v122, v124, v125
    v_cvt_pk_bf16_f32 v123, v126, v127
    s_waitcnt lgkmcnt(0)
    v_mfma_f32_32x32x16_bf16 v[184:199], v[200:203], v[112:115], v[184:199]
    v_mfma_f32_32x32x16_bf16 v[184:199], v[204:207], v[120:123], v[184:199]
    s_nop 11
    v_mov_b32 v239, v196
    v_mov_b32 v240, v196
    s_nop 1
    v_permlane32_swap_b32 v239, v240
    v_rcp_f32 v240, v240
    s_nop 0
    v_pk_mul_f32 v[184:185], v[184:185], v[240:241] op_sel_hi:[1,0]
    s_nop 0
    v_cvt_pk_bf16_f32 v152, v184, v185
    v_pk_mul_f32 v[186:187], v[186:187], v[240:241] op_sel_hi:[1,0]
    s_nop 0
    v_cvt_pk_bf16_f32 v153, v186, v187
    v_pk_mul_f32 v[188:189], v[188:189], v[240:241] op_sel_hi:[1,0]
    s_nop 0
    v_cvt_pk_bf16_f32 v154, v188, v189
    v_pk_mul_f32 v[190:191], v[190:191], v[240:241] op_sel_hi:[1,0]
    s_nop 0
    v_cvt_pk_bf16_f32 v155, v190, v191
    buffer_store_dwordx4 v[152:155], v254, s[36:39], s90 offen offset:0
    v_pk_mul_f32 v[192:193], v[192:193], v[240:241] op_sel_hi:[1,0]
    s_nop 0
    v_cvt_pk_bf16_f32 v156, v192, v193
    v_pk_mul_f32 v[194:195], v[194:195], v[240:241] op_sel_hi:[1,0]
    s_nop 0
    v_cvt_pk_bf16_f32 v157, v194, v195
    v_pk_mul_f32 v[196:197], v[196:197], v[240:241] op_sel_hi:[1,0]
    s_nop 0
    v_cvt_pk_bf16_f32 v158, v196, v197
    v_cndmask_b32 v158, 0, v158, vcc
    v_pk_mul_f32 v[198:199], v[198:199], v[240:241] op_sel_hi:[1,0]
    s_nop 0
    v_cvt_pk_bf16_f32 v159, v198, v199
    v_cndmask_b32 v159, 0, v159, vcc
    buffer_store_dwordx4 v[156:159], v254, s[36:39], s90 offen offset:1024
    s_cmp_eq_u32 s68, 1
    s_cbranch_scc1 L_hu0
    s_waitcnt vmcnt(0)
    s_mov_b64 exec, 1
    s_cmp_eq_u32 s7, 0
    s_cbranch_scc1 L_fs19
    buffer_store_dword v245, off, s[36:39], s91
L_fj20:
    s_mov_b64 exec, -1
    s_barrier
    s_mul_i32 s67, s3, 4096
    s_add_u32 m0, s67, 98304
    s_mul_i32 s67, s67, 28
    s_add_u32 s67, s67, s94
    s_add_u32 s67, s67, 1146880
    buffer_load_dwordx4 v222, s[20:23], s67 offen offset:0 lds
    buffer_load_dwordx4 v223, s[20:23], s67 offen offset:1024 lds
    buffer_load_dwordx4 v224, s[20:23], s67 offen offset:2048 lds
    buffer_load_dwordx4 v225, s[20:23], s67 offen offset:3072 lds
    s_mul_i32 s67, s3, 14336
    s_add_u32 m0, s67, 0
    s_mul_i32 s67, s67, 28
    s_add_u32 s67, s67, s93
    buffer_load_dwordx4 v222, s[20:23], s67 offen offset:0 lds
    buffer_load_dwordx4 v223, s[20:23], s67 offen offset:1024 lds
    v_min_u32 v228, 13, v255
    v_lshlrev_b32 v228, 2, v228
    s_lshl_b32 s62, s3, 6
    s_add_u32 s62, s62, s47
    s_add_u32 s82, s62, 1536
    s_lshl_b32 s62, s3, 8
    s_add_u32 s62, s62, s47
    s_lshl_b32 s63, s48, 2
    s_add_u32 s62, s62, s63
    s_add_u32 s85, s62, 2048
    s_mul_i32 s84, s49, 14
    s_add_u32 s84, s84, s48
    s_lshl_b32 s84, s84, 7
    s_add_u32 s84, s84, 524288
    s_mul_i32 s83, s49, 28672
    s_mul_i32 s87, s49, 3584
    s_add_u32 s87, s87, 163840
    s_mul_i32 s88, s49, 114688
    s_lshl_b32 s62, s93, 5
    s_add_u32 s88, s88, s62
    s_add_u32 s88, s88, 7340032
    s_lshl_b32 s61, s93, 3
    s_add_u32 s89, s61, 114688
    s_xor_b32 s61, s61, 1024
    s_add_u32 s90, s61, 114688
    v_lshlrev_b32 v229, 11, v244
    v_lshl_add_u32 v229, v243, 4, v229
    v_lshlrev_b32 v230, 30, v244
    v_add_u32 v230, v230, v229
    v_add_u32 v239, 57344, v251
    v_add_u32 v240, 57344, v250
    v_cmp_eq_u32 s[80:81], 0, v244
    v_lshlrev_b32 v241, 2, v243
    v_lshlrev_b32 v242, 7, v243
    v_accvgpr_write_b32 a243, 0
    v_accvgpr_write_b32 a247, 0
    v_accvgpr_write_b32 a235, 0
    v_accvgpr_write_b32 a239, 0
    buffer_load_dwordx4 v224, s[20:23], s67 offen offset:2048 lds
    buffer_load_dwordx4 v225, s[20:23], s67 offen offset:3072 lds
    s_add_u32 m0, m0, 4096
    s_add_u32 s67, s67, 114688
    buffer_load_dwordx4 v222, s[20:23], s67 offen offset:0 lds
    buffer_load_dwordx4 v223, s[20:23], s67 offen offset:1024 lds
    buffer_load_dwordx4 v224, s[20:23], s67 offen offset:2048 lds
    buffer_load_dwordx4 v225, s[20:23], s67 offen offset:3072 lds
    s_add_u32 m0, m0, 4096
    s_add_u32 s67, s67, 114688
    buffer_load_dwordx4 v222, s[20:23], s67 offen offset:0 lds
    buffer_load_dwordx4 v223, s[20:23], s67 offen offset:1024 lds
    buffer_load_dwordx4 v224, s[20:23], s67 offen offset:2048 lds
    buffer_load_dwordx4 v225, s[20:23], s67 offen offset:3072 lds
    s_add_u32 m0, m0, 4096
    s_add_u32 s67, s67, 114688
    buffer_load_dwordx4 v222, s[20:23], s67 offen offset:0 lds
    buffer_load_dwordx4 v223, s[20:23], s67 offen offset:1024 lds
    s_and_b32 s66, s4, 1
    s_xor_b32 s66, s66, 0
    s_lshl_b32 s66, s66, 2
    s_add_u32 s66, s66, s3
    s_mul_i32 s66, s66, 7168
    s_mul_i32 s65, s48, 114688
    s_add_u32 s65, s65, s66
    s_bitcmp1_b32 s48, 1
    s_cselect_b32 s66, 57344, 0
    s_add_u32 s65, s65, s66
    v_min_u32 v242, 55, v255
    v_lshlrev_b32 v242, 7, v242
    buffer_load_dword v238, v242, s[24:27], s65 offen
    s_and_b32 s66, s4, 1
    s_xor_b32 s66, s66, 1
    s_lshl_b32 s66, s66, 2
    s_add_u32 s66, s66, s3
    s_mul_i32 s66, s66, 7168
    s_mul_i32 s65, s48, 114688
    s_add_u32 s65, s65, s66
    s_bitcmp1_b32 s48, 1
    s_cselect_b32 s66, 57344, 0
    s_add_u32 s65, s65, s66
    v_min_u32 v242, 55, v255
    v_lshlrev_b32 v242, 7, v242
    buffer_load_dword v238, v242, s[24:27], s65 offen
    v_lshlrev_b32 v242, 7, v243
    s_waitcnt vmcnt(2)
    s_barrier
    buffer_load_dwordx4 v[144:147], v254, s[36:39], s89 offen sc1
    buffer_load_dwordx4 v[148:151], v254, s[36:39], s90 offen sc1
    ds_read_b64_tr_b16 a[112:113], v251 offset:0
    ds_read_b64_tr_b16 a[114:115], v251 offset:1024
    ds_read_b64_tr_b16 a[116:117], v250 offset:0
    ds_read_b64_tr_b16 a[118:119], v250 offset:1024
    ds_read_b64_tr_b16 a[120:121], v251 offset:2048
    ds_read_b64_tr_b16 a[122:123], v251 offset:3072
    ds_read_b64_tr_b16 a[124:125], v250 offset:2048
    ds_read_b64_tr_b16 a[126:127], v250 offset:3072
    ds_read_b64_tr_b16 a[128:129], v251 offset:4096
    ds_read_b64_tr_b16 a[130:131], v251 offset:5120
    ds_read_b64_tr_b16 a[132:133], v250 offset:4096
    ds_read_b64_tr_b16 a[134:135], v250 offset:5120
    ds_read_b64_tr_b16 a[136:137], v251 offset:6144
    ds_read_b64_tr_b16 a[138:139], v251 offset:7168
    ds_read_b64_tr_b16 a[140:141], v250 offset:6144
    ds_read_b64_tr_b16 a[142:143], v250 offset:7168
    ds_read_b64_tr_b16 a[144:145], v251 offset:8192
    ds_read_b64_tr_b16 a[146:147], v251 offset:9216
    ds_read_b64_tr_b16 a[148:149], v250 offset:8192
    ds_read_b64_tr_b16 a[150:151], v250 offset:9216
    ds_read_b64_tr_b16 a[152:153], v251 offset:10240
    ds_read_b64_tr_b16 a[154:155], v251 offset:11264
    ds_read_b64_tr_b16 a[156:157], v250 offset:10240
    ds_read_b64_tr_b16 a[158:159], v250 offset:11264
    ds_read_b64_tr_b16 a[160:161], v251 offset:12288
    ds_read_b64_tr_b16 a[162:163], v251 offset:13312
    ds_read_b64_tr_b16 a[164:165], v250 offset:12288
    ds_read_b64_tr_b16 a[166:167], v250 offset:13312
    ds_read_b64_tr_b16 a[168:169], v239 offset:0
    ds_read_b64_tr_b16 a[170:171], v239 offset:1024
    ds_read_b64_tr_b16 a[172:173], v240 offset:0
    ds_read_b64_tr_b16 a[174:175], v240 offset:1024
    ds_read_b64_tr_b16 a[176:177], v239 offset:2048
    ds_read_b64_tr_b16 a[178:179], v239 offset:3072
    ds_read_b64_tr_b16 a[180:181], v240 offset:2048
    ds_read_b64_tr_b16 a[182:183], v240 offset:3072
    ds_read_b64_tr_b16 a[184:185], v239 offset:4096
    ds_read_b64_tr_b16 a[186:187], v239 offset:5120
    ds_read_b64_tr_b16 a[188:189], v240 offset:4096
    ds_read_b64_tr_b16 a[190:191], v240 offset:5120
    ds_read_b64_tr_b16 a[192:193], v239 offset:6144
    ds_read_b64_tr_b16 a[194:195], v239 offset:7168
    ds_read_b64_tr_b16 a[196:197], v240 offset:6144
    ds_read_b64_tr_b16 a[198:199], v240 offset:7168
    ds_read_b64_tr_b16 a[200:201], v239 offset:8192
    ds_read_b64_tr_b16 a[202:203], v239 offset:9216
    ds_read_b64_tr_b16 a[204:205], v240 offset:8192
    ds_read_b64_tr_b16 a[206:207], v240 offset:9216
    ds_read_b64_tr_b16 a[208:209], v239 offset:10240
    ds_read_b64_tr_b16 a[210:211], v239 offset:11264
    ds_read_b64_tr_b16 a[212:213], v240 offset:10240
    ds_read_b64_tr_b16 a[214:215], v240 offset:11264
    ds_read_b64_tr_b16 a[216:217], v239 offset:12288
    ds_read_b64_tr_b16 a[218:219], v239 offset:13312
    ds_read_b64_tr_b16 a[220:221], v240 offset:12288
    ds_read_b64_tr_b16 a[222:223], v240 offset:13312
    s_mov_b32 s60, 0
L_p21:
    buffer_load_dword v238, v228, s[36:39], s82 offen sc1
    s_add_u32 s60, s60, 1
    s_cmp_ge_u32 s60, 60000
    s_cbranch_scc1 L_pd22
    s_cmp_eq_u32 s7, 0
    s_waitcnt vmcnt(0)
    v_cmp_ne_u32 vcc, s6, v238
    s_cbranch_vccnz L_p21
L_pd22:
    s_cbranch_scc1 L_pi23
L_pj24:
    buffer_load_dwordx4 v[0:3], v254, s[32:35], s83 offen offset:0 sc1
    buffer_load_dwordx4 v[4:7], v254, s[32:35], s83 offen offset:1024 sc1
    buffer_load_dwordx4 v[8:11], v254, s[32:35], s83 offen offset:2048 sc1
    buffer_load_dwordx4 v[12:15], v254, s[32:35], s83 offen offset:3072 sc1
    s_add_u32 s83, s83, 4096
    buffer_load_dwordx4 v[16:19], v254, s[32:35], s83 offen offset:0 sc1
    buffer_load_dwordx4 v[20:23], v254, s[32:35], s83 offen offset:1024 sc1
    buffer_load_dwordx4 v[24:27], v254, s[32:35], s83 offen offset:2048 sc1
    buffer_load_dwordx4 v[28:31], v254, s[32:35], s83 offen offset:3072 sc1
    s_add_u32 s83, s83, 4096
    buffer_load_dwordx4 v[32:35], v254, s[32:35], s83 offen offset:0 sc1
    buffer_load_dwordx4 v[36:39], v254, s[32:35], s83 offen offset:1024 sc1
    s_waitcnt lgkmcnt(0)
    s_waitcnt vmcnt(9)
    v_mfma_f32_32x32x16_bf16 v[112:127], a[112:115], v[0:3], 0
    buffer_load_dwordx4 v[40:43], v254, s[32:35], s83 offen offset:2048 sc1
    v_mfma_f32_32x32x16_bf16 v[128:143], a[116:119], v[0:3], 0
    s_waitcnt vmcnt(9)
    v_mfma_f32_32x32x16_bf16 v[112:127], a[120:123], v[4:7], v[112:127]
    buffer_load_dwordx4 v[44:47], v254, s[32:35], s83 offen offset:3072 sc1
    v_mfma_f32_32x32x16_bf16 v[128:143], a[124:127], v[4:7], v[128:143]
    s_waitcnt vmcnt(9)
    v_mfma_f32_32x32x16_bf16 v[112:127], a[128:131], v[8:11], v[112:127]
    buffer_load_dwordx4 v[160:163], v229, s[36:39], s87 offen offset:0 sc1
    buffer_load_dwordx4 v[164:167], v229, s[36:39], s87 offen offset:512 sc1
    v_mfma_f32_32x32x16_bf16 v[128:143], a[132:135], v[8:11], v[128:143]
    s_waitcnt vmcnt(10)
    v_mfma_f32_32x32x16_bf16 v[112:127], a[136:139], v[12:15], v[112:127]
    buffer_load_dwordx4 v[168:171], v229, s[36:39], s87 offen offset:1024 sc1
    buffer_load_dwordx4 v[172:175], v230, s[36:39], s87 offen offset:1536 sc1
    v_mfma_f32_32x32x16_bf16 v[128:143], a[140:143], v[12:15], v[128:143]
    s_waitcnt vmcnt(11)
    v_mfma_f32_32x32x16_bf16 v[112:127], a[144:147], v[16:19], v[112:127]
    s_add_u32 s83, s83, 4096
    buffer_load_dwordx4 v[48:51], v254, s[32:35], s83 offen offset:0 sc1
    buffer_load_dwordx4 v[52:55], v254, s[32:35], s83 offen offset:1024 sc1
    ds_read_b64_tr_b16 v[200:201], v251 offset:14336
    v_mfma_f32_32x32x16_bf16 v[128:143], a[148:151], v[16:19], v[128:143]
    ds_read_b64_tr_b16 v[202:203], v251 offset:15360
    ds_read_b64_tr_b16 v[204:205], v250 offset:14336
    ds_read_b64_tr_b16 v[206:207], v250 offset:15360
    s_waitcnt vmcnt(12)
    v_mfma_f32_32x32x16_bf16 v[112:127], a[152:155], v[20:23], v[112:127]
    buffer_load_dwordx4 v[56:59], v254, s[32:35], s83 offen offset:2048 sc1
    buffer_load_dwordx4 v[60:63], v254, s[32:35], s83 offen offset:3072 sc1
    ds_read_b64_tr_b16 v[176:177], v251 offset:16384
    v_mfma_f32_32x32x16_bf16 v[128:143], a[156:159], v[20:23], v[128:143]
    ds_read_b64_tr_b16 v[178:179], v251 offset:17408
    ds_read_b64_tr_b16 v[180:181], v250 offset:16384
    ds_read_b64_tr_b16 v[182:183], v250 offset:17408
    s_waitcnt vmcnt(13)
    v_mfma_f32_32x32x16_bf16 v[112:127], a[160:163], v[24:27], v[112:127]
    s_add_u32 s83, s83, 4096
    buffer_load_dwordx4 v[64:67], v254, s[32:35], s83 offen offset:0 sc1
    ds_read_b64_tr_b16 v[184:185], v251 offset:18432
    v_mfma_f32_32x32x16_bf16 v[128:143], a[164:167], v[24:27], v[128:143]
    ds_read_b64_tr_b16 v[186:187], v251 offset:19456
    ds_read_b64_tr_b16 v[188:189], v250 offset:18432
    ds_read_b64_tr_b16 v[190:191], v250 offset:19456
    s_waitcnt vmcnt(13)
    s_waitcnt lgkmcnt(8)
    v_mfma_f32_32x32x16_bf16 v[112:127], v[200:203], v[28:31], v[112:127]
    buffer_load_dwordx4 v[68:71], v254, s[32:35], s83 offen offset:1024 sc1
    ds_read_b64_tr_b16 v[192:193], v251 offset:20480
    v_mfma_f32_32x32x16_bf16 v[128:143], v[204:207], v[28:31], v[128:143]
    ds_read_b64_tr_b16 v[194:195], v251 offset:21504
    ds_read_b64_tr_b16 v[196:197], v250 offset:20480
    ds_read_b64_tr_b16 v[198:199], v250 offset:21504
    s_waitcnt vmcnt(13)
    s_waitcnt lgkmcnt(8)
    v_mfma_f32_32x32x16_bf16 v[112:127], v[176:179], v[32:35], v[112:127]
    buffer_load_dwordx4 v[72:75], v254, s[32:35], s83 offen offset:2048 sc1
    ds_read_b64_tr_b16 v[200:201], v251 offset:22528
    v_mfma_f32_32x32x16_bf16 v[128:143], v[180:183], v[32:35], v[128:143]
    ds_read_b64_tr_b16 v[202:203], v251 offset:23552
    ds_read_b64_tr_b16 v[204:205], v250 offset:22528
    ds_read_b64_tr_b16 v[206:207], v250 offset:23552
    s_waitcnt vmcnt(13)
    s_waitcnt lgkmcnt(8)
    v_mfma_f32_32x32x16_bf16 v[112:127], v[184:187], v[36:39], v[112:127]
    buffer_load_dwordx4 v[76:79], v254, s[32:35], s83 offen offset:3072 sc1
    ds_read_b64_tr_b16 v[176:177], v251 offset:24576
    v_mfma_f32_32x32x16_bf16 v[128:143], v[188:191], v[36:39], v[128:143]
    ds_read_b64_tr_b16 v[178:179], v251 offset:25600
    ds_read_b64_tr_b16 v[180:181], v250 offset:24576
    ds_read_b64_tr_b16 v[182:183], v250 offset:25600
    s_waitcnt vmcnt(13)
    s_waitcnt lgkmcnt(8)
    v_mfma_f32_32x32x16_bf16 v[112:127], v[192:195], v[40:43], v[112:127]
    s_add_u32 s83, s83, 4096
    buffer_load_dwordx4 v[80:83], v254, s[32:35], s83 offen offset:0 sc1
    ds_read_b64_tr_b16 v[184:185], v251 offset:26624
    v_mfma_f32_32x32x16_bf16 v[128:143], v[196:199], v[40:43], v[128:143]
    ds_read_b64_tr_b16 v[186:187], v251 offset:27648
    ds_read_b64_tr_b16 v[188:189], v250 offset:26624
    ds_read_b64_tr_b16 v[190:191], v250 offset:27648
    s_waitcnt vmcnt(13)
    s_waitcnt lgkmcnt(8)
    v_mfma_f32_32x32x16_bf16 v[112:127], v[200:203], v[44:47], v[112:127]
    buffer_load_dwordx4 v[84:87], v254, s[32:35], s83 offen offset:1024 sc1
    ds_read_b64_tr_b16 v[192:193], v251 offset:28672
    v_mfma_f32_32x32x16_bf16 v[128:143], v[204:207], v[44:47], v[128:143]
    ds_read_b64_tr_b16 v[194:195], v251 offset:29696
    ds_read_b64_tr_b16 v[196:197], v250 offset:28672
    ds_read_b64_tr_b16 v[198:199], v250 offset:29696
    s_waitcnt vmcnt(9)
    s_waitcnt lgkmcnt(8)
    v_mfma_f32_32x32x16_bf16 v[112:127], v[176:179], v[48:51], v[112:127]
    buffer_load_dwordx4 v[88:91], v254, s[32:35], s83 offen offset:2048 sc1
    ds_read_b64_tr_b16 v[200:201], v251 offset:30720
    v_add_f32 v208, v160, v162
    v_add_f32 v209, v161, v163
    v_mfma_f32_32x32x16_bf16 v[128:143], v[180:183], v[48:51], v[128:143]
    ds_read_b64_tr_b16 v[202:203], v251 offset:31744
    ds_read_b64_tr_b16 v[204:205], v250 offset:30720
    ds_read_b64_tr_b16 v[206:207], v250 offset:31744
    v_add_f32 v210, v164, v166
    v_add_f32 v211, v165, v167
    v_add_f32 v212, v168, v170
    s_waitcnt vmcnt(9)
    s_waitcnt lgkmcnt(8)
    v_mfma_f32_32x32x16_bf16 v[112:127], v[184:187], v[52:55], v[112:127]
    buffer_load_dwordx4 v[92:95], v254, s[32:35], s83 offen offset:3072 sc1
    ds_read_b64_tr_b16 v[176:177], v251 offset:32768
    v_add_f32 v213, v169, v171
    v_add_f32 v214, v172, v174
    v_mfma_f32_32x32x16_bf16 v[128:143], v[188:191], v[52:55], v[128:143]
    ds_read_b64_tr_b16 v[178:179], v251 offset:33792
    ds_read_b64_tr_b16 v[180:181], v250 offset:32768
    ds_read_b64_tr_b16 v[182:183], v250 offset:33792
    v_add_f32 v215, v173, v175
    v_add_f32 v208, v208, v210
    v_add_f32 v209, v209, v211
    s_waitcnt vmcnt(9)
    s_waitcnt lgkmcnt(8)
    v_mfma_f32_32x32x16_bf16 v[112:127], v[192:195], v[56:59], v[112:127]
    s_add_u32 s83, s83, 4096
    buffer_load_dwordx4 v[96:99], v254, s[32:35], s83 offen offset:0 sc1
    ds_read_b64_tr_b16 v[184:185], v251 offset:34816
    v_add_f32 v212, v212, v214
    v_add_f32 v213, v213, v215
    v_mfma_f32_32x32x16_bf16 v[128:143], v[196:199], v[56:59], v[128:143]
    ds_read_b64_tr_b16 v[186:187], v251 offset:35840
    ds_read_b64_tr_b16 v[188:189], v250 offset:34816
    ds_read_b64_tr_b16 v[190:191], v250 offset:35840
    v_add_f32 v208, v208, v212
    v_add_f32 v209, v209, v213
    v_mov_b32 v210, v208
    s_waitcnt vmcnt(9)
    s_waitcnt lgkmcnt(8)
    v_mfma_f32_32x32x16_bf16 v[112:127], v[200:203], v[60:63], v[112:127]
    buffer_load_dwordx4 v[100:103], v254, s[32:35], s83 offen offset:1024 sc1
    ds_read_b64_tr_b16 v[192:193], v251 offset:36864
    v_mov_b32 v211, v209
    v_permlane32_swap_b32 v208, v210
    v_mfma_f32_32x32x16_bf16 v[128:143], v[204:207], v[60:63], v[128:143]
    ds_read_b64_tr_b16 v[194:195], v251 offset:37888
    ds_read_b64_tr_b16 v[196:197], v250 offset:36864
    ds_read_b64_tr_b16 v[198:199], v250 offset:37888
    v_permlane32_swap_b32 v209, v211
    v_add_f32 v208, v208, v210
    v_add_f32 v209, v209, v211
    s_waitcnt vmcnt(9)
    s_waitcnt lgkmcnt(8)
    v_mfma_f32_32x32x16_bf16 v[112:127], v[176:179], v[64:67], v[112:127]
    buffer_load_dwordx4 v[104:107], v254, s[32:35], s83 offen offset:2048 sc1
    ds_read_b64_tr_b16 v[200:201], v251 offset:38912
    v_mul_f32 v208, 0xbb124925, v208
    v_mul_f32 v209, 0x3b124925, v209
    v_mfma_f32_32x32x16_bf16 v[128:143], v[180:183], v[64:67], v[128:143]
    ds_read_b64_tr_b16 v[202:203], v251 offset:39936
    ds_read_b64_tr_b16 v[204:205], v250 offset:38912
    ds_read_b64_tr_b16 v[206:207], v250 offset:39936
    v_fma_f32 v209, -v208, v208, v209
    v_max_f32 v209, 0, v209
    v_add_f32 v209, 0x3727c5ac, v209
    s_waitcnt vmcnt(9)
    s_waitcnt lgkmcnt(8)
    buffer_load_dword v238, v228, s[36:39], s82 offen offset:256 sc1
    v_mfma_f32_32x32x16_bf16 v[112:127], v[184:187], v[68:71], v[112:127]
    buffer_load_dwordx4 v[108:111], v254, s[32:35], s83 offen offset:3072 sc1
    ds_read_b64_tr_b16 v[176:177], v251 offset:40960
    v_rcp_f32 v226, v209
    v_sqrt_f32 v209, v209
    v_mfma_f32_32x32x16_bf16 v[128:143], v[188:191], v[68:71], v[128:143]
    ds_read_b64_tr_b16 v[178:179], v251 offset:41984
    ds_read_b64_tr_b16 v[180:181], v250 offset:40960
    ds_read_b64_tr_b16 v[182:183], v250 offset:41984
    v_cvt_pk_bf16_f32 v213, v208, v208
    v_cvt_pk_bf16_f32 v210, v209, v209
    v_and_b32 v211, 0xffff0000, v213
    s_waitcnt vmcnt(10)
    s_waitcnt lgkmcnt(8)
    v_mfma_f32_32x32x16_bf16 v[112:127], v[192:195], v[72:75], v[112:127]
    ds_read_b64_tr_b16 v[184:185], v251 offset:43008
    ds_read_b64_tr_b16 v[186:187], v251 offset:44032
    v_and_b32 v210, 0xffff0000, v210
    v_sub_f32 v211, v208, v211
    v_sub_f32 v212, v209, v210
    v_mfma_f32_32x32x16_bf16 v[128:143], v[196:199], v[72:75], v[128:143]
    ds_read_b64_tr_b16 v[188:189], v250 offset:43008
    ds_read_b64_tr_b16 v[190:191], v250 offset:44032
    v_cvt_pk_bf16_f32 v214, v211, v210
    v_cvt_pk_bf16_f32 v215, v210, v212
    v_cndmask_b32 v216, 0, v213, s[80:81]
    s_waitcnt vmcnt(9)
    s_waitcnt lgkmcnt(8)
    v_mfma_f32_32x32x16_bf16 v[112:127], v[200:203], v[76:79], v[112:127]
    ds_read_b64_tr_b16 v[192:193], v251 offset:45056
    ds_read_b64_tr_b16 v[194:195], v251 offset:46080
    v_cndmask_b32 v219, v213, 0, s[80:81]
    v_cndmask_b32 v217, 0, v214, s[80:81]
    v_cndmask_b32 v220, v214, 0, s[80:81]
    v_mfma_f32_32x32x16_bf16 v[128:143], v[204:207], v[76:79], v[128:143]
    ds_read_b64_tr_b16 v[196:197], v250 offset:45056
    ds_read_b64_tr_b16 v[198:199], v250 offset:46080
    v_cndmask_b32 v218, 0, v215, s[80:81]
    v_cndmask_b32 v221, v215, 0, s[80:81]
    v_accvgpr_write_b32 a240, v216
    s_waitcnt vmcnt(8)
    s_waitcnt lgkmcnt(8)
    v_mfma_f32_32x32x16_bf16 v[112:127], v[176:179], v[80:83], v[112:127]
    ds_read_b64_tr_b16 v[200:201], v251 offset:47104
    ds_read_b64_tr_b16 v[202:203], v251 offset:48128
    v_accvgpr_write_b32 a244, v219
    v_accvgpr_write_b32 a241, v217
    v_accvgpr_write_b32 a245, v220
    v_mfma_f32_32x32x16_bf16 v[128:143], v[180:183], v[80:83], v[128:143]
    ds_read_b64_tr_b16 v[204:205], v250 offset:47104
    ds_read_b64_tr_b16 v[206:207], v250 offset:48128
    v_accvgpr_write_b32 a242, v218
    v_accvgpr_write_b32 a246, v221
    s_mov_b32 s60, 0
L_au:
    v_cmp_ne_u32 vcc, s6, v147
    v_cmp_ne_u32 s[62:63], s6, v151
    s_nop 0
    s_or_b64 vcc, vcc, s[62:63]
    s_cbranch_vccnz L_aur
L_aud:
    s_waitcnt vmcnt(7)
    s_waitcnt lgkmcnt(8)
    v_mfma_f32_32x32x16_bf16 v[112:127], v[184:187], v[84:87], v[112:127]
    ds_read_b64_tr_b16 v[176:177], v251 offset:49152
    ds_read_b64_tr_b16 v[178:179], v251 offset:50176
    v_accvgpr_write_b32 a248, v144
    v_accvgpr_write_b32 a249, v145
    v_accvgpr_write_b32 a250, v146
    v_mfma_f32_32x32x16_bf16 v[128:143], v[188:191], v[84:87], v[128:143]
    ds_read_b64_tr_b16 v[180:181], v250 offset:49152
    ds_read_b64_tr_b16 v[182:183], v250 offset:50176
    v_accvgpr_write_b32 a251, 0
    v_accvgpr_write_b32 a252, v148
    v_accvgpr_write_b32 a253, v149
    s_waitcnt vmcnt(6)
    s_waitcnt lgkmcnt(8)
    v_mfma_f32_32x32x16_bf16 v[112:127], v[192:195], v[88:91], v[112:127]
    ds_read_b64_tr_b16 v[184:185], v251 offset:51200
    ds_read_b64_tr_b16 v[186:187], v251 offset:52224
    v_accvgpr_write_b32 a254, v150
    v_accvgpr_write_b32 a255, 0
    v_mfma_f32_32x32x16_bf16 v[128:143], v[196:199], v[88:91], v[128:143]
    ds_read_b64_tr_b16 v[188:189], v250 offset:51200
    ds_read_b64_tr_b16 v[190:191], v250 offset:52224
    s_waitcnt vmcnt(5)
    s_waitcnt lgkmcnt(8)
    v_mfma_f32_32x32x16_bf16 v[112:127], v[200:203], v[92:95], v[112:127]
    ds_read_b64_tr_b16 v[192:193], v251 offset:53248
    ds_read_b64_tr_b16 v[194:195], v251 offset:54272
    v_mfma_f32_32x32x16_bf16 v[128:143], v[204:207], v[92:95], v[128:143]
    ds_read_b64_tr_b16 v[196:197], v250 offset:53248
    ds_read_b64_tr_b16 v[198:199], v250 offset:54272
    s_waitcnt vmcnt(4)
    s_waitcnt lgkmcnt(8)
    s_waitcnt vmcnt(1)
    v_cmp_ne_u32 vcc, s6, v238
    s_cmp_eq_u32 s7, 0
    s_cbranch_scc1 L_lr25
    s_cbranch_vccnz L_lr25
L_lj26:
    v_mfma_f32_32x32x16_bf16 v[112:127], v[176:179], v[96:99], v[112:127]
    s_add_u32 s83, s83, 90112
    buffer_load_dwordx4 a[0:3], v254, s[32:35], s83 offen offset:0 sc1
    ds_read_b64_tr_b16 v[200:201], v251 offset:55296
    v_mfma_f32_32x32x16_bf16 v[128:143], v[180:183], v[96:99], v[128:143]
    ds_read_b64_tr_b16 v[202:203], v251 offset:56320
    ds_read_b64_tr_b16 v[204:205], v250 offset:55296
    ds_read_b64_tr_b16 v[206:207], v250 offset:56320
    s_waitcnt lgkmcnt(8)
    v_mfma_f32_32x32x16_bf16 v[112:127], v[184:187], v[100:103], v[112:127]
    buffer_load_dwordx4 a[4:7], v254, s[32:35], s83 offen offset:1024 sc1
    v_mfma_f32_32x32x16_bf16 v[128:143], v[188:191], v[100:103], v[128:143]
    s_waitcnt lgkmcnt(4)
    v_mfma_f32_32x32x16_bf16 v[112:127], v[192:195], v[104:107], v[112:127]
    buffer_load_dwordx4 a[8:11], v254, s[32:35], s83 offen offset:2048 sc1
    v_mfma_f32_32x32x16_bf16 v[128:143], v[196:199], v[104:107], v[128:143]
    s_waitcnt vmcnt(3)
    s_waitcnt lgkmcnt(0)
    v_mfma_f32_32x32x16_bf16 v[112:127], v[200:203], v[108:111], v[112:127]
    buffer_load_dwordx4 a[12:15], v254, s[32:35], s83 offen offset:3072 sc1
    v_mfma_f32_32x32x16_bf16 v[128:143], v[204:207], v[108:111], v[128:143]
    v_mfma_f32_32x32x16_bf16 v[112:127], a[248:251], a[240:243], v[112:127]
    v_mfma_f32_32x32x16_bf16 v[128:143], a[248:251], a[244:247], v[128:143]
    buffer_store_dword v226, v241, s[36:39], s84 offen sc1
    v_mfma_f32_32x32x16_bf16 v[144:159], a[168:171], v[0:3], 0
    s_add_u32 s83, s83, 4096
    buffer_load_dwordx4 a[16:19], v254, s[32:35], s83 offen offset:0 sc1
    v_mfma_f32_32x32x16_bf16 v[160:175], a[172:175], v[0:3], 0
    s_xor_b32 s86, s88, 0
    s_nop 4
L_sb11:
    s_cbranch_execz L_wzb
    v_mul_f32 v112, v112, abs(v112)
    v_mul_f32 v113, v113, abs(v113)
    v_cvt_pk_bf16_f32 v208, v112, v113
    v_pk_max_i16 v208, v208, 0
    v_mul_f32 v114, v114, abs(v114)
    v_mul_f32 v115, v115, abs(v115)
    v_mfma_f32_32x32x16_bf16 v[144:159], a[176:179], v[4:7], v[144:159]
    v_cvt_pk_bf16_f32 v209, v114, v115
    v_pk_max_i16 v209, v209, 0
    v_mul_f32 v116, v116, abs(v116)
    v_mul_f32 v117, v117, abs(v117)
    v_cvt_pk_bf16_f32 v210, v116, v117
    v_pk_max_i16 v210, v210, 0
    v_mul_f32 v118, v118, abs(v118)
    v_mfma_f32_32x32x16_bf16 v[160:175], a[180:183], v[4:7], v[160:175]
    v_mul_f32 v119, v119, abs(v119)
    v_cvt_pk_bf16_f32 v211, v118, v119
    v_pk_max_i16 v211, v211, 0
    buffer_store_dwordx4 v[208:211], v254, s[36:39], s86 offen offset:0 sc1
    v_mul_f32 v120, v120, abs(v120)
    v_mul_f32 v121, v121, abs(v121)
    v_cvt_pk_bf16_f32 v212, v120, v121
    v_mfma_f32_32x32x16_bf16 v[144:159], a[184:187], v[8:11], v[144:159]
    v_pk_max_i16 v212, v212, 0
    v_mul_f32 v122, v122, abs(v122)
    v_mul_f32 v123, v123, abs(v123)
    v_cvt_pk_bf16_f32 v213, v122, v123
    v_pk_max_i16 v213, v213, 0
    v_mul_f32 v124, v124, abs(v124)
    v_mul_f32 v125, v125, abs(v125)
    v_mfma_f32_32x32x16_bf16 v[160:175], a[188:191], v[8:11], v[160:175]
    v_cvt_pk_bf16_f32 v214, v124, v125
    v_pk_max_i16 v214, v214, 0
    v_mul_f32 v126, v126, abs(v126)
    v_mul_f32 v127, v127, abs(v127)
    v_cvt_pk_bf16_f32 v215, v126, v127
    v_pk_max_i16 v215, v215, 0
    buffer_store_dwordx4 v[212:215], v254, s[36:39], s86 offen offset:1024 sc1
    v_mfma_f32_32x32x16_bf16 v[144:159], a[192:195], v[12:15], v[144:159]
    v_mul_f32 v128, v128, abs(v128)
    v_mul_f32 v129, v129, abs(v129)
    v_cvt_pk_bf16_f32 v216, v128, v129
    v_pk_max_i16 v216, v216, 0
    v_mul_f32 v130, v130, abs(v130)
    v_mul_f32 v131, v131, abs(v131)
    v_cvt_pk_bf16_f32 v217, v130, v131
    v_mfma_f32_32x32x16_bf16 v[160:175], a[196:199], v[12:15], v[160:175]
    v_pk_max_i16 v217, v217, 0
    v_mul_f32 v132, v132, abs(v132)
    v_mul_f32 v133, v133, abs(v133)
    v_cvt_pk_bf16_f32 v218, v132, v133
    v_pk_max_i16 v218, v218, 0
    v_mul_f32 v134, v134, abs(v134)
    v_mul_f32 v135, v135, abs(v135)
    v_mfma_f32_32x32x16_bf16 v[144:159], a[200:203], v[16:19], v[144:159]
    ds_read_b64_tr_b16 v[200:201], v239 offset:14336
    ds_read_b64_tr_b16 v[202:203], v239 offset:15360
    v_cvt_pk_bf16_f32 v219, v134, v135
    v_pk_max_i16 v219, v219, 0
    buffer_store_dwordx4 v[216:219], v254, s[36:39], s86 offen offset:2048 sc1
    v_mul_f32 v136, v136, abs(v136)
    v_mul_f32 v137, v137, abs(v137)
    v_cvt_pk_bf16_f32 v220, v136, v137
    v_mfma_f32_32x32x16_bf16 v[160:175], a[204:207], v[16:19], v[160:175]
    ds_read_b64_tr_b16 v[204:205], v240 offset:14336
    ds_read_b64_tr_b16 v[206:207], v240 offset:15360
    v_pk_max_i16 v220, v220, 0
    v_mul_f32 v138, v138, abs(v138)
    v_mul_f32 v139, v139, abs(v139)
    v_cvt_pk_bf16_f32 v221, v138, v139
    v_pk_max_i16 v221, v221, 0
    v_mul_f32 v140, v140, abs(v140)
    v_mfma_f32_32x32x16_bf16 v[144:159], a[208:211], v[20:23], v[144:159]
    ds_read_b64_tr_b16 v[176:177], v239 offset:16384
    ds_read_b64_tr_b16 v[178:179], v239 offset:17408
    v_mul_f32 v141, v141, abs(v141)
    v_cvt_pk_bf16_f32 v222, v140, v141
    v_pk_max_i16 v222, v222, 0
    v_mul_f32 v142, v142, abs(v142)
    v_mul_f32 v143, v143, abs(v143)
    v_cvt_pk_bf16_f32 v223, v142, v143
    v_mfma_f32_32x32x16_bf16 v[160:175], a[212:215], v[20:23], v[160:175]
    ds_read_b64_tr_b16 v[180:181], v240 offset:16384
    ds_read_b64_tr_b16 v[182:183], v240 offset:17408
    v_pk_max_i16 v223, v223, 0
    buffer_store_dwordx4 v[220:223], v254, s[36:39], s86 offen offset:3072 sc1
    v_mfma_f32_32x32x16_bf16 v[144:159], a[216:219], v[24:27], v[144:159]
    buffer_load_dwordx4 a[20:23], v254, s[32:35], s83 offen offset:1024 sc1
    ds_read_b64_tr_b16 v[184:185], v239 offset:18432
    v_mfma_f32_32x32x16_bf16 v[160:175], a[220:223], v[24:27], v[160:175]
    ds_read_b64_tr_b16 v[186:187], v239 offset:19456
    ds_read_b64_tr_b16 v[188:189], v240 offset:18432
    ds_read_b64_tr_b16 v[190:191], v240 offset:19456
    s_waitcnt lgkmcnt(8)
    v_mfma_f32_32x32x16_bf16 v[144:159], v[200:203], v[28:31], v[144:159]
    buffer_load_dwordx4 a[24:27], v254, s[32:35], s83 offen offset:2048 sc1
    ds_read_b64_tr_b16 v[192:193], v239 offset:20480
    v_mfma_f32_32x32x16_bf16 v[160:175], v[204:207], v[28:31], v[160:175]
    ds_read_b64_tr_b16 v[194:195], v239 offset:21504
    ds_read_b64_tr_b16 v[196:197], v240 offset:20480
    ds_read_b64_tr_b16 v[198:199], v240 offset:21504
    s_waitcnt lgkmcnt(8)
    v_mfma_f32_32x32x16_bf16 v[144:159], v[176:179], v[32:35], v[144:159]
    buffer_load_dwordx4 a[28:31], v254, s[32:35], s83 offen offset:3072 sc1
    ds_read_b64_tr_b16 v[200:201], v239 offset:22528
    v_mfma_f32_32x32x16_bf16 v[160:175], v[180:183], v[32:35], v[160:175]
    ds_read_b64_tr_b16 v[202:203], v239 offset:23552
    ds_read_b64_tr_b16 v[204:205], v240 offset:22528
    ds_read_b64_tr_b16 v[206:207], v240 offset:23552
    s_waitcnt lgkmcnt(8)
    v_mfma_f32_32x32x16_bf16 v[144:159], v[184:187], v[36:39], v[144:159]
    s_add_u32 s83, s83, 4096
    buffer_load_dwordx4 a[32:35], v254, s[32:35], s83 offen offset:0 sc1
    ds_read_b64_tr_b16 v[176:177], v239 offset:24576
    v_mfma_f32_32x32x16_bf16 v[160:175], v[188:191], v[36:39], v[160:175]
    ds_read_b64_tr_b16 v[178:179], v239 offset:25600
    ds_read_b64_tr_b16 v[180:181], v240 offset:24576
    ds_read_b64_tr_b16 v[182:183], v240 offset:25600
    s_waitcnt lgkmcnt(8)
    v_mfma_f32_32x32x16_bf16 v[144:159], v[192:195], v[40:43], v[144:159]
    buffer_load_dwordx4 a[36:39], v254, s[32:35], s83 offen offset:1024 sc1
    ds_read_b64_tr_b16 v[184:185], v239 offset:26624
    v_mfma_f32_32x32x16_bf16 v[160:175], v[196:199], v[40:43], v[160:175]
    ds_read_b64_tr_b16 v[186:187], v239 offset:27648
    ds_read_b64_tr_b16 v[188:189], v240 offset:26624
    ds_read_b64_tr_b16 v[190:191], v240 offset:27648
    s_waitcnt lgkmcnt(8)
    v_mfma_f32_32x32x16_bf16 v[144:159], v[200:203], v[44:47], v[144:159]
    buffer_load_dwordx4 a[40:43], v254, s[32:35], s83 offen offset:2048 sc1
    ds_read_b64_tr_b16 v[192:193], v239 offset:28672
    v_mfma_f32_32x32x16_bf16 v[160:175], v[204:207], v[44:47], v[160:175]
    ds_read_b64_tr_b16 v[194:195], v239 offset:29696
    ds_read_b64_tr_b16 v[196:197], v240 offset:28672
    ds_read_b64_tr_b16 v[198:199], v240 offset:29696
    s_waitcnt lgkmcnt(8)
    v_mfma_f32_32x32x16_bf16 v[144:159], v[176:179], v[48:51], v[144:159]
    buffer_load_dwordx4 a[44:47], v254, s[32:35], s83 offen offset:3072 sc1
    ds_read_b64_tr_b16 v[200:201], v239 offset:30720
    v_mfma_f32_32x32x16_bf16 v[160:175], v[180:183], v[48:51], v[160:175]
    ds_read_b64_tr_b16 v[202:203], v239 offset:31744
    ds_read_b64_tr_b16 v[204:205], v240 offset:30720
    ds_read_b64_tr_b16 v[206:207], v240 offset:31744
    s_waitcnt lgkmcnt(8)
    v_mfma_f32_32x32x16_bf16 v[144:159], v[184:187], v[52:55], v[144:159]
    s_add_u32 s83, s83, 4096
    buffer_load_dwordx4 a[48:51], v254, s[32:35], s83 offen offset:0 sc1
    ds_read_b64_tr_b16 v[176:177], v239 offset:32768
    v_mfma_f32_32x32x16_bf16 v[160:175], v[188:191], v[52:55], v[160:175]
    ds_read_b64_tr_b16 v[178:179], v239 offset:33792
    ds_read_b64_tr_b16 v[180:181], v240 offset:32768
    ds_read_b64_tr_b16 v[182:183], v240 offset:33792
    s_waitcnt lgkmcnt(8)
    v_mfma_f32_32x32x16_bf16 v[144:159], v[192:195], v[56:59], v[144:159]
    buffer_load_dwordx4 a[52:55], v254, s[32:35], s83 offen offset:1024 sc1
    ds_read_b64_tr_b16 v[184:185], v239 offset:34816
    v_mfma_f32_32x32x16_bf16 v[160:175], v[196:199], v[56:59], v[160:175]
    ds_read_b64_tr_b16 v[186:187], v239 offset:35840
    ds_read_b64_tr_b16 v[188:189], v240 offset:34816
    ds_read_b64_tr_b16 v[190:191], v240 offset:35840
    s_waitcnt vmcnt(9)
    s_add_u32 s79, s85, 0
    s_mov_b64 exec, 1
    s_cmp_eq_u32 s7, 0
    s_cbranch_scc1 L_fs27
    buffer_store_dword v245, off, s[36:39], s79
L_fj28:
    s_mov_b64 exec, -1
    s_waitcnt lgkmcnt(8)
    v_mfma_f32_32x32x16_bf16 v[144:159], v[200:203], v[60:63], v[144:159]
    buffer_load_dwordx4 a[56:59], v254, s[32:35], s83 offen offset:2048 sc1
    ds_read_b64_tr_b16 v[192:193], v239 offset:36864
    v_mfma_f32_32x32x16_bf16 v[160:175], v[204:207], v[60:63], v[160:175]
    ds_read_b64_tr_b16 v[194:195], v239 offset:37888
    ds_read_b64_tr_b16 v[196:197], v240 offset:36864
    ds_read_b64_tr_b16 v[198:199], v240 offset:37888
    s_waitcnt lgkmcnt(8)
    v_mfma_f32_32x32x16_bf16 v[144:159], v[176:179], v[64:67], v[144:159]
    buffer_load_dwordx4 a[60:63], v254, s[32:35], s83 offen offset:3072 sc1
    ds_read_b64_tr_b16 v[200:201], v239 offset:38912
    v_mfma_f32_32x32x16_bf16 v[160:175], v[180:183], v[64:67], v[160:175]
    ds_read_b64_tr_b16 v[202:203], v239 offset:39936
    ds_read_b64_tr_b16 v[204:205], v240 offset:38912
    ds_read_b64_tr_b16 v[206:207], v240 offset:39936
    s_waitcnt lgkmcnt(8)
    v_mfma_f32_32x32x16_bf16 v[144:159], v[184:187], v[68:71], v[144:159]
    s_add_u32 s87, s87, 14336
    buffer_load_dwordx4 v[0:3], v229, s[36:39], s87 offen offset:0 sc1
    ds_read_b64_tr_b16 v[176:177], v239 offset:40960
    v_mfma_f32_32x32x16_bf16 v[160:175], v[188:191], v[68:71], v[160:175]
    ds_read_b64_tr_b16 v[178:179], v239 offset:41984
    ds_read_b64_tr_b16 v[180:181], v240 offset:40960
    ds_read_b64_tr_b16 v[182:183], v240 offset:41984
    s_waitcnt lgkmcnt(8)
    v_mfma_f32_32x32x16_bf16 v[144:159], v[192:195], v[72:75], v[144:159]
    buffer_load_dwordx4 v[4:7], v229, s[36:39], s87 offen offset:512 sc1
    ds_read_b64_tr_b16 v[184:185], v239 offset:43008
    v_mfma_f32_32x32x16_bf16 v[160:175], v[196:199], v[72:75], v[160:175]
    ds_read_b64_tr_b16 v[186:187], v239 offset:44032
    ds_read_b64_tr_b16 v[188:189], v240 offset:43008
    ds_read_b64_tr_b16 v[190:191], v240 offset:44032
    s_waitcnt lgkmcnt(8)
    v_mfma_f32_32x32x16_bf16 v[144:159], v[200:203], v[76:79], v[144:159]
    buffer_load_dwordx4 v[8:11], v229, s[36:39], s87 offen offset:1024 sc1
    ds_read_b64_tr_b16 v[192:193], v239 offset:45056
    v_mfma_f32_32x32x16_bf16 v[160:175], v[204:207], v[76:79], v[160:175]
    ds_read_b64_tr_b16 v[194:195], v239 offset:46080
    ds_read_b64_tr_b16 v[196:197], v240 offset:45056
    ds_read_b64_tr_b16 v[198:199], v240 offset:46080
    s_waitcnt lgkmcnt(8)
    v_mfma_f32_32x32x16_bf16 v[144:159], v[176:179], v[80:83], v[144:159]
    buffer_load_dwordx4 v[12:15], v230, s[36:39], s87 offen offset:1536 sc1
    ds_read_b64_tr_b16 v[200:201], v239 offset:47104
    v_mfma_f32_32x32x16_bf16 v[160:175], v[180:183], v[80:83], v[160:175]
    ds_read_b64_tr_b16 v[202:203], v239 offset:48128
    ds_read_b64_tr_b16 v[204:205], v240 offset:47104
    ds_read_b64_tr_b16 v[206:207], v240 offset:48128
    s_waitcnt lgkmcnt(8)
    v_mfma_f32_32x32x16_bf16 v[144:159], v[184:187], v[84:87], v[144:159]
    s_add_u32 s83, s83, 4096
    buffer_load_dwordx4 a[64:67], v254, s[32:35], s83 offen offset:0 sc1
    ds_read_b64_tr_b16 v[176:177], v239 offset:49152
    v_mfma_f32_32x32x16_bf16 v[160:175], v[188:191], v[84:87], v[160:175]
    ds_read_b64_tr_b16 v[178:179], v239 offset:50176
    ds_read_b64_tr_b16 v[180:181], v240 offset:49152
    ds_read_b64_tr_b16 v[182:183], v240 offset:50176
    s_waitcnt lgkmcnt(8)
    v_mfma_f32_32x32x16_bf16 v[144:159], v[192:195], v[88:91], v[144:159]
    buffer_load_dwordx4 a[68:71], v254, s[32:35], s83 offen offset:1024 sc1
    ds_read_b64_tr_b16 v[184:185], v239 offset:51200
    v_mfma_f32_32x32x16_bf16 v[160:175], v[196:199], v[88:91], v[160:175]
    ds_read_b64_tr_b16 v[186:187], v239 offset:52224
    ds_read_b64_tr_b16 v[188:189], v240 offset:51200
    ds_read_b64_tr_b16 v[190:191], v240 offset:52224
    s_waitcnt lgkmcnt(8)
    v_mfma_f32_32x32x16_bf16 v[144:159], v[200:203], v[92:95], v[144:159]
    buffer_load_dwordx4 a[72:75], v254, s[32:35], s83 offen offset:2048 sc1
    ds_read_b64_tr_b16 v[192:193], v239 offset:53248
    v_mfma_f32_32x32x16_bf16 v[160:175], v[204:207], v[92:95], v[160:175]
    ds_read_b64_tr_b16 v[194:195], v239 offset:54272
    ds_read_b64_tr_b16 v[196:197], v240 offset:53248
    ds_read_b64_tr_b16 v[198:199], v240 offset:54272
    s_waitcnt lgkmcnt(8)
    v_mfma_f32_32x32x16_bf16 v[144:159], v[176:179], v[96:99], v[144:159]
    buffer_load_dwordx4 a[76:79], v254, s[32:35], s83 offen offset:3072 sc1
    ds_read_b64_tr_b16 v[200:201], v239 offset:55296
    v_mfma_f32_32x32x16_bf16 v[160:175], v[180:183], v[96:99], v[160:175]
    ds_read_b64_tr_b16 v[202:203], v239 offset:56320
    ds_read_b64_tr_b16 v[204:205], v240 offset:55296
    ds_read_b64_tr_b16 v[206:207], v240 offset:56320
    s_waitcnt lgkmcnt(8)
    v_mfma_f32_32x32x16_bf16 v[144:159], v[184:187], v[100:103], v[144:159]
    s_add_u32 s83, s83, 4096
    buffer_load_dwordx4 a[80:83], v254, s[32:35], s83 offen offset:0 sc1
    v_mfma_f32_32x32x16_bf16 v[160:175], v[188:191], v[100:103], v[160:175]
    s_waitcnt lgkmcnt(4)
    v_mfma_f32_32x32x16_bf16 v[144:159], v[192:195], v[104:107], v[144:159]
    buffer_load_dwordx4 a[84:87], v254, s[32:35], s83 offen offset:1024 sc1
    v_mfma_f32_32x32x16_bf16 v[160:175], v[196:199], v[104:107], v[160:175]
    s_waitcnt lgkmcnt(0)
    v_mfma_f32_32x32x16_bf16 v[144:159], v[200:203], v[108:111], v[144:159]
    buffer_load_dwordx4 a[88:91], v254, s[32:35], s83 offen offset:2048 sc1
    v_mfma_f32_32x32x16_bf16 v[160:175], v[204:207], v[108:111], v[160:175]
    v_mfma_f32_32x32x16_bf16 v[144:159], a[252:255], a[240:243], v[144:159]
    v_mfma_f32_32x32x16_bf16 v[160:175], a[252:255], a[244:247], v[160:175]
    v_mfma_f32_32x32x16_bf16 v[112:127], a[112:115], a[0:3], 0
    buffer_load_dwordx4 a[92:95], v254, s[32:35], s83 offen offset:3072 sc1
    v_mfma_f32_32x32x16_bf16 v[128:143], a[116:119], a[0:3], 0
    s_xor_b32 s86, s88, 4096
    s_nop 6
    v_mul_f32 v144, v144, abs(v144)
    v_mul_f32 v145, v145, abs(v145)
    v_cvt_pk_bf16_f32 v208, v144, v145
    v_pk_max_i16 v208, v208, 0
    v_mul_f32 v146, v146, abs(v146)
    v_mul_f32 v147, v147, abs(v147)
    v_mfma_f32_32x32x16_bf16 v[112:127], a[120:123], a[4:7], v[112:127]
    s_add_u32 s83, s83, 4096
    buffer_load_dwordx4 a[96:99], v254, s[32:35], s83 offen offset:0 sc1
    v_cvt_pk_bf16_f32 v209, v146, v147
    v_pk_max_i16 v209, v209, 0
    v_mul_f32 v148, v148, abs(v148)
    v_mul_f32 v149, v149, abs(v149)
    v_cvt_pk_bf16_f32 v210, v148, v149
    v_pk_max_i16 v210, v210, 0
    v_mfma_f32_32x32x16_bf16 v[128:143], a[124:127], a[4:7], v[128:143]
    v_mul_f32 v150, v150, abs(v150)
    v_mul_f32 v151, v151, abs(v151)
    v_cvt_pk_bf16_f32 v211, v150, v151
    v_pk_max_i16 v211, v211, 0
    buffer_store_dwordx4 v[208:211], v254, s[36:39], s86 offen offset:0 sc1
    v_mul_f32 v152, v152, abs(v152)
    v_mul_f32 v153, v153, abs(v153)
    v_mfma_f32_32x32x16_bf16 v[112:127], a[128:131], a[8:11], v[112:127]
    buffer_load_dwordx4 a[100:103], v254, s[32:35], s83 offen offset:1024 sc1
    v_cvt_pk_bf16_f32 v212, v152, v153
    v_pk_max_i16 v212, v212, 0
    v_mul_f32 v154, v154, abs(v154)
    v_mul_f32 v155, v155, abs(v155)
    v_cvt_pk_bf16_f32 v213, v154, v155
    v_pk_max_i16 v213, v213, 0
    v_mfma_f32_32x32x16_bf16 v[128:143], a[132:135], a[8:11], v[128:143]
    v_mul_f32 v156, v156, abs(v156)
    v_mul_f32 v157, v157, abs(v157)
    v_cvt_pk_bf16_f32 v214, v156, v157
    v_pk_max_i16 v214, v214, 0
    v_mul_f32 v158, v158, abs(v158)
    v_mul_f32 v159, v159, abs(v159)
    v_cvt_pk_bf16_f32 v215, v158, v159
    v_mfma_f32_32x32x16_bf16 v[112:127], a[136:139], a[12:15], v[112:127]
    buffer_load_dwordx4 a[104:107], v254, s[32:35], s83 offen offset:2048 sc1
    v_pk_max_i16 v215, v215, 0
    buffer_store_dwordx4 v[212:215], v254, s[36:39], s86 offen offset:1024 sc1
    v_mul_f32 v160, v160, abs(v160)
    v_mul_f32 v161, v161, abs(v161)
    v_cvt_pk_bf16_f32 v216, v160, v161
    v_pk_max_i16 v216, v216, 0
    v_mfma_f32_32x32x16_bf16 v[128:143], a[140:143], a[12:15], v[128:143]
    v_mul_f32 v162, v162, abs(v162)
    v_mul_f32 v163, v163, abs(v163)
    v_cvt_pk_bf16_f32 v217, v162, v163
    v_pk_max_i16 v217, v217, 0
    v_mul_f32 v164, v164, abs(v164)
    v_mul_f32 v165, v165, abs(v165)
    v_cvt_pk_bf16_f32 v218, v164, v165
    v_mfma_f32_32x32x16_bf16 v[112:127], a[144:147], a[16:19], v[112:127]
    buffer_load_dwordx4 a[108:111], v254, s[32:35], s83 offen offset:3072 sc1
    ds_read_b64_tr_b16 v[200:201], v251 offset:14336
    v_pk_max_i16 v218, v218, 0
    v_mul_f32 v166, v166, abs(v166)
    v_mul_f32 v167, v167, abs(v167)
    v_cvt_pk_bf16_f32 v219, v166, v167
    v_pk_max_i16 v219, v219, 0
    v_mfma_f32_32x32x16_bf16 v[128:143], a[148:151], a[16:19], v[128:143]
    ds_read_b64_tr_b16 v[202:203], v251 offset:15360
    ds_read_b64_tr_b16 v[204:205], v250 offset:14336
    ds_read_b64_tr_b16 v[206:207], v250 offset:15360
    buffer_store_dwordx4 v[216:219], v254, s[36:39], s86 offen offset:2048 sc1
    v_mul_f32 v168, v168, abs(v168)
    v_mul_f32 v169, v169, abs(v169)
    v_cvt_pk_bf16_f32 v220, v168, v169
    v_pk_max_i16 v220, v220, 0
    v_mul_f32 v170, v170, abs(v170)
    s_waitcnt vmcnt(30)
    v_mfma_f32_32x32x16_bf16 v[112:127], a[152:155], a[20:23], v[112:127]
    ds_read_b64_tr_b16 v[176:177], v251 offset:16384
    ds_read_b64_tr_b16 v[178:179], v251 offset:17408
    v_mul_f32 v171, v171, abs(v171)
    v_cvt_pk_bf16_f32 v221, v170, v171
    v_pk_max_i16 v221, v221, 0
    v_mul_f32 v172, v172, abs(v172)
    v_mul_f32 v173, v173, abs(v173)
    v_cvt_pk_bf16_f32 v222, v172, v173
    v_mfma_f32_32x32x16_bf16 v[128:143], a[156:159], a[20:23], v[128:143]
    ds_read_b64_tr_b16 v[180:181], v250 offset:16384
    ds_read_b64_tr_b16 v[182:183], v250 offset:17408
    v_pk_max_i16 v222, v222, 0
    v_mul_f32 v174, v174, abs(v174)
    v_mul_f32 v175, v175, abs(v175)
    v_cvt_pk_bf16_f32 v223, v174, v175
    v_pk_max_i16 v223, v223, 0
    buffer_store_dwordx4 v[220:223], v254, s[36:39], s86 offen offset:3072 sc1
    s_waitcnt vmcnt(30)
    v_mfma_f32_32x32x16_bf16 v[112:127], a[160:163], a[24:27], v[112:127]
    ds_read_b64_tr_b16 v[184:185], v251 offset:18432
    ds_read_b64_tr_b16 v[186:187], v251 offset:19456
    v_mfma_f32_32x32x16_bf16 v[128:143], a[164:167], a[24:27], v[128:143]
    ds_read_b64_tr_b16 v[188:189], v250 offset:18432
    ds_read_b64_tr_b16 v[190:191], v250 offset:19456
    s_waitcnt vmcnt(29)
    s_waitcnt lgkmcnt(8)
    v_mfma_f32_32x32x16_bf16 v[112:127], v[200:203], a[28:31], v[112:127]
    ds_read_b64_tr_b16 v[192:193], v251 offset:20480
    ds_read_b64_tr_b16 v[194:195], v251 offset:21504
    v_mfma_f32_32x32x16_bf16 v[128:143], v[204:207], a[28:31], v[128:143]
    ds_read_b64_tr_b16 v[196:197], v250 offset:20480
    ds_read_b64_tr_b16 v[198:199], v250 offset:21504
    s_waitcnt vmcnt(28)
    s_waitcnt lgkmcnt(8)
    v_mfma_f32_32x32x16_bf16 v[112:127], v[176:179], a[32:35], v[112:127]
    ds_read_b64_tr_b16 v[200:201], v251 offset:22528
    ds_read_b64_tr_b16 v[202:203], v251 offset:23552
    v_mfma_f32_32x32x16_bf16 v[128:143], v[180:183], a[32:35], v[128:143]
    ds_read_b64_tr_b16 v[204:205], v250 offset:22528
    ds_read_b64_tr_b16 v[206:207], v250 offset:23552
    s_waitcnt vmcnt(27)
    s_waitcnt lgkmcnt(8)
    v_mfma_f32_32x32x16_bf16 v[112:127], v[184:187], a[36:39], v[112:127]
    ds_read_b64_tr_b16 v[176:177], v251 offset:24576
    ds_read_b64_tr_b16 v[178:179], v251 offset:25600
    v_mfma_f32_32x32x16_bf16 v[128:143], v[188:191], a[36:39], v[128:143]
    ds_read_b64_tr_b16 v[180:181], v250 offset:24576
    ds_read_b64_tr_b16 v[182:183], v250 offset:25600
    s_waitcnt vmcnt(26)
    s_waitcnt lgkmcnt(8)
    v_mfma_f32_32x32x16_bf16 v[112:127], v[192:195], a[40:43], v[112:127]
    ds_read_b64_tr_b16 v[184:185], v251 offset:26624
    ds_read_b64_tr_b16 v[186:187], v251 offset:27648
    v_mfma_f32_32x32x16_bf16 v[128:143], v[196:199], a[40:43], v[128:143]
    ds_read_b64_tr_b16 v[188:189], v250 offset:26624
    ds_read_b64_tr_b16 v[190:191], v250 offset:27648
    s_waitcnt vmcnt(25)
    s_waitcnt lgkmcnt(8)
    s_waitcnt vmcnt(16)
    v_mfma_f32_32x32x16_bf16 v[112:127], v[200:203], a[44:47], v[112:127]
    ds_read_b64_tr_b16 v[192:193], v251 offset:28672
    ds_read_b64_tr_b16 v[194:195], v251 offset:29696
    v_add_f32 v208, v0, v2
    v_add_f32 v209, v1, v3
    v_add_f32 v210, v4, v6
    v_mfma_f32_32x32x16_bf16 v[128:143], v[204:207], a[44:47], v[128:143]
    ds_read_b64_tr_b16 v[196:197], v250 offset:28672
    ds_read_b64_tr_b16 v[198:199], v250 offset:29696
    v_add_f32 v211, v5, v7
    v_add_f32 v212, v8, v10
    v_add_f32 v213, v9, v11
    s_waitcnt lgkmcnt(8)
    v_mfma_f32_32x32x16_bf16 v[112:127], v[176:179], a[48:51], v[112:127]
    ds_read_b64_tr_b16 v[200:201], v251 offset:30720
    ds_read_b64_tr_b16 v[202:203], v251 offset:31744
    v_add_f32 v214, v12, v14
    v_add_f32 v215, v13, v15
    v_add_f32 v208, v208, v210
    v_mfma_f32_32x32x16_bf16 v[128:143], v[180:183], a[48:51], v[128:143]
    ds_read_b64_tr_b16 v[204:205], v250 offset:30720
    ds_read_b64_tr_b16 v[206:207], v250 offset:31744
    v_add_f32 v209, v209, v211
    v_add_f32 v212, v212, v214
    v_add_f32 v213, v213, v215
    s_waitcnt lgkmcnt(8)
    v_mfma_f32_32x32x16_bf16 v[112:127], v[184:187], a[52:55], v[112:127]
    ds_read_b64_tr_b16 v[176:177], v251 offset:32768
    ds_read_b64_tr_b16 v[178:179], v251 offset:33792
    v_add_f32 v208, v208, v212
    v_add_f32 v209, v209, v213
    v_mov_b32 v210, v208
    v_mfma_f32_32x32x16_bf16 v[128:143], v[188:191], a[52:55], v[128:143]
    ds_read_b64_tr_b16 v[180:181], v250 offset:32768
    ds_read_b64_tr_b16 v[182:183], v250 offset:33792
    v_mov_b32 v211, v209
    v_permlane32_swap_b32 v208, v210
    s_nop 0
    v_permlane32_swap_b32 v209, v211
    s_waitcnt lgkmcnt(8)
    v_mfma_f32_32x32x16_bf16 v[112:127], v[192:195], a[56:59], v[112:127]
    ds_read_b64_tr_b16 v[184:185], v251 offset:34816
    ds_read_b64_tr_b16 v[186:187], v251 offset:35840
    v_add_f32 v208, v208, v210
    v_add_f32 v209, v209, v211
    v_mul_f32 v208, 0xbb124925, v208
    v_mfma_f32_32x32x16_bf16 v[128:143], v[196:199], a[56:59], v[128:143]
    ds_read_b64_tr_b16 v[188:189], v250 offset:34816
    ds_read_b64_tr_b16 v[190:191], v250 offset:35840
    v_mul_f32 v209, 0x3b124925, v209
    v_fma_f32 v209, -v208, v208, v209
    v_max_f32 v209, 0, v209
    s_waitcnt vmcnt(0)
    s_add_u32 s79, s85, 64
    s_mov_b64 exec, 1
    s_cmp_eq_u32 s7, 0
    s_cbranch_scc1 L_fs29
    buffer_store_dword v245, off, s[36:39], s79
L_fj30:
    s_mov_b64 exec, -1
    buffer_load_dword v246, v242, s[36:39], s86 offen sc1
    s_waitcnt lgkmcnt(8)
    v_mfma_f32_32x32x16_bf16 v[112:127], v[200:203], a[60:63], v[112:127]
    ds_read_b64_tr_b16 v[192:193], v251 offset:36864
    ds_read_b64_tr_b16 v[194:195], v251 offset:37888
    v_add_f32 v209, 0x3727c5ac, v209
    v_rcp_f32 v227, v209
    v_sqrt_f32 v209, v209
    v_mfma_f32_32x32x16_bf16 v[128:143], v[204:207], a[60:63], v[128:143]
    ds_read_b64_tr_b16 v[196:197], v250 offset:36864
    ds_read_b64_tr_b16 v[198:199], v250 offset:37888
    v_cvt_pk_bf16_f32 v213, v208, v208
    v_cvt_pk_bf16_f32 v210, v209, v209
    v_and_b32 v211, 0xffff0000, v213
    s_waitcnt lgkmcnt(8)
    v_mfma_f32_32x32x16_bf16 v[112:127], v[176:179], a[64:67], v[112:127]
    ds_read_b64_tr_b16 v[200:201], v251 offset:38912
    ds_read_b64_tr_b16 v[202:203], v251 offset:39936
    v_and_b32 v210, 0xffff0000, v210
    v_sub_f32 v211, v208, v211
    v_sub_f32 v212, v209, v210
    v_mfma_f32_32x32x16_bf16 v[128:143], v[180:183], a[64:67], v[128:143]
    ds_read_b64_tr_b16 v[204:205], v250 offset:38912
    ds_read_b64_tr_b16 v[206:207], v250 offset:39936
    v_cvt_pk_bf16_f32 v214, v211, v210
    v_cvt_pk_bf16_f32 v215, v210, v212
    v_cndmask_b32 v216, 0, v213, s[80:81]
    s_waitcnt lgkmcnt(8)
    v_mfma_f32_32x32x16_bf16 v[112:127], v[184:187], a[68:71], v[112:127]
    ds_read_b64_tr_b16 v[176:177], v251 offset:40960
    ds_read_b64_tr_b16 v[178:179], v251 offset:41984
    v_cndmask_b32 v219, v213, 0, s[80:81]
    v_cndmask_b32 v217, 0, v214, s[80:81]
    v_cndmask_b32 v220, v214, 0, s[80:81]
    v_mfma_f32_32x32x16_bf16 v[128:143], v[188:191], a[68:71], v[128:143]
    ds_read_b64_tr_b16 v[180:181], v250 offset:40960
    ds_read_b64_tr_b16 v[182:183], v250 offset:41984
    v_cndmask_b32 v218, 0, v215, s[80:81]
    v_cndmask_b32 v221, v215, 0, s[80:81]
    v_accvgpr_write_b32 a232, v216
    s_waitcnt lgkmcnt(8)
    v_mfma_f32_32x32x16_bf16 v[112:127], v[192:195], a[72:75], v[112:127]
    ds_read_b64_tr_b16 v[184:185], v251 offset:43008
    ds_read_b64_tr_b16 v[186:187], v251 offset:44032
    v_accvgpr_write_b32 a236, v219
    v_accvgpr_write_b32 a233, v217
    v_accvgpr_write_b32 a237, v220
    v_mfma_f32_32x32x16_bf16 v[128:143], v[196:199], a[72:75], v[128:143]
    ds_read_b64_tr_b16 v[188:189], v250 offset:43008
    ds_read_b64_tr_b16 v[190:191], v250 offset:44032
    v_accvgpr_write_b32 a234, v218
    v_accvgpr_write_b32 a238, v221
    s_waitcnt lgkmcnt(8)
    v_mfma_f32_32x32x16_bf16 v[112:127], v[200:203], a[76:79], v[112:127]
    ds_read_b64_tr_b16 v[192:193], v251 offset:45056
    ds_read_b64_tr_b16 v[194:195], v251 offset:46080
    v_mfma_f32_32x32x16_bf16 v[128:143], v[204:207], a[76:79], v[128:143]
    ds_read_b64_tr_b16 v[196:197], v250 offset:45056
    ds_read_b64_tr_b16 v[198:199], v250 offset:46080
    s_waitcnt lgkmcnt(8)
    v_mfma_f32_32x32x16_bf16 v[112:127], v[176:179], a[80:83], v[112:127]
    ds_read_b64_tr_b16 v[200:201], v251 offset:47104
    ds_read_b64_tr_b16 v[202:203], v251 offset:48128
    v_mfma_f32_32x32x16_bf16 v[128:143], v[180:183], a[80:83], v[128:143]
    ds_read_b64_tr_b16 v[204:205], v250 offset:47104
    ds_read_b64_tr_b16 v[206:207], v250 offset:48128
    s_waitcnt lgkmcnt(8)
    v_mfma_f32_32x32x16_bf16 v[112:127], v[184:187], a[84:87], v[112:127]
    ds_read_b64_tr_b16 v[176:177], v251 offset:49152
    ds_read_b64_tr_b16 v[178:179], v251 offset:50176
    v_mfma_f32_32x32x16_bf16 v[128:143], v[188:191], a[84:87], v[128:143]
    ds_read_b64_tr_b16 v[180:181], v250 offset:49152
    ds_read_b64_tr_b16 v[182:183], v250 offset:50176
    s_waitcnt lgkmcnt(8)
    v_mfma_f32_32x32x16_bf16 v[112:127], v[192:195], a[88:91], v[112:127]
    ds_read_b64_tr_b16 v[184:185], v251 offset:51200
    ds_read_b64_tr_b16 v[186:187], v251 offset:52224
    v_mfma_f32_32x32x16_bf16 v[128:143], v[196:199], a[88:91], v[128:143]
    ds_read_b64_tr_b16 v[188:189], v250 offset:51200
    ds_read_b64_tr_b16 v[190:191], v250 offset:52224
    s_waitcnt lgkmcnt(8)
    v_mfma_f32_32x32x16_bf16 v[112:127], v[200:203], a[92:95], v[112:127]
    ds_read_b64_tr_b16 v[192:193], v251 offset:53248
    ds_read_b64_tr_b16 v[194:195], v251 offset:54272
    v_mfma_f32_32x32x16_bf16 v[128:143], v[204:207], a[92:95], v[128:143]
    ds_read_b64_tr_b16 v[196:197], v250 offset:53248
    ds_read_b64_tr_b16 v[198:199], v250 offset:54272
    s_waitcnt lgkmcnt(8)
    v_mfma_f32_32x32x16_bf16 v[112:127], v[176:179], a[96:99], v[112:127]
    ds_read_b64_tr_b16 v[200:201], v251 offset:55296
    ds_read_b64_tr_b16 v[202:203], v251 offset:56320
    v_mfma_f32_32x32x16_bf16 v[128:143], v[180:183], a[96:99], v[128:143]
    ds_read_b64_tr_b16 v[204:205], v250 offset:55296
    ds_read_b64_tr_b16 v[206:207], v250 offset:56320
L_sb12:
    s_cbranch_execz L_wzb
    s_waitcnt lgkmcnt(8)
    v_mfma_f32_32x32x16_bf16 v[112:127], v[184:187], a[100:103], v[112:127]
    v_mfma_f32_32x32x16_bf16 v[128:143], v[188:191], a[100:103], v[128:143]
    s_waitcnt lgkmcnt(4)
    v_mfma_f32_32x32x16_bf16 v[112:127], v[192:195], a[104:107], v[112:127]
    v_mfma_f32_32x32x16_bf16 v[128:143], v[196:199], a[104:107], v[128:143]
    s_waitcnt lgkmcnt(0)
    v_mfma_f32_32x32x16_bf16 v[112:127], v[200:203], a[108:111], v[112:127]
    v_mfma_f32_32x32x16_bf16 v[128:143], v[204:207], a[108:111], v[128:143]
    v_mfma_f32_32x32x16_bf16 v[112:127], a[248:251], a[232:235], v[112:127]
    v_mfma_f32_32x32x16_bf16 v[128:143], a[248:251], a[236:239], v[128:143]
    s_add_u32 s84, s84, 7168
    buffer_store_dword v227, v241, s[36:39], s84 offen sc1
    v_mfma_f32_32x32x16_bf16 v[144:159], a[168:171], a[0:3], 0
    v_mfma_f32_32x32x16_bf16 v[160:175], a[172:175], a[0:3], 0
    s_xor_b32 s86, s88, 0
    s_add_u32 s86, s86, 458752
    s_nop 4
    v_mul_f32 v112, v112, abs(v112)
    v_mul_f32 v113, v113, abs(v113)
    v_cvt_pk_bf16_f32 v208, v112, v113
    v_pk_max_i16 v208, v208, 0
    v_mul_f32 v114, v114, abs(v114)
    v_mfma_f32_32x32x16_bf16 v[144:159], a[176:179], a[4:7], v[144:159]
    v_mul_f32 v115, v115, abs(v115)
    v_cvt_pk_bf16_f32 v209, v114, v115
    v_pk_max_i16 v209, v209, 0
    v_mul_f32 v116, v116, abs(v116)
    v_mul_f32 v117, v117, abs(v117)
    v_cvt_pk_bf16_f32 v210, v116, v117
    v_pk_max_i16 v210, v210, 0
    v_mfma_f32_32x32x16_bf16 v[160:175], a[180:183], a[4:7], v[160:175]
    v_mul_f32 v118, v118, abs(v118)
    v_mul_f32 v119, v119, abs(v119)
    v_cvt_pk_bf16_f32 v211, v118, v119
    v_pk_max_i16 v211, v211, 0
    buffer_store_dwordx4 v[208:211], v254, s[36:39], s86 offen offset:0 sc1
    v_mul_f32 v120, v120, abs(v120)
    v_mul_f32 v121, v121, abs(v121)
    v_mfma_f32_32x32x16_bf16 v[144:159], a[184:187], a[8:11], v[144:159]
    v_cvt_pk_bf16_f32 v212, v120, v121
    v_pk_max_i16 v212, v212, 0
    v_mul_f32 v122, v122, abs(v122)
    v_mul_f32 v123, v123, abs(v123)
    v_cvt_pk_bf16_f32 v213, v122, v123
    v_pk_max_i16 v213, v213, 0
    v_mul_f32 v124, v124, abs(v124)
    v_mfma_f32_32x32x16_bf16 v[160:175], a[188:191], a[8:11], v[160:175]
    v_mul_f32 v125, v125, abs(v125)
    v_cvt_pk_bf16_f32 v214, v124, v125
    v_pk_max_i16 v214, v214, 0
    v_mul_f32 v126, v126, abs(v126)
    v_mul_f32 v127, v127, abs(v127)
    v_cvt_pk_bf16_f32 v215, v126, v127
    v_pk_max_i16 v215, v215, 0
    v_mfma_f32_32x32x16_bf16 v[144:159], a[192:195], a[12:15], v[144:159]
    buffer_store_dwordx4 v[212:215], v254, s[36:39], s86 offen offset:1024 sc1
    v_mul_f32 v128, v128, abs(v128)
    v_mul_f32 v129, v129, abs(v129)
    v_cvt_pk_bf16_f32 v216, v128, v129
    v_pk_max_i16 v216, v216, 0
    v_mul_f32 v130, v130, abs(v130)
    v_mul_f32 v131, v131, abs(v131)
    v_mfma_f32_32x32x16_bf16 v[160:175], a[196:199], a[12:15], v[160:175]
    v_cvt_pk_bf16_f32 v217, v130, v131
    v_pk_max_i16 v217, v217, 0
    v_mul_f32 v132, v132, abs(v132)
    v_mul_f32 v133, v133, abs(v133)
    v_cvt_pk_bf16_f32 v218, v132, v133
    v_pk_max_i16 v218, v218, 0
    v_mul_f32 v134, v134, abs(v134)
    v_mfma_f32_32x32x16_bf16 v[144:159], a[200:203], a[16:19], v[144:159]
    ds_read_b64_tr_b16 v[200:201], v239 offset:14336
    ds_read_b64_tr_b16 v[202:203], v239 offset:15360
    v_mul_f32 v135, v135, abs(v135)
    v_cvt_pk_bf16_f32 v219, v134, v135
    v_pk_max_i16 v219, v219, 0
    buffer_store_dwordx4 v[216:219], v254, s[36:39], s86 offen offset:2048 sc1
    v_mul_f32 v136, v136, abs(v136)
    v_mul_f32 v137, v137, abs(v137)
    v_mfma_f32_32x32x16_bf16 v[160:175], a[204:207], a[16:19], v[160:175]
    ds_read_b64_tr_b16 v[204:205], v240 offset:14336
    ds_read_b64_tr_b16 v[206:207], v240 offset:15360
    v_cvt_pk_bf16_f32 v220, v136, v137
    v_pk_max_i16 v220, v220, 0
    v_mul_f32 v138, v138, abs(v138)
    v_mul_f32 v139, v139, abs(v139)
    v_cvt_pk_bf16_f32 v221, v138, v139
    v_pk_max_i16 v221, v221, 0
    v_mfma_f32_32x32x16_bf16 v[144:159], a[208:211], a[20:23], v[144:159]
    ds_read_b64_tr_b16 v[176:177], v239 offset:16384
    ds_read_b64_tr_b16 v[178:179], v239 offset:17408
    v_mul_f32 v140, v140, abs(v140)
    v_mul_f32 v141, v141, abs(v141)
    v_cvt_pk_bf16_f32 v222, v140, v141
    v_pk_max_i16 v222, v222, 0
    v_mul_f32 v142, v142, abs(v142)
    v_mul_f32 v143, v143, abs(v143)
    v_mfma_f32_32x32x16_bf16 v[160:175], a[212:215], a[20:23], v[160:175]
    ds_read_b64_tr_b16 v[180:181], v240 offset:16384
    ds_read_b64_tr_b16 v[182:183], v240 offset:17408
    v_cvt_pk_bf16_f32 v223, v142, v143
    v_pk_max_i16 v223, v223, 0
    buffer_store_dwordx4 v[220:223], v254, s[36:39], s86 offen offset:3072 sc1
    v_mfma_f32_32x32x16_bf16 v[144:159], a[216:219], a[24:27], v[144:159]
    ds_read_b64_tr_b16 v[184:185], v239 offset:18432
    ds_read_b64_tr_b16 v[186:187], v239 offset:19456
    v_mfma_f32_32x32x16_bf16 v[160:175], a[220:223], a[24:27], v[160:175]
    ds_read_b64_tr_b16 v[188:189], v240 offset:18432
    ds_read_b64_tr_b16 v[190:191], v240 offset:19456
    s_waitcnt lgkmcnt(8)
    v_mfma_f32_32x32x16_bf16 v[144:159], v[200:203], a[28:31], v[144:159]
    ds_read_b64_tr_b16 v[192:193], v239 offset:20480
    ds_read_b64_tr_b16 v[194:195], v239 offset:21504
    v_mfma_f32_32x32x16_bf16 v[160:175], v[204:207], a[28:31], v[160:175]
    ds_read_b64_tr_b16 v[196:197], v240 offset:20480
    ds_read_b64_tr_b16 v[198:199], v240 offset:21504
    s_waitcnt lgkmcnt(8)
    v_mfma_f32_32x32x16_bf16 v[144:159], v[176:179], a[32:35], v[144:159]
    ds_read_b64_tr_b16 v[200:201], v239 offset:22528
    ds_read_b64_tr_b16 v[202:203], v239 offset:23552
    v_mfma_f32_32x32x16_bf16 v[160:175], v[180:183], a[32:35], v[160:175]
    ds_read_b64_tr_b16 v[204:205], v240 offset:22528
    ds_read_b64_tr_b16 v[206:207], v240 offset:23552
    s_waitcnt lgkmcnt(8)
    v_mfma_f32_32x32x16_bf16 v[144:159], v[184:187], a[36:39], v[144:159]
    ds_read_b64_tr_b16 v[176:177], v239 offset:24576
    ds_read_b64_tr_b16 v[178:179], v239 offset:25600
    v_mfma_f32_32x32x16_bf16 v[160:175], v[188:191], a[36:39], v[160:175]
    ds_read_b64_tr_b16 v[180:181], v240 offset:24576
    ds_read_b64_tr_b16 v[182:183], v240 offset:25600
    s_waitcnt lgkmcnt(8)
    v_mfma_f32_32x32x16_bf16 v[144:159], v[192:195], a[40:43], v[144:159]
    ds_read_b64_tr_b16 v[184:185], v239 offset:26624
    ds_read_b64_tr_b16 v[186:187], v239 offset:27648
    v_mfma_f32_32x32x16_bf16 v[160:175], v[196:199], a[40:43], v[160:175]
    ds_read_b64_tr_b16 v[188:189], v240 offset:26624
    ds_read_b64_tr_b16 v[190:191], v240 offset:27648
    s_waitcnt lgkmcnt(8)
    v_mfma_f32_32x32x16_bf16 v[144:159], v[200:203], a[44:47], v[144:159]
    ds_read_b64_tr_b16 v[192:193], v239 offset:28672
    ds_read_b64_tr_b16 v[194:195], v239 offset:29696
    v_mfma_f32_32x32x16_bf16 v[160:175], v[204:207], a[44:47], v[160:175]
    ds_read_b64_tr_b16 v[196:197], v240 offset:28672
    ds_read_b64_tr_b16 v[198:199], v240 offset:29696
    s_waitcnt lgkmcnt(8)
    v_mfma_f32_32x32x16_bf16 v[144:159], v[176:179], a[48:51], v[144:159]
    ds_read_b64_tr_b16 v[200:201], v239 offset:30720
    ds_read_b64_tr_b16 v[202:203], v239 offset:31744
    v_mfma_f32_32x32x16_bf16 v[160:175], v[180:183], a[48:51], v[160:175]
    ds_read_b64_tr_b16 v[204:205], v240 offset:30720
    ds_read_b64_tr_b16 v[206:207], v240 offset:31744
    s_waitcnt lgkmcnt(8)
    v_mfma_f32_32x32x16_bf16 v[144:159], v[184:187], a[52:55], v[144:159]
    ds_read_b64_tr_b16 v[176:177], v239 offset:32768
    ds_read_b64_tr_b16 v[178:179], v239 offset:33792
    v_mfma_f32_32x32x16_bf16 v[160:175], v[188:191], a[52:55], v[160:175]
    ds_read_b64_tr_b16 v[180:181], v240 offset:32768
    ds_read_b64_tr_b16 v[182:183], v240 offset:33792
    s_waitcnt lgkmcnt(8)
    v_mfma_f32_32x32x16_bf16 v[144:159], v[192:195], a[56:59], v[144:159]
    ds_read_b64_tr_b16 v[184:185], v239 offset:34816
    ds_read_b64_tr_b16 v[186:187], v239 offset:35840
    v_mfma_f32_32x32x16_bf16 v[160:175], v[196:199], a[56:59], v[160:175]
    ds_read_b64_tr_b16 v[188:189], v240 offset:34816
    ds_read_b64_tr_b16 v[190:191], v240 offset:35840
    s_waitcnt vmcnt(0)
    s_add_u32 s79, s85, 1024
    s_mov_b64 exec, 1
    s_cmp_eq_u32 s7, 0
    s_cbranch_scc1 L_fs31
    buffer_store_dword v245, off, s[36:39], s79
L_fj32:
    s_mov_b64 exec, -1
    buffer_load_dword v246, v242, s[36:39], s86 offen sc1
    s_waitcnt lgkmcnt(8)
    v_mfma_f32_32x32x16_bf16 v[144:159], v[200:203], a[60:63], v[144:159]
    ds_read_b64_tr_b16 v[192:193], v239 offset:36864
    ds_read_b64_tr_b16 v[194:195], v239 offset:37888
    v_mfma_f32_32x32x16_bf16 v[160:175], v[204:207], a[60:63], v[160:175]
    ds_read_b64_tr_b16 v[196:197], v240 offset:36864
    ds_read_b64_tr_b16 v[198:199], v240 offset:37888
    s_waitcnt lgkmcnt(8)
    v_mfma_f32_32x32x16_bf16 v[144:159], v[176:179], a[64:67], v[144:159]
    ds_read_b64_tr_b16 v[200:201], v239 offset:38912
    ds_read_b64_tr_b16 v[202:203], v239 offset:39936
    v_mfma_f32_32x32x16_bf16 v[160:175], v[180:183], a[64:67], v[160:175]
    ds_read_b64_tr_b16 v[204:205], v240 offset:38912
    ds_read_b64_tr_b16 v[206:207], v240 offset:39936
    s_waitcnt lgkmcnt(8)
    v_mfma_f32_32x32x16_bf16 v[144:159], v[184:187], a[68:71], v[144:159]
    ds_read_b64_tr_b16 v[176:177], v239 offset:40960
    ds_read_b64_tr_b16 v[178:179], v239 offset:41984
    v_mfma_f32_32x32x16_bf16 v[160:175], v[188:191], a[68:71], v[160:175]
    ds_read_b64_tr_b16 v[180:181], v240 offset:40960
    ds_read_b64_tr_b16 v[182:183], v240 offset:41984
    s_waitcnt lgkmcnt(8)
    v_mfma_f32_32x32x16_bf16 v[144:159], v[192:195], a[72:75], v[144:159]
    ds_read_b64_tr_b16 v[184:185], v239 offset:43008
    ds_read_b64_tr_b16 v[186:187], v239 offset:44032
    v_mfma_f32_32x32x16_bf16 v[160:175], v[196:199], a[72:75], v[160:175]
    ds_read_b64_tr_b16 v[188:189], v240 offset:43008
    ds_read_b64_tr_b16 v[190:191], v240 offset:44032
    s_waitcnt lgkmcnt(8)
    v_mfma_f32_32x32x16_bf16 v[144:159], v[200:203], a[76:79], v[144:159]
    ds_read_b64_tr_b16 v[192:193], v239 offset:45056
    ds_read_b64_tr_b16 v[194:195], v239 offset:46080
    v_mfma_f32_32x32x16_bf16 v[160:175], v[204:207], a[76:79], v[160:175]
    ds_read_b64_tr_b16 v[196:197], v240 offset:45056
    ds_read_b64_tr_b16 v[198:199], v240 offset:46080
    s_waitcnt lgkmcnt(8)
    v_mfma_f32_32x32x16_bf16 v[144:159], v[176:179], a[80:83], v[144:159]
    ds_read_b64_tr_b16 v[200:201], v239 offset:47104
    ds_read_b64_tr_b16 v[202:203], v239 offset:48128
    v_mfma_f32_32x32x16_bf16 v[160:175], v[180:183], a[80:83], v[160:175]
    ds_read_b64_tr_b16 v[204:205], v240 offset:47104
    ds_read_b64_tr_b16 v[206:207], v240 offset:48128
    s_waitcnt lgkmcnt(8)
    v_mfma_f32_32x32x16_bf16 v[144:159], v[184:187], a[84:87], v[144:159]
    ds_read_b64_tr_b16 v[176:177], v239 offset:49152
    ds_read_b64_tr_b16 v[178:179], v239 offset:50176
    v_mfma_f32_32x32x16_bf16 v[160:175], v[188:191], a[84:87], v[160:175]
    ds_read_b64_tr_b16 v[180:181], v240 offset:49152
    ds_read_b64_tr_b16 v[182:183], v240 offset:50176
    s_waitcnt lgkmcnt(8)
    v_mfma_f32_32x32x16_bf16 v[144:159], v[192:195], a[88:91], v[144:159]
    ds_read_b64_tr_b16 v[184:185], v239 offset:51200
    ds_read_b64_tr_b16 v[186:187], v239 offset:52224
    v_mfma_f32_32x32x16_bf16 v[160:175], v[196:199], a[88:91], v[160:175]
    ds_read_b64_tr_b16 v[188:189], v240 offset:51200
    ds_read_b64_tr_b16 v[190:191], v240 offset:52224
    s_waitcnt lgkmcnt(8)
    v_mfma_f32_32x32x16_bf16 v[144:159], v[200:203], a[92:95], v[144:159]
    ds_read_b64_tr_b16 v[192:193], v239 offset:53248
    ds_read_b64_tr_b16 v[194:195], v239 offset:54272
    v_mfma_f32_32x32x16_bf16 v[160:175], v[204:207], a[92:95], v[160:175]
    ds_read_b64_tr_b16 v[196:197], v240 offset:53248
    ds_read_b64_tr_b16 v[198:199], v240 offset:54272
    s_waitcnt lgkmcnt(8)
    v_mfma_f32_32x32x16_bf16 v[144:159], v[176:179], a[96:99], v[144:159]
    ds_read_b64_tr_b16 v[200:201], v239 offset:55296
    ds_read_b64_tr_b16 v[202:203], v239 offset:56320
    v_mfma_f32_32x32x16_bf16 v[160:175], v[180:183], a[96:99], v[160:175]
    ds_read_b64_tr_b16 v[204:205], v240 offset:55296
    ds_read_b64_tr_b16 v[206:207], v240 offset:56320
    s_waitcnt lgkmcnt(8)
    v_mfma_f32_32x32x16_bf16 v[144:159], v[184:187], a[100:103], v[144:159]
    v_mfma_f32_32x32x16_bf16 v[160:175], v[188:191], a[100:103], v[160:175]
    s_waitcnt lgkmcnt(4)
    v_mfma_f32_32x32x16_bf16 v[144:159], v[192:195], a[104:107], v[144:159]
    v_mfma_f32_32x32x16_bf16 v[160:175], v[196:199], a[104:107], v[160:175]
    s_waitcnt lgkmcnt(0)
    v_mfma_f32_32x32x16_bf16 v[144:159], v[200:203], a[108:111], v[144:159]
    v_mfma_f32_32x32x16_bf16 v[160:175], v[204:207], a[108:111], v[160:175]
    v_mfma_f32_32x32x16_bf16 v[144:159], a[252:255], a[232:235], v[144:159]
    v_mfma_f32_32x32x16_bf16 v[160:175], a[252:255], a[236:239], v[160:175]
    s_xor_b32 s86, s88, 4096
    s_add_u32 s86, s86, 458752
    s_nop 8
    v_mul_f32 v144, v144, abs(v144)
    v_mul_f32 v145, v145, abs(v145)
    v_cvt_pk_bf16_f32 v208, v144, v145
    v_pk_max_i16 v208, v208, 0
    v_mul_f32 v146, v146, abs(v146)
    v_mul_f32 v147, v147, abs(v147)
    v_cvt_pk_bf16_f32 v209, v146, v147
    v_pk_max_i16 v209, v209, 0
    v_mul_f32 v148, v148, abs(v148)
    v_mul_f32 v149, v149, abs(v149)
    v_cvt_pk_bf16_f32 v210, v148, v149
    v_pk_max_i16 v210, v210, 0
    v_mul_f32 v150, v150, abs(v150)
    v_mul_f32 v151, v151, abs(v151)
    v_cvt_pk_bf16_f32 v211, v150, v151
    v_pk_max_i16 v211, v211, 0
    buffer_store_dwordx4 v[208:211], v254, s[36:39], s86 offen offset:0 sc1
    v_mul_f32 v152, v152, abs(v152)
    v_mul_f32 v153, v153, abs(v153)
    v_cvt_pk_bf16_f32 v212, v152, v153
    v_pk_max_i16 v212, v212, 0
    v_mul_f32 v154, v154, abs(v154)
    v_mul_f32 v155, v155, abs(v155)
    v_cvt_pk_bf16_f32 v213, v154, v155
    v_pk_max_i16 v213, v213, 0
    v_mul_f32 v156, v156, abs(v156)
    v_mul_f32 v157, v157, abs(v157)
    v_cvt_pk_bf16_f32 v214, v156, v157
    v_pk_max_i16 v214, v214, 0
    v_mul_f32 v158, v158, abs(v158)
    v_mul_f32 v159, v159, abs(v159)
    v_cvt_pk_bf16_f32 v215, v158, v159
    v_pk_max_i16 v215, v215, 0
    buffer_store_dwordx4 v[212:215], v254, s[36:39], s86 offen offset:1024 sc1
    v_mul_f32 v160, v160, abs(v160)
    v_mul_f32 v161, v161, abs(v161)
    v_cvt_pk_bf16_f32 v216, v160, v161
    v_pk_max_i16 v216, v216, 0
    v_mul_f32 v162, v162, abs(v162)
    v_mul_f32 v163, v163, abs(v163)
    v_cvt_pk_bf16_f32 v217, v162, v163
    v_pk_max_i16 v217, v217, 0
    v_mul_f32 v164, v164, abs(v164)
    v_mul_f32 v165, v165, abs(v165)
    v_cvt_pk_bf16_f32 v218, v164, v165
    v_pk_max_i16 v218, v218, 0
    v_mul_f32 v166, v166, abs(v166)
    v_mul_f32 v167, v167, abs(v167)
    v_cvt_pk_bf16_f32 v219, v166, v167
    v_pk_max_i16 v219, v219, 0
    buffer_store_dwordx4 v[216:219], v254, s[36:39], s86 offen offset:2048 sc1
    v_mul_f32 v168, v168, abs(v168)
    v_mul_f32 v169, v169, abs(v169)
    v_cvt_pk_bf16_f32 v220, v168, v169
    v_pk_max_i16 v220, v220, 0
    v_mul_f32 v170, v170, abs(v170)
    v_mul_f32 v171, v171, abs(v171)
    v_cvt_pk_bf16_f32 v221, v170, v171
    v_pk_max_i16 v221, v221, 0
    v_mul_f32 v172, v172, abs(v172)
    v_mul_f32 v173, v173, abs(v173)
    v_cvt_pk_bf16_f32 v222, v172, v173
    v_pk_max_i16 v222, v222, 0
    v_mul_f32 v174, v174, abs(v174)
    v_mul_f32 v175, v175, abs(v175)
    v_cvt_pk_bf16_f32 v223, v174, v175
    v_pk_max_i16 v223, v223, 0
    buffer_store_dwordx4 v[220:223], v254, s[36:39], s86 offen offset:3072 sc1
    s_waitcnt vmcnt(0)
    s_add_u32 s79, s85, 1088
    s_mov_b64 exec, 1
    s_cmp_eq_u32 s7, 0
    s_cbranch_scc1 L_fs33
    buffer_store_dword v245, off, s[36:39], s79
L_fj34:
    s_mov_b64 exec, -1
    buffer_load_dword v246, v242, s[36:39], s86 offen sc1
    s_branch L_fin
L_at2:
L_sb13:
    s_cbranch_execz L_sb17
    ds_read_b64 v[152:153], v216 offset:0
    ds_read_b64 v[154:155], v216 offset:256
    ds_read_b64 v[156:157], v216 offset:1024
    ds_read_b64 v[158:159], v216 offset:1280
    ds_read_b64 v[160:161], v216 offset:16384
    ds_read_b64 v[162:163], v216 offset:16640
    ds_read_b64 v[164:165], v216 offset:17408
    ds_read_b64 v[166:167], v216 offset:17664
    ds_read_b64 v[168:169], v216 offset:2048
    ds_read_b64 v[170:171], v216 offset:2304
    ds_read_b64 v[172:173], v216 offset:3072
    ds_read_b64 v[174:175], v216 offset:3328
    s_bitcmp0_b32 s56, 0
    s_cselect_b32 s65, 0, 7168
    s_add_u32 s65, s65, s92
    s_mov_b32 m0, s65
    s_mul_i32 s67, s65, 7
    s_add_u32 s67, s67, s59
    buffer_load_dwordx4 v246, s[16:19], s67 offen offset:0 lds
    buffer_load_dwordx4 v247, s[16:19], s67 offen offset:1024 lds
    buffer_load_dwordx4 v248, s[16:19], s67 offen offset:2048 lds
    s_waitcnt lgkmcnt(8)
    v_mfma_f32_32x32x16_bf16 v[0:15], v[152:155], v[144:147], v[0:15]
    ds_read_b64 v[176:177], v216 offset:4096
    ds_read_b64 v[178:179], v216 offset:4352
    ds_read_b64 v[180:181], v216 offset:5120
    ds_read_b64 v[182:183], v216 offset:5376
    v_mfma_f32_32x32x16_bf16 v[0:15], v[156:159], v[148:151], v[0:15]
    buffer_load_dwordx4 v249, s[16:19], s67 offen offset:3072 lds
    s_waitcnt lgkmcnt(8)
    v_mfma_f32_32x32x16_bf16 v[128:143], v[160:163], v[144:147], v[128:143]
    ds_read_b64 v[152:153], v216 offset:6144
    ds_read_b64 v[154:155], v216 offset:6400
    ds_read_b64 v[156:157], v216 offset:7168
    ds_read_b64 v[158:159], v216 offset:7424
    v_mfma_f32_32x32x16_bf16 v[128:143], v[164:167], v[148:151], v[128:143]
    s_add_u32 m0, m0, 4096
    s_add_u32 s67, s67, 28672
    buffer_load_dwordx4 v246, s[16:19], s67 offen offset:0 lds
    s_waitcnt lgkmcnt(8)
    v_mfma_f32_32x32x16_bf16 v[16:31], v[168:171], v[144:147], 0
    ds_read_b64 v[160:161], v216 offset:8192
    ds_read_b64 v[162:163], v216 offset:8448
    ds_read_b64 v[164:165], v216 offset:9216
    ds_read_b64 v[166:167], v216 offset:9472
    v_mfma_f32_32x32x16_bf16 v[16:31], v[172:175], v[148:151], v[16:31]
    s_waitcnt lgkmcnt(8)
    v_mfma_f32_32x32x16_bf16 v[32:47], v[176:179], v[144:147], 0
    ds_read_b64 v[168:169], v216 offset:10240
    ds_read_b64 v[170:171], v216 offset:10496
    ds_read_b64 v[172:173], v216 offset:11264
    ds_read_b64 v[174:175], v216 offset:11520
    v_max_f32 v0, v0, v128
    v_max_f32 v1, v1, v129
    v_mfma_f32_32x32x16_bf16 v[32:47], v[180:183], v[148:151], v[32:47]
    v_max_f32 v2, v2, v130
    v_max_f32 v3, v3, v131
    v_max_f32 v4, v4, v132
    v_max_f32 v5, v5, v133
    v_max_f32 v6, v6, v134
    v_max_f32 v7, v7, v135
    v_max_f32 v8, v8, v136
    s_waitcnt lgkmcnt(8)
    v_mfma_f32_32x32x16_bf16 v[48:63], v[152:155], v[144:147], 0
    ds_read_b64 v[176:177], v216 offset:12288
    ds_read_b64 v[178:179], v216 offset:12544
    ds_read_b64 v[180:181], v216 offset:13312
    ds_read_b64 v[182:183], v216 offset:13568
    v_max_f32 v9, v9, v137
    v_max_f32 v10, v10, v138
    v_mfma_f32_32x32x16_bf16 v[48:63], v[156:159], v[148:151], v[48:63]
    v_max_f32 v11, v11, v139
    v_max_f32 v12, v12, v140
    v_max_f32 v13, v13, v141
    v_max_f32 v14, v14, v142
    v_max_f32 v15, v15, v143
    v_max_f32 v226, v0, v1
    v_max3_f32 v226, v226, v2, v3
    s_waitcnt lgkmcnt(8)
    v_mfma_f32_32x32x16_bf16 v[64:79], v[160:163], v[144:147], 0
    ds_read_b64 v[152:153], v216 offset:14336
    ds_read_b64 v[154:155], v216 offset:14592
    ds_read_b64 v[156:157], v216 offset:15360
    ds_read_b64 v[158:159], v216 offset:15616
    v_max3_f32 v226, v226, v4, v5
    v_max3_f32 v226, v226, v6, v7
    v_mfma_f32_32x32x16_bf16 v[64:79], v[164:167], v[148:151], v[64:79]
    v_max3_f32 v226, v226, v8, v9
    v_max3_f32 v226, v226, v10, v11
    v_max3_f32 v226, v226, v12, v13
    v_max3_f32 v226, v226, v14, v15
    v_max3_f32 v226, v226, v16, v17
    v_max3_f32 v226, v226, v18, v19
    v_max3_f32 v226, v226, v20, v21
    s_waitcnt lgkmcnt(8)
    v_mfma_f32_32x32x16_bf16 v[80:95], v[168:171], v[144:147], 0
    buffer_load_dwordx4 v247, s[16:19], s67 offen offset:1024 lds
    v_max3_f32 v226, v226, v22, v23
    v_max3_f32 v226, v226, v24, v25
    v_max3_f32 v226, v226, v26, v27
    v_max3_f32 v226, v226, v28, v29
    v_mfma_f32_32x32x16_bf16 v[80:95], v[172:175], v[148:151], v[80:95]
    v_max3_f32 v226, v226, v30, v31
    v_max3_f32 v226, v226, v32, v33
    v_max3_f32 v226, v226, v34, v35
    v_max3_f32 v226, v226, v36, v37
    v_max3_f32 v226, v226, v38, v39
    v_max3_f32 v226, v226, v40, v41
    v_max3_f32 v226, v226, v42, v43
    s_waitcnt lgkmcnt(4)
    v_mfma_f32_32x32x16_bf16 v[96:111], v[176:179], v[144:147], 0
    buffer_load_dwordx4 v248, s[16:19], s67 offen offset:2048 lds
    v_max3_f32 v226, v226, v44, v45
    v_max3_f32 v226, v226, v46, v47
    v_max3_f32 v226, v226, v48, v49
    v_max3_f32 v226, v226, v50, v51
    v_mfma_f32_32x32x16_bf16 v[96:111], v[180:183], v[148:151], v[96:111]
    v_max3_f32 v226, v226, v52, v53
    v_max3_f32 v226, v226, v54, v55
    v_max3_f32 v226, v226, v56, v57
    v_max3_f32 v226, v226, v58, v59
    v_max3_f32 v226, v226, v60, v61
    v_max3_f32 v226, v226, v62, v63
    v_max3_f32 v226, v226, v64, v65
    s_waitcnt lgkmcnt(0)
    v_mfma_f32_32x32x16_bf16 v[112:127], v[152:155], v[144:147], 0
    buffer_load_dwordx4 v249, s[16:19], s67 offen offset:3072 lds
    v_max3_f32 v226, v226, v66, v67
    v_max3_f32 v226, v226, v68, v69
    v_max3_f32 v226, v226, v70, v71
    v_max3_f32 v226, v226, v72, v73
    v_mfma_f32_32x32x16_bf16 v[112:127], v[156:159], v[148:151], v[112:127]
    v_max3_f32 v226, v226, v74, v75
    v_max3_f32 v226, v226, v76, v77
    v_max3_f32 v226, v226, v78, v79
    v_max3_f32 v226, v226, v80, v81
    v_max3_f32 v226, v226, v82, v83
    v_max3_f32 v226, v226, v84, v85
    v_max3_f32 v226, v226, v86, v87
    v_max3_f32 v226, v226, v88, v89
    v_max3_f32 v226, v226, v90, v91
    v_max3_f32 v226, v226, v92, v93
    v_max3_f32 v226, v226, v94, v95
    v_max3_f32 v226, v226, v96, v97
    v_max3_f32 v226, v226, v98, v99
    v_max3_f32 v226, v226, v100, v101
    v_max3_f32 v226, v226, v102, v103
    v_max3_f32 v226, v226, v104, v105
    v_max3_f32 v226, v226, v106, v107
    v_max3_f32 v226, v226, v108, v109
    v_max3_f32 v226, v226, v110, v111
    v_mov_b32 v240, 0x3f803f80
    v_cndmask_b32 v160, 0, v240, vcc
    v_cndmask_b32 v161, 0, v239, vcc
    v_mov_b32 v162, 0
    v_mov_b32 v163, 0
    v_mov_b32 v166, 0
    v_mov_b32 v167, 0
    buffer_load_dwordx4 v[228:231], v232, s[36:39], s45 offen sc1
    v_max3_f32 v226, v226, v112, v113
    v_max3_f32 v226, v226, v114, v115
    v_max3_f32 v226, v226, v116, v117
    v_max3_f32 v226, v226, v118, v119
    v_max3_f32 v226, v226, v120, v121
    v_max3_f32 v226, v226, v122, v123
    v_max3_f32 v226, v226, v124, v125
    v_max3_f32 v226, v226, v126, v127
    v_mov_b32 v239, v226
    s_nop 1
    v_permlane32_swap_b32 v226, v239
    v_max_f32 v226, v226, v239
    v_pk_add_f32 v[0:1], v[0:1], v[226:227] op_sel_hi:[1,0] neg_lo:[0,1] neg_hi:[0,1]
    v_pk_add_f32 v[2:3], v[2:3], v[226:227] op_sel_hi:[1,0] neg_lo:[0,1] neg_hi:[0,1]
    v_pk_add_f32 v[4:5], v[4:5], v[226:227] op_sel_hi:[1,0] neg_lo:[0,1] neg_hi:[0,1]
    v_pk_add_f32 v[6:7], v[6:7], v[226:227] op_sel_hi:[1,0] neg_lo:[0,1] neg_hi:[0,1]
    v_pk_add_f32 v[8:9], v[8:9], v[226:227] op_sel_hi:[1,0] neg_lo:[0,1] neg_hi:[0,1]
    v_pk_add_f32 v[10:11], v[10:11], v[226:227] op_sel_hi:[1,0] neg_lo:[0,1] neg_hi:[0,1]
    v_pk_add_f32 v[12:13], v[12:13], v[226:227] op_sel_hi:[1,0] neg_lo:[0,1] neg_hi:[0,1]
    v_pk_add_f32 v[14:15], v[14:15], v[226:227] op_sel_hi:[1,0] neg_lo:[0,1] neg_hi:[0,1]
    v_and_b32 v239, 0xffff0000, v226
    v_sub_f32 v240, v226, v239
    v_and_b32 v241, 0xffff0000, v240
    v_sub_f32 v240, v240, v241
    v_cvt_pk_bf16_f32 v164, -v239, -v241
    v_cvt_pk_bf16_f32 v165, -v240, 0
    s_nop 1
    v_mfma_f32_32x32x16_bf16 v[16:31], v[160:163], v[164:167], v[16:31]
    v_exp_f32 v0, v0
    v_exp_f32 v1, v1
    v_exp_f32 v2, v2
    v_exp_f32 v3, v3
    v_exp_f32 v4, v4
    v_exp_f32 v5, v5
    v_exp_f32 v6, v6
    v_exp_f32 v7, v7
    v_cvt_pk_bf16_f32 v0, v0, v1
    v_cvt_pk_bf16_f32 v1, v2, v3
    v_cvt_pk_bf16_f32 v2, v4, v5
    v_cvt_pk_bf16_f32 v3, v6, v7
    v_and_b32 v128, v192, v0
    v_xor_b32 v0, v0, v128
    v_and_b32 v129, v193, v1
    v_xor_b32 v1, v1, v129
    v_and_b32 v130, v194, v2
    v_xor_b32 v2, v2, v130
    v_and_b32 v131, v195, v3
    v_xor_b32 v3, v3, v131
    s_waitcnt vmcnt(9)
    s_barrier
    ds_read_b128 v[200:203], v217 offset:0
    ds_read_b128 v[204:207], v217 offset:1024
    ds_read_b128 v[208:211], v217 offset:16384
    ds_read_b128 v[212:215], v217 offset:17408
    v_exp_f32 v8, v8
    v_exp_f32 v9, v9
    v_exp_f32 v10, v10
    v_exp_f32 v11, v11
    v_exp_f32 v12, v12
    v_exp_f32 v13, v13
    v_exp_f32 v14, v14
    v_exp_f32 v15, v15
    v_cvt_pk_bf16_f32 v8, v8, v9
    v_cvt_pk_bf16_f32 v9, v10, v11
    v_cvt_pk_bf16_f32 v10, v12, v13
    v_cvt_pk_bf16_f32 v11, v14, v15
    v_and_b32 v136, v196, v8
    v_xor_b32 v8, v8, v136
    v_and_b32 v137, v197, v9
    v_xor_b32 v9, v9, v137
    v_and_b32 v138, v198, v10
    v_xor_b32 v10, v10, v138
    v_and_b32 v139, v199, v11
    v_xor_b32 v11, v11, v139
    s_waitcnt lgkmcnt(2)
L_sb14:
    s_cbranch_execz L_wzc
    v_mfma_f32_32x32x16_bf16 v[184:199], v[200:203], v[0:3], 0
    s_bitcmp1_b32 s56, 0
    s_cselect_b32 s65, 0, 7168
    s_add_u32 s65, s65, s92
    s_mov_b32 m0, s65
    s_mul_i32 s67, s65, 7
    s_add_u32 s67, s67, s59
    buffer_load_dwordx4 v246, s[16:19], s67 offen offset:0 lds
    v_exp_f32 v16, v16
    v_exp_f32 v17, v17
    v_exp_f32 v18, v18
    v_exp_f32 v19, v19
    v_mfma_f32_32x32x16_bf16 v[32:47], v[160:163], v[164:167], v[32:47]
    v_exp_f32 v20, v20
    v_exp_f32 v21, v21
    v_exp_f32 v22, v22
    v_exp_f32 v23, v23
    v_cvt_pk_bf16_f32 v16, v16, v17
    v_cvt_pk_bf16_f32 v17, v18, v19
    v_cvt_pk_bf16_f32 v18, v20, v21
    v_cvt_pk_bf16_f32 v19, v22, v23
    v_mfma_f32_32x32x16_bf16 v[184:199], v[204:207], v[8:11], v[184:199]
    ds_read_b128 v[200:203], v217 offset:2048
    ds_read_b128 v[204:207], v217 offset:3072
    buffer_load_dwordx4 v247, s[16:19], s67 offen offset:1024 lds
    v_exp_f32 v24, v24
    v_exp_f32 v25, v25
    v_exp_f32 v26, v26
    v_exp_f32 v27, v27
    s_waitcnt lgkmcnt(2)
    v_mfma_f32_32x32x16_bf16 v[184:199], v[208:211], v[128:131], v[184:199]
    v_exp_f32 v28, v28
    v_exp_f32 v29, v29
    v_exp_f32 v30, v30
    v_exp_f32 v31, v31
    v_cvt_pk_bf16_f32 v24, v24, v25
    v_cvt_pk_bf16_f32 v25, v26, v27
    v_cvt_pk_bf16_f32 v26, v28, v29
    v_cvt_pk_bf16_f32 v27, v30, v31
    v_mfma_f32_32x32x16_bf16 v[184:199], v[212:215], v[136:139], v[184:199]
    ds_read_b128 v[208:211], v217 offset:4096
    ds_read_b128 v[212:215], v217 offset:5120
    buffer_load_dwordx4 v248, s[16:19], s67 offen offset:2048 lds
    v_exp_f32 v32, v32
    v_exp_f32 v33, v33
    v_exp_f32 v34, v34
    v_exp_f32 v35, v35
    v_mfma_f32_32x32x16_bf16 v[48:63], v[160:163], v[164:167], v[48:63]
    v_exp_f32 v36, v36
    v_exp_f32 v37, v37
    v_exp_f32 v38, v38
    v_exp_f32 v39, v39
    v_cvt_pk_bf16_f32 v32, v32, v33
    v_cvt_pk_bf16_f32 v33, v34, v35
    v_cvt_pk_bf16_f32 v34, v36, v37
    v_cvt_pk_bf16_f32 v35, v38, v39
    s_waitcnt lgkmcnt(2)
    v_mfma_f32_32x32x16_bf16 v[184:199], v[200:203], v[16:19], v[184:199]
    buffer_load_dwordx4 v249, s[16:19], s67 offen offset:3072 lds
    v_exp_f32 v40, v40
    v_exp_f32 v41, v41
    v_exp_f32 v42, v42
    v_exp_f32 v43, v43
    v_mfma_f32_32x32x16_bf16 v[184:199], v[204:207], v[24:27], v[184:199]
    ds_read_b128 v[200:203], v217 offset:6144
    ds_read_b128 v[204:207], v217 offset:7168
    v_exp_f32 v44, v44
    v_exp_f32 v45, v45
    v_exp_f32 v46, v46
    v_exp_f32 v47, v47
    v_cvt_pk_bf16_f32 v40, v40, v41
    v_cvt_pk_bf16_f32 v41, v42, v43
    v_cvt_pk_bf16_f32 v42, v44, v45
    v_cvt_pk_bf16_f32 v43, v46, v47
    s_waitcnt lgkmcnt(2)
    v_mfma_f32_32x32x16_bf16 v[184:199], v[208:211], v[32:35], v[184:199]
    s_add_u32 m0, m0, 4096
    s_add_u32 s67, s67, 28672
    buffer_load_dwordx4 v246, s[16:19], s67 offen offset:0 lds
    v_exp_f32 v48, v48
    v_exp_f32 v49, v49
    v_exp_f32 v50, v50
    v_exp_f32 v51, v51
    v_mfma_f32_32x32x16_bf16 v[64:79], v[160:163], v[164:167], v[64:79]
    v_exp_f32 v52, v52
    v_exp_f32 v53, v53
    v_exp_f32 v54, v54
    v_exp_f32 v55, v55
    v_cvt_pk_bf16_f32 v48, v48, v49
    v_cvt_pk_bf16_f32 v49, v50, v51
    v_cvt_pk_bf16_f32 v50, v52, v53
    v_cvt_pk_bf16_f32 v51, v54, v55
    v_mfma_f32_32x32x16_bf16 v[184:199], v[212:215], v[40:43], v[184:199]
    ds_read_b128 v[208:211], v217 offset:8192
    ds_read_b128 v[212:215], v217 offset:9216
    buffer_load_dwordx4 v247, s[16:19], s67 offen offset:1024 lds
    v_exp_f32 v56, v56
    v_exp_f32 v57, v57
    v_exp_f32 v58, v58
    v_exp_f32 v59, v59
    v_exp_f32 v60, v60
    v_exp_f32 v61, v61
    v_exp_f32 v62, v62
    v_exp_f32 v63, v63
    v_cvt_pk_bf16_f32 v56, v56, v57
    v_cvt_pk_bf16_f32 v57, v58, v59
    v_cvt_pk_bf16_f32 v58, v60, v61
    v_cvt_pk_bf16_f32 v59, v62, v63
    s_waitcnt lgkmcnt(2)
    v_mfma_f32_32x32x16_bf16 v[184:199], v[200:203], v[48:51], v[184:199]
    buffer_load_dwordx4 v248, s[16:19], s67 offen offset:2048 lds
    v_exp_f32 v64, v64
    v_exp_f32 v65, v65
    v_exp_f32 v66, v66
    v_exp_f32 v67, v67
    v_mfma_f32_32x32x16_bf16 v[80:95], v[160:163], v[164:167], v[80:95]
    v_exp_f32 v68, v68
    v_exp_f32 v69, v69
    v_exp_f32 v70, v70
    v_exp_f32 v71, v71
    v_cvt_pk_bf16_f32 v64, v64, v65
    v_cvt_pk_bf16_f32 v65, v66, v67
    v_cvt_pk_bf16_f32 v66, v68, v69
    v_cvt_pk_bf16_f32 v67, v70, v71
    v_mfma_f32_32x32x16_bf16 v[184:199], v[204:207], v[56:59], v[184:199]
    ds_read_b128 v[200:203], v217 offset:10240
    ds_read_b128 v[204:207], v217 offset:11264
    buffer_load_dwordx4 v249, s[16:19], s67 offen offset:3072 lds
    v_exp_f32 v72, v72
    v_exp_f32 v73, v73
    v_exp_f32 v74, v74
    v_exp_f32 v75, v75
    v_exp_f32 v76, v76
    v_exp_f32 v77, v77
    v_exp_f32 v78, v78
    v_exp_f32 v79, v79
    v_cvt_pk_bf16_f32 v72, v72, v73
    v_cvt_pk_bf16_f32 v73, v74, v75
    v_cvt_pk_bf16_f32 v74, v76, v77
    v_cvt_pk_bf16_f32 v75, v78, v79
    s_waitcnt lgkmcnt(2)
    v_mfma_f32_32x32x16_bf16 v[184:199], v[208:211], v[64:67], v[184:199]
    v_exp_f32 v80, v80
    v_exp_f32 v81, v81
    v_exp_f32 v82, v82
    v_exp_f32 v83, v83
    v_mfma_f32_32x32x16_bf16 v[96:111], v[160:163], v[164:167], v[96:111]
    v_exp_f32 v84, v84
    v_exp_f32 v85, v85
    v_exp_f32 v86, v86
    v_exp_f32 v87, v87
    v_cvt_pk_bf16_f32 v80, v80, v81
    v_cvt_pk_bf16_f32 v81, v82, v83
    v_cvt_pk_bf16_f32 v82, v84, v85
    v_cvt_pk_bf16_f32 v83, v86, v87
    v_mfma_f32_32x32x16_bf16 v[184:199], v[212:215], v[72:75], v[184:199]
    ds_read_b128 v[208:211], v217 offset:12288
    ds_read_b128 v[212:215], v217 offset:13312
    v_exp_f32 v88, v88
    v_exp_f32 v89, v89
    v_exp_f32 v90, v90
    v_exp_f32 v91, v91
    v_exp_f32 v92, v92
    v_exp_f32 v93, v93
    v_exp_f32 v94, v94
    v_exp_f32 v95, v95
    v_cvt_pk_bf16_f32 v88, v88, v89
    v_cvt_pk_bf16_f32 v89, v90, v91
    v_cvt_pk_bf16_f32 v90, v92, v93
    v_cvt_pk_bf16_f32 v91, v94, v95
    s_waitcnt lgkmcnt(2)
    v_mfma_f32_32x32x16_bf16 v[184:199], v[200:203], v[80:83], v[184:199]
    v_exp_f32 v96, v96
    v_exp_f32 v97, v97
    v_exp_f32 v98, v98
    v_exp_f32 v99, v99
    v_mfma_f32_32x32x16_bf16 v[112:127], v[160:163], v[164:167], v[112:127]
    v_exp_f32 v100, v100
    v_exp_f32 v101, v101
    v_exp_f32 v102, v102
    v_exp_f32 v103, v103
    v_cvt_pk_bf16_f32 v96, v96, v97
    v_cvt_pk_bf16_f32 v97, v98, v99
    v_cvt_pk_bf16_f32 v98, v100, v101
    v_cvt_pk_bf16_f32 v99, v102, v103
    v_mfma_f32_32x32x16_bf16 v[184:199], v[204:207], v[88:91], v[184:199]
    ds_read_b128 v[200:203], v217 offset:14336
    ds_read_b128 v[204:207], v217 offset:15360
    v_exp_f32 v104, v104
    v_exp_f32 v105, v105
    v_exp_f32 v106, v106
    v_exp_f32 v107, v107
    v_exp_f32 v108, v108
    v_exp_f32 v109, v109
    v_exp_f32 v110, v110
    v_exp_f32 v111, v111
    v_cvt_pk_bf16_f32 v104, v104, v105
    v_cvt_pk_bf16_f32 v105, v106, v107
    v_cvt_pk_bf16_f32 v106, v108, v109
    v_cvt_pk_bf16_f32 v107, v110, v111
    s_waitcnt lgkmcnt(2)
    v_mfma_f32_32x32x16_bf16 v[184:199], v[208:211], v[96:99], v[184:199]
    v_exp_f32 v112, v112
    v_exp_f32 v113, v113
    v_exp_f32 v114, v114
    v_exp_f32 v115, v115
    v_exp_f32 v116, v116
    v_exp_f32 v117, v117
    v_exp_f32 v118, v118
    v_exp_f32 v119, v119
    v_cvt_pk_bf16_f32 v112, v112, v113
    v_cvt_pk_bf16_f32 v113, v114, v115
    v_cvt_pk_bf16_f32 v114, v116, v117
    v_cvt_pk_bf16_f32 v115, v118, v119
    v_mfma_f32_32x32x16_bf16 v[184:199], v[212:215], v[104:107], v[184:199]
    v_exp_f32 v120, v120
    v_exp_f32 v121, v121
    v_exp_f32 v122, v122
    v_exp_f32 v123, v123
    v_exp_f32 v124, v124
    v_exp_f32 v125, v125
    v_exp_f32 v126, v126
    v_exp_f32 v127, v127
    v_cvt_pk_bf16_f32 v120, v120, v121
    v_cvt_pk_bf16_f32 v121, v122, v123
    v_cvt_pk_bf16_f32 v122, v124, v125
    v_cvt_pk_bf16_f32 v123, v126, v127
    s_waitcnt lgkmcnt(0)
    v_mfma_f32_32x32x16_bf16 v[184:199], v[200:203], v[112:115], v[184:199]
    v_mfma_f32_32x32x16_bf16 v[184:199], v[204:207], v[120:123], v[184:199]
    s_nop 11
    v_mov_b32 v239, v196
    v_mov_b32 v240, v196
    s_nop 1
    v_permlane32_swap_b32 v239, v240
    v_rcp_f32 v240, v240
    s_nop 0
    v_pk_mul_f32 v[184:185], v[184:185], v[240:241] op_sel_hi:[1,0]
    s_nop 0
    v_cvt_pk_bf16_f32 v152, v184, v185
    v_pk_mul_f32 v[186:187], v[186:187], v[240:241] op_sel_hi:[1,0]
    s_nop 0
    v_cvt_pk_bf16_f32 v153, v186, v187
    v_pk_mul_f32 v[188:189], v[188:189], v[240:241] op_sel_hi:[1,0]
    s_nop 0
    v_cvt_pk_bf16_f32 v154, v188, v189
    v_pk_mul_f32 v[190:191], v[190:191], v[240:241] op_sel_hi:[1,0]
    s_nop 0
    v_cvt_pk_bf16_f32 v155, v190, v191
    buffer_store_dwordx4 v[152:155], v254, s[36:39], s90 offen offset:0
    v_pk_mul_f32 v[192:193], v[192:193], v[240:241] op_sel_hi:[1,0]
    s_nop 0
    v_cvt_pk_bf16_f32 v156, v192, v193
    v_pk_mul_f32 v[194:195], v[194:195], v[240:241] op_sel_hi:[1,0]
    s_nop 0
    v_cvt_pk_bf16_f32 v157, v194, v195
    v_pk_mul_f32 v[196:197], v[196:197], v[240:241] op_sel_hi:[1,0]
    s_nop 0
    v_cvt_pk_bf16_f32 v158, v196, v197
    v_cndmask_b32 v158, 0, v158, vcc
    v_pk_mul_f32 v[198:199], v[198:199], v[240:241] op_sel_hi:[1,0]
    s_nop 0
    v_cvt_pk_bf16_f32 v159, v198, v199
    v_cndmask_b32 v159, 0, v159, vcc
    buffer_store_dwordx4 v[156:159], v254, s[36:39], s90 offen offset:1024
    s_and_b32 s61, s3, 1
    s_lshl_b32 s61, s61, 12
    s_add_u32 s61, s61, 81920
    v_lshl_add_u32 v4, v243, 7, s61
    v_lshl_add_u32 v4, v244, 3, v4
    v_and_b32 v5, 7, v255
    s_lshl_b32 s61, s55, 2
    v_xor_b32 v5, s61, v5
    v_xor_b32 v6, 0, v5
    v_lshl_add_u32 v124, v6, 4, v4
    v_xor_b32 v6, 1, v5
    v_lshl_add_u32 v125, v6, 4, v4
    v_xor_b32 v6, 2, v5
    v_lshl_add_u32 v126, v6, 4, v4
    v_xor_b32 v6, 3, v5
    v_lshl_add_u32 v127, v6, 4, v4
    ds_read_b64 v[128:129], v124 offset:0
    ds_read_b64 v[130:131], v125 offset:0
    ds_read_b64 v[132:133], v126 offset:0
    ds_read_b64 v[134:135], v127 offset:0
    v_accvgpr_read_b32 v12, a246
    v_accvgpr_read_b32 v13, a247
    v_accvgpr_read_b32 v7, a234
    v_and_b32 v242, 7, v255
    v_lshlrev_b32 v242, 2, v242
    v_bfe_u32 v241, v255, 3, 1
    v_lshl_add_u32 v242, v241, 8, v242
    s_mul_i32 s61, s55, 28672
    v_add_u32 v218, s61, v233
    v_add_u32 v219, s61, v234
    s_add_u32 s61, s78, 98304
    v_add_u32 v216, s61, v254
    s_xor_b32 s61, s61, 8192
    v_add_u32 v217, s61, v254
    s_mov_b32 s79, 0xffff0000
    s_waitcnt lgkmcnt(0)
    v_lshlrev_b32 v168, 16, v128
    v_and_b32 v169, s79, v128
    v_lshlrev_b32 v170, 16, v129
    v_and_b32 v171, s79, v129
    v_lshlrev_b32 v172, 16, v130
    v_and_b32 v173, s79, v130
    v_lshlrev_b32 v174, 16, v131
    v_and_b32 v175, s79, v131
    v_lshlrev_b32 v176, 16, v132
    v_and_b32 v177, s79, v132
    v_lshlrev_b32 v178, 16, v133
    v_and_b32 v179, s79, v133
    v_lshlrev_b32 v180, 16, v134
    v_and_b32 v181, s79, v134
    v_lshlrev_b32 v182, 16, v135
    v_and_b32 v183, s79, v135
    s_waitcnt vmcnt(0)
    s_mov_b64 exec, 1
    s_cmp_eq_u32 s7, 0
    s_cbranch_scc1 L_fs35
    buffer_store_dword v245, off, s[36:39], s91
L_fj36:
    s_mov_b64 exec, -1
    s_barrier
    ds_read_b64_tr_b16 v[184:185], v219 offset:0
    ds_read_b64_tr_b16 v[186:187], v219 offset:1024
    ds_read_b64_tr_b16 v[188:189], v218 offset:0
    ds_read_b64_tr_b16 v[190:191], v218 offset:1024
    ds_read_b64_tr_b16 v[192:193], v219 offset:2048
    ds_read_b64_tr_b16 v[194:195], v219 offset:3072
    ds_read_b64_tr_b16 v[196:197], v218 offset:2048
    ds_read_b64_tr_b16 v[198:199], v218 offset:3072
    ds_read_b64_tr_b16 v[200:201], v219 offset:3584
    ds_read_b64_tr_b16 v[202:203], v219 offset:4608
    s_add_u32 s61, s78, 0
    v_add_u32 v220, s61, v233
    v_add_u32 v221, s61, v234
    s_add_u32 s61, s78, 65536
    v_add_u32 v222, s61, v233
    v_add_u32 v223, s61, v234
    s_add_u32 s61, s78, 131072
    v_add_u32 v224, s61, v233
    v_add_u32 v225, s61, v234
    s_mov_b32 s60, 0
L_p37:
    buffer_load_dword v238, v242, s[36:39], s0 offen sc1
    s_add_u32 s60, s60, 1
    s_cmp_ge_u32 s60, 60000
    s_cbranch_scc1 L_pd38
    s_cmp_eq_u32 s7, 0
    s_waitcnt vmcnt(0)
    v_cmp_ne_u32 vcc, s6, v238
    s_cbranch_vccnz L_p37
L_pd38:
    s_cbranch_scc1 L_pi39
L_pj40:
    buffer_load_dwordx4 v[16:19], v254, s[36:39], s1 offen offset:0 sc1
    buffer_load_dwordx4 v[20:23], v254, s[36:39], s1 offen offset:1024 sc1
    buffer_load_dwordx4 v[24:27], v254, s[36:39], s1 offen offset:2048 sc1
    buffer_load_dwordx4 v[28:31], v254, s[36:39], s1 offen offset:3072 sc1
    s_add_u32 s1, s1, 4096
    buffer_load_dwordx4 v[32:35], v254, s[36:39], s1 offen offset:0 sc1
    buffer_load_dwordx4 v[36:39], v254, s[36:39], s1 offen offset:1024 sc1
    buffer_load_dwordx4 v[40:43], v254, s[36:39], s1 offen offset:2048 sc1
    buffer_load_dwordx4 v[44:47], v254, s[36:39], s1 offen offset:3072 sc1
    s_add_u32 s1, s1, 4096
    buffer_load_dwordx4 v[48:51], v254, s[36:39], s1 offen offset:0 sc1
    buffer_load_dwordx4 v[52:55], v254, s[36:39], s1 offen offset:1024 sc1
    s_mov_b32 s60, 0
L_nv:
    v_cmp_ne_u32 vcc, s6, v229
    v_cmp_ne_u32 s[62:63], s6, v231
    s_nop 0
    s_or_b64 vcc, vcc, s[62:63]
    s_cbranch_vccnz L_nvr
L_nvd:
    v_cmp_lt_u32 vcc, 23, v243
    s_nop 1
    v_cndmask_b32 v8, v228, v12, vcc
    v_cndmask_b32 v10, v230, v13, vcc
    v_and_b32 v9, s79, v8
    v_lshlrev_b32 v8, 16, v8
    v_and_b32 v11, s79, v10
    v_lshlrev_b32 v10, 16, v10
    ds_write_b128 v7, v[8:11]
    s_waitcnt vmcnt(9)
    s_waitcnt lgkmcnt(9)
    v_mfma_f32_32x32x16_bf16 v[96:111], v[184:187], v[16:19], 0
    ds_read_b64_tr_b16 v[204:205], v218 offset:3584
    ds_read_b64_tr_b16 v[206:207], v218 offset:4608
    buffer_load_dwordx4 v[56:59], v254, s[36:39], s1 offen offset:2048 sc1
    s_waitcnt lgkmcnt(9)
    v_mfma_f32_32x32x16_bf16 v[80:95], v[188:191], v[16:19], 0
    ds_read_b64_tr_b16 v[208:209], v219 offset:5632
    ds_read_b64_tr_b16 v[210:211], v219 offset:6656
    ds_read_b128 v[136:139], v235 offset:0
    ds_read_b128 v[152:155], v235 offset:128
    ds_read_b128 v[140:143], v235 offset:32
    s_waitcnt vmcnt(9)
    s_waitcnt lgkmcnt(12)
    v_mfma_f32_32x32x16_bf16 v[96:111], v[192:195], v[20:23], v[96:111]
    ds_read_b64_tr_b16 v[212:213], v218 offset:5632
    ds_read_b64_tr_b16 v[214:215], v218 offset:6656
    buffer_load_dwordx4 v[60:63], v254, s[36:39], s1 offen offset:3072 sc1
    s_waitcnt lgkmcnt(12)
    v_mfma_f32_32x32x16_bf16 v[80:95], v[196:199], v[20:23], v[80:95]
    ds_read_b64_tr_b16 v[184:185], v219 offset:7168
    ds_read_b64_tr_b16 v[186:187], v219 offset:8192
    ds_read_b128 v[156:159], v235 offset:160
    ds_read_b128 v[144:147], v235 offset:64
    ds_read_b128 v[160:163], v235 offset:192
    s_waitcnt vmcnt(9)
    s_waitcnt lgkmcnt(15)
    v_mfma_f32_32x32x16_bf16 v[96:111], v[200:203], v[24:27], v[96:111]
    ds_read_b64_tr_b16 v[188:189], v218 offset:7168
    ds_read_b64_tr_b16 v[190:191], v218 offset:8192
    s_add_u32 s1, s1, 4096
    buffer_load_dwordx4 v[64:67], v254, s[36:39], s1 offen offset:0 sc1
    s_waitcnt lgkmcnt(14)
    v_mfma_f32_32x32x16_bf16 v[80:95], v[204:207], v[24:27], v[80:95]
    ds_read_b64_tr_b16 v[192:193], v219 offset:9216
    ds_read_b64_tr_b16 v[194:195], v219 offset:10240
    ds_read_b128 v[148:151], v235 offset:96
    ds_read_b128 v[164:167], v235 offset:224
    s_waitcnt vmcnt(9)
    s_waitcnt lgkmcnt(15)
    v_mfma_f32_32x32x16_bf16 v[96:111], v[208:211], v[28:31], v[96:111]
    ds_read_b64_tr_b16 v[196:197], v218 offset:9216
    ds_read_b64_tr_b16 v[198:199], v218 offset:10240
    buffer_load_dwordx4 v[68:71], v254, s[36:39], s1 offen offset:1024 sc1
    s_waitcnt lgkmcnt(13)
    v_mfma_f32_32x32x16_bf16 v[80:95], v[212:215], v[28:31], v[80:95]
    ds_read_b64_tr_b16 v[200:201], v219 offset:10752
    ds_read_b64_tr_b16 v[202:203], v219 offset:11776
    s_waitcnt vmcnt(9)
    s_waitcnt lgkmcnt(13)
    v_mfma_f32_32x32x16_bf16 v[96:111], v[184:187], v[32:35], v[96:111]
    ds_read_b64_tr_b16 v[204:205], v218 offset:10752
    ds_read_b64_tr_b16 v[206:207], v218 offset:11776
    buffer_load_dwordx4 v[72:75], v254, s[36:39], s1 offen offset:2048 sc1
    s_waitcnt lgkmcnt(10)
    v_mfma_f32_32x32x16_bf16 v[80:95], v[188:191], v[32:35], v[80:95]
    ds_read_b64_tr_b16 v[208:209], v219 offset:12800
    ds_read_b64_tr_b16 v[210:211], v219 offset:13824
    s_waitcnt vmcnt(9)
    s_waitcnt lgkmcnt(10)
    v_mfma_f32_32x32x16_bf16 v[96:111], v[192:195], v[36:39], v[96:111]
    ds_read_b64_tr_b16 v[212:213], v218 offset:12800
    ds_read_b64_tr_b16 v[214:215], v218 offset:13824
    buffer_load_dwordx4 v[76:79], v254, s[36:39], s1 offen offset:3072 sc1
    s_waitcnt lgkmcnt(8)
    v_mfma_f32_32x32x16_bf16 v[80:95], v[196:199], v[36:39], v[80:95]
    ds_read_b64_tr_b16 v[184:185], v219 offset:14336
    ds_read_b64_tr_b16 v[186:187], v219 offset:15360
    s_waitcnt vmcnt(9)
    s_waitcnt lgkmcnt(8)
    v_mfma_f32_32x32x16_bf16 v[96:111], v[200:203], v[40:43], v[96:111]
    ds_read_b64_tr_b16 v[188:189], v218 offset:14336
    ds_read_b64_tr_b16 v[190:191], v218 offset:15360
    s_add_u32 s1, s1, 118784
    buffer_load_dwordx4 v[16:19], v254, s[36:39], s1 offen offset:0 sc1
    s_waitcnt lgkmcnt(8)
    v_mfma_f32_32x32x16_bf16 v[80:95], v[204:207], v[40:43], v[80:95]
    ds_read_b64_tr_b16 v[192:193], v219 offset:16384
    ds_read_b64_tr_b16 v[194:195], v219 offset:17408
    s_waitcnt vmcnt(9)
    s_waitcnt lgkmcnt(8)
    v_mfma_f32_32x32x16_bf16 v[96:111], v[208:211], v[44:47], v[96:111]
    ds_read_b64_tr_b16 v[196:197], v218 offset:16384
    ds_read_b64_tr_b16 v[198:199], v218 offset:17408
    buffer_load_dwordx4 v[20:23], v254, s[36:39], s1 offen offset:1024 sc1
    s_waitcnt lgkmcnt(8)
    v_mfma_f32_32x32x16_bf16 v[80:95], v[212:215], v[44:47], v[80:95]
    ds_read_b64_tr_b16 v[200:201], v219 offset:17920
    ds_read_b64_tr_b16 v[202:203], v219 offset:18944
    s_waitcnt vmcnt(9)
    s_waitcnt lgkmcnt(8)
    v_mfma_f32_32x32x16_bf16 v[96:111], v[184:187], v[48:51], v[96:111]
    ds_read_b64_tr_b16 v[204:205], v218 offset:17920
    ds_read_b64_tr_b16 v[206:207], v218 offset:18944
    buffer_load_dwordx4 v[24:27], v254, s[36:39], s1 offen offset:2048 sc1
    s_waitcnt lgkmcnt(8)
    v_mfma_f32_32x32x16_bf16 v[80:95], v[188:191], v[48:51], v[80:95]
    ds_read_b64_tr_b16 v[208:209], v219 offset:19968
    ds_read_b64_tr_b16 v[210:211], v219 offset:20992
    s_waitcnt vmcnt(9)
    s_waitcnt lgkmcnt(8)
    v_mfma_f32_32x32x16_bf16 v[96:111], v[192:195], v[52:55], v[96:111]
    ds_read_b64_tr_b16 v[212:213], v219 offset:21504
    ds_read_b64_tr_b16 v[214:215], v219 offset:22528
    buffer_load_dwordx4 v[28:31], v254, s[36:39], s1 offen offset:3072 sc1
    s_waitcnt lgkmcnt(8)
    v_mfma_f32_32x32x16_bf16 v[80:95], v[196:199], v[52:55], v[80:95]
    ds_read_b64_tr_b16 v[184:185], v219 offset:23552
    ds_read_b64_tr_b16 v[186:187], v219 offset:24576
    s_waitcnt vmcnt(9)
    s_waitcnt lgkmcnt(8)
    v_mfma_f32_32x32x16_bf16 v[96:111], v[200:203], v[56:59], v[96:111]
    ds_read_b64_tr_b16 v[188:189], v219 offset:25088
    ds_read_b64_tr_b16 v[190:191], v219 offset:26112
    s_add_u32 s1, s1, 4096
    buffer_load_dwordx4 v[32:35], v254, s[36:39], s1 offen offset:0 sc1
    s_waitcnt lgkmcnt(8)
    v_mfma_f32_32x32x16_bf16 v[80:95], v[204:207], v[56:59], v[80:95]
    ds_read_b64_tr_b16 v[192:193], v219 offset:27136
    ds_read_b64_tr_b16 v[194:195], v219 offset:28160
    s_waitcnt vmcnt(9)
    s_waitcnt lgkmcnt(8)
    v_mfma_f32_32x32x16_bf16 v[96:111], v[208:211], v[60:63], v[96:111]
    ds_read_b64_tr_b16 v[196:197], v218 offset:19968
    ds_read_b64_tr_b16 v[198:199], v218 offset:20992
    buffer_load_dwordx4 v[36:39], v254, s[36:39], s1 offen offset:1024 sc1
    s_waitcnt vmcnt(9)
    s_waitcnt lgkmcnt(8)
    v_mfma_f32_32x32x16_bf16 v[96:111], v[212:215], v[64:67], v[96:111]
    ds_read_b64_tr_b16 v[200:201], v218 offset:21504
    ds_read_b64_tr_b16 v[202:203], v218 offset:22528
    s_waitcnt vmcnt(8)
    s_waitcnt lgkmcnt(8)
    v_mfma_f32_32x32x16_bf16 v[96:111], v[184:187], v[68:71], v[96:111]
    ds_read_b64_tr_b16 v[204:205], v218 offset:23552
    ds_read_b64_tr_b16 v[206:207], v218 offset:24576
    buffer_load_dwordx4 v[40:43], v254, s[36:39], s1 offen offset:2048 sc1
    s_waitcnt vmcnt(8)
    s_waitcnt lgkmcnt(8)
    v_mfma_f32_32x32x16_bf16 v[96:111], v[188:191], v[72:75], v[96:111]
    ds_read_b64_tr_b16 v[208:209], v218 offset:25088
    ds_read_b64_tr_b16 v[210:211], v218 offset:26112
    s_waitcnt vmcnt(7)
    s_waitcnt lgkmcnt(8)
    v_mfma_f32_32x32x16_bf16 v[96:111], v[192:195], v[76:79], v[96:111]
    ds_read_b64_tr_b16 v[212:213], v218 offset:27136
    ds_read_b64_tr_b16 v[214:215], v218 offset:28160
    buffer_load_dwordx4 v[44:47], v254, s[36:39], s1 offen offset:3072 sc1
    s_waitcnt lgkmcnt(8)
    v_mfma_f32_32x32x16_bf16 v[80:95], v[196:199], v[60:63], v[80:95]
    ds_read_b64_tr_b16 v[184:185], v219 offset:0
    ds_read_b64_tr_b16 v[186:187], v219 offset:1024
    s_waitcnt lgkmcnt(8)
    v_mfma_f32_32x32x16_bf16 v[80:95], v[200:203], v[64:67], v[80:95]
    ds_read_b64_tr_b16 v[188:189], v218 offset:0
    ds_read_b64_tr_b16 v[190:191], v218 offset:1024
    s_waitcnt lgkmcnt(8)
    v_mfma_f32_32x32x16_bf16 v[80:95], v[204:207], v[68:71], v[80:95]
    ds_read_b64_tr_b16 v[192:193], v219 offset:2048
    ds_read_b64_tr_b16 v[194:195], v219 offset:3072
    ds_write_b128 v217, v[96:99] offset:0
    ds_write_b128 v217, v[100:103] offset:1024
    s_waitcnt lgkmcnt(10)
    v_mfma_f32_32x32x16_bf16 v[80:95], v[208:211], v[72:75], v[80:95]
    ds_read_b64_tr_b16 v[196:197], v218 offset:2048
    ds_read_b64_tr_b16 v[198:199], v218 offset:3072
    ds_write_b128 v217, v[104:107] offset:2048
    ds_write_b128 v217, v[108:111] offset:3072
    s_waitcnt lgkmcnt(12)
    v_mfma_f32_32x32x16_bf16 v[80:95], v[212:215], v[76:79], v[80:95]
    ds_read_b64_tr_b16 v[200:201], v219 offset:3584
    ds_read_b64_tr_b16 v[202:203], v219 offset:4608
    s_waitcnt lgkmcnt(0)
    s_barrier
    ds_read_b128 v[0:3], v216 offset:0
    ds_read_b128 v[4:7], v216 offset:1024
    ds_read_b128 v[8:11], v216 offset:2048
    ds_read_b128 v[12:15], v216 offset:3072
    s_waitcnt lgkmcnt(3)
    .p2align 3
    s_nop 2
    v_pk_add_f32 v[0:1], v[80:81], v[0:1]
    v_pk_fma_f32 v[168:169], v[0:1], v[136:137], v[168:169]
    v_pk_mul_f32 v[0:1], v[168:169], v[152:153]
    v_cvt_pk_bf16_f32 v112, v0, v1
    v_pk_add_f32 v[2:3], v[82:83], v[2:3]
    v_pk_fma_f32 v[170:171], v[2:3], v[138:139], v[170:171]
    v_pk_mul_f32 v[2:3], v[170:171], v[154:155]
    v_cvt_pk_bf16_f32 v113, v2, v3
    s_waitcnt lgkmcnt(2)
    .p2align 3
    v_pk_add_f32 v[4:5], v[84:85], v[4:5]
    v_pk_fma_f32 v[172:173], v[4:5], v[140:141], v[172:173]
    v_pk_mul_f32 v[4:5], v[172:173], v[156:157]
    v_cvt_pk_bf16_f32 v114, v4, v5
    v_pk_add_f32 v[6:7], v[86:87], v[6:7]
    v_pk_fma_f32 v[174:175], v[6:7], v[142:143], v[174:175]
    v_pk_mul_f32 v[6:7], v[174:175], v[158:159]
    v_cvt_pk_bf16_f32 v115, v6, v7
    buffer_store_dwordx4 v[112:115], v254, s[32:35], s98 offen offset:0
    s_waitcnt lgkmcnt(1)
    .p2align 3
    v_pk_add_f32 v[8:9], v[88:89], v[8:9]
    v_pk_fma_f32 v[176:177], v[8:9], v[144:145], v[176:177]
    v_pk_mul_f32 v[8:9], v[176:177], v[160:161]
    v_cvt_pk_bf16_f32 v116, v8, v9
    v_pk_add_f32 v[10:11], v[90:91], v[10:11]
    v_pk_fma_f32 v[178:179], v[10:11], v[146:147], v[178:179]
    v_pk_mul_f32 v[10:11], v[178:179], v[162:163]
    v_cvt_pk_bf16_f32 v117, v10, v11
    s_waitcnt lgkmcnt(0)
    .p2align 3
    v_pk_add_f32 v[12:13], v[92:93], v[12:13]
    v_pk_fma_f32 v[180:181], v[12:13], v[148:149], v[180:181]
    v_pk_mul_f32 v[12:13], v[180:181], v[164:165]
    v_cvt_pk_bf16_f32 v118, v12, v13
    v_pk_add_f32 v[14:15], v[94:95], v[14:15]
    v_pk_fma_f32 v[182:183], v[14:15], v[150:151], v[182:183]
    v_pk_mul_f32 v[14:15], v[182:183], v[166:167]
    v_cvt_pk_bf16_f32 v119, v14, v15
    buffer_store_dwordx4 v[116:119], v254, s[32:35], s98 offen offset:1024
    v_pk_add_f32 v[120:121], v[168:169], v[170:171]
    v_pk_mul_f32 v[122:123], v[168:169], v[168:169]
    v_pk_fma_f32 v[122:123], v[170:171], v[170:171], v[122:123]
    v_pk_add_f32 v[120:121], v[120:121], v[172:173]
    v_pk_fma_f32 v[122:123], v[172:173], v[172:173], v[122:123]
    v_pk_add_f32 v[120:121], v[120:121], v[174:175]
    v_pk_fma_f32 v[122:123], v[174:175], v[174:175], v[122:123]
    v_pk_add_f32 v[120:121], v[120:121], v[176:177]
    v_pk_fma_f32 v[122:123], v[176:177], v[176:177], v[122:123]
    v_pk_add_f32 v[120:121], v[120:121], v[178:179]
    v_pk_fma_f32 v[122:123], v[178:179], v[178:179], v[122:123]
    v_pk_add_f32 v[120:121], v[120:121], v[180:181]
    v_pk_fma_f32 v[122:123], v[180:181], v[180:181], v[122:123]
    v_pk_add_f32 v[120:121], v[120:121], v[182:183]
    v_pk_fma_f32 v[122:123], v[182:183], v[182:183], v[122:123]
    v_add_f32 v120, v120, v121
    v_add_f32 v121, v122, v123
    v_mov_b32 v122, v120
    v_mov_b32 v123, v121
    s_nop 0
    v_permlane32_swap_b32 v120, v122
    v_permlane32_swap_b32 v121, v123
    v_add_f32 v120, v120, v122
    v_add_f32 v121, v121, v123
    s_mov_b32 exec_hi, 0
    buffer_store_dwordx2 v[120:121], v254, s[36:39], s44 offen
    s_mov_b64 exec, -1
    s_waitcnt vmcnt(10)
    v_mfma_f32_32x32x16_bf16 v[96:111], v[184:187], v[16:19], 0
    ds_read_b64_tr_b16 v[204:205], v218 offset:3584
    ds_read_b64_tr_b16 v[206:207], v218 offset:4608
    s_add_u32 s1, s1, 4096
    buffer_load_dwordx4 v[48:51], v254, s[36:39], s1 offen offset:0 sc1
    buffer_load_dwordx4 v[52:55], v254, s[36:39], s1 offen offset:1024 sc1
    v_mfma_f32_32x32x16_bf16 v[80:95], v[188:191], v[16:19], 0
    ds_read_b64_tr_b16 v[208:209], v219 offset:5632
    ds_read_b64_tr_b16 v[210:211], v219 offset:6656
    ds_read_b64 v[128:129], v124 offset:8192
    ds_read_b64 v[130:131], v125 offset:8192
    ds_read_b64 v[132:133], v126 offset:8192
    s_waitcnt vmcnt(11)
    v_mfma_f32_32x32x16_bf16 v[96:111], v[192:195], v[20:23], v[96:111]
    ds_read_b64_tr_b16 v[212:213], v218 offset:5632
    ds_read_b64_tr_b16 v[214:215], v218 offset:6656
    buffer_load_dwordx4 v[56:59], v254, s[36:39], s1 offen offset:2048 sc1
    v_mfma_f32_32x32x16_bf16 v[80:95], v[196:199], v[20:23], v[80:95]
    ds_read_b64_tr_b16 v[184:185], v219 offset:7168
    ds_read_b64_tr_b16 v[186:187], v219 offset:8192
    ds_read_b64 v[134:135], v127 offset:8192
    v_accvgpr_write_b32 a224, v168
    v_accvgpr_write_b32 a225, v169
L_sb15:
    s_cbranch_execz L_wzc
    s_waitcnt vmcnt(11)
    v_mfma_f32_32x32x16_bf16 v[96:111], v[200:203], v[24:27], v[96:111]
    ds_read_b64_tr_b16 v[188:189], v218 offset:7168
    ds_read_b64_tr_b16 v[190:191], v218 offset:8192
    buffer_load_dwordx4 v[60:63], v254, s[36:39], s1 offen offset:3072 sc1
    s_waitcnt lgkmcnt(12)
    v_mfma_f32_32x32x16_bf16 v[80:95], v[204:207], v[24:27], v[80:95]
    ds_read_b64_tr_b16 v[192:193], v219 offset:9216
    ds_read_b64_tr_b16 v[194:195], v219 offset:10240
    v_accvgpr_write_b32 a226, v170
    v_accvgpr_write_b32 a227, v171
    v_accvgpr_write_b32 a228, v172
    s_waitcnt vmcnt(11)
    s_waitcnt lgkmcnt(12)
    v_mfma_f32_32x32x16_bf16 v[96:111], v[208:211], v[28:31], v[96:111]
    ds_read_b64_tr_b16 v[196:197], v218 offset:9216
    ds_read_b64_tr_b16 v[198:199], v218 offset:10240
    s_add_u32 s1, s1, 4096
    buffer_load_dwordx4 v[64:67], v254, s[36:39], s1 offen offset:0 sc1
    s_waitcnt vmcnt(5)
    s_mov_b64 exec, 1
    s_cmp_eq_u32 s7, 0
    s_cbranch_scc1 L_fs41
    buffer_store_dword v245, off, s[36:39], s99
L_fj42:
    s_mov_b64 exec, -1
    s_waitcnt lgkmcnt(9)
    v_mfma_f32_32x32x16_bf16 v[80:95], v[212:215], v[28:31], v[80:95]
    ds_read_b64_tr_b16 v[200:201], v219 offset:10752
    ds_read_b64_tr_b16 v[202:203], v219 offset:11776
    v_accvgpr_write_b32 a229, v173
    v_accvgpr_write_b32 a230, v174
    v_accvgpr_write_b32 a231, v175
    s_waitcnt lgkmcnt(9)
    v_mfma_f32_32x32x16_bf16 v[96:111], v[184:187], v[32:35], v[96:111]
    ds_read_b64_tr_b16 v[204:205], v218 offset:10752
    ds_read_b64_tr_b16 v[206:207], v218 offset:11776
    buffer_load_dwordx4 v[68:71], v254, s[36:39], s1 offen offset:1024 sc1
    s_waitcnt lgkmcnt(8)
    v_mfma_f32_32x32x16_bf16 v[80:95], v[188:191], v[32:35], v[80:95]
    ds_read_b64_tr_b16 v[208:209], v219 offset:12800
    ds_read_b64_tr_b16 v[210:211], v219 offset:13824
    v_accvgpr_write_b32 a232, v176
    v_accvgpr_write_b32 a233, v177
    v_accvgpr_write_b32 a234, v178
    s_waitcnt lgkmcnt(8)
    v_mfma_f32_32x32x16_bf16 v[96:111], v[192:195], v[36:39], v[96:111]
    ds_read_b64_tr_b16 v[212:213], v218 offset:12800
    ds_read_b64_tr_b16 v[214:215], v218 offset:13824
    buffer_load_dwordx4 v[72:75], v254, s[36:39], s1 offen offset:2048 sc1
    s_waitcnt lgkmcnt(8)
    v_mfma_f32_32x32x16_bf16 v[80:95], v[196:199], v[36:39], v[80:95]
    ds_read_b64_tr_b16 v[184:185], v219 offset:14336
    ds_read_b64_tr_b16 v[186:187], v219 offset:15360
    v_accvgpr_write_b32 a235, v179
    v_accvgpr_write_b32 a236, v180
    v_accvgpr_write_b32 a237, v181
    s_waitcnt lgkmcnt(8)
    v_mfma_f32_32x32x16_bf16 v[96:111], v[200:203], v[40:43], v[96:111]
    ds_read_b64_tr_b16 v[188:189], v218 offset:14336
    ds_read_b64_tr_b16 v[190:191], v218 offset:15360
    buffer_load_dwordx4 v[76:79], v254, s[36:39], s1 offen offset:3072 sc1
    s_waitcnt lgkmcnt(8)
    v_mfma_f32_32x32x16_bf16 v[80:95], v[204:207], v[40:43], v[80:95]
    ds_read_b64_tr_b16 v[192:193], v219 offset:16384
    ds_read_b64_tr_b16 v[194:195], v219 offset:17408
    v_accvgpr_write_b32 a238, v182
    v_accvgpr_write_b32 a239, v183
    s_waitcnt lgkmcnt(8)
    v_mfma_f32_32x32x16_bf16 v[96:111], v[208:211], v[44:47], v[96:111]
    ds_read_b64_tr_b16 v[196:197], v218 offset:16384
    ds_read_b64_tr_b16 v[198:199], v218 offset:17408
    s_waitcnt lgkmcnt(8)
    v_mfma_f32_32x32x16_bf16 v[80:95], v[212:215], v[44:47], v[80:95]
    ds_read_b64_tr_b16 v[200:201], v219 offset:17920
    ds_read_b64_tr_b16 v[202:203], v219 offset:18944
    v_lshlrev_b32 v168, 16, v128
    v_and_b32 v169, s79, v128
    v_lshlrev_b32 v170, 16, v129
    s_waitcnt vmcnt(8)
    s_waitcnt lgkmcnt(8)
    v_mfma_f32_32x32x16_bf16 v[96:111], v[184:187], v[48:51], v[96:111]
    ds_read_b64_tr_b16 v[204:205], v218 offset:17920
    ds_read_b64_tr_b16 v[206:207], v218 offset:18944
    s_add_u32 m0, s78, 65536
    s_mul_i32 s67, s70, 28672
    s_add_u32 s67, s67, s59
    buffer_load_dwordx4 v246, s[24:27], s67 offen offset:0 lds
    s_waitcnt lgkmcnt(8)
    v_mfma_f32_32x32x16_bf16 v[80:95], v[188:191], v[48:51], v[80:95]
    ds_read_b64_tr_b16 v[208:209], v219 offset:19968
    ds_read_b64_tr_b16 v[210:211], v219 offset:20992
    v_and_b32 v171, s79, v129
    v_lshlrev_b32 v172, 16, v130
    v_and_b32 v173, s79, v130
    s_waitcnt vmcnt(8)
    s_waitcnt lgkmcnt(8)
    v_mfma_f32_32x32x16_bf16 v[96:111], v[192:195], v[52:55], v[96:111]
    ds_read_b64_tr_b16 v[212:213], v219 offset:21504
    ds_read_b64_tr_b16 v[214:215], v219 offset:22528
    buffer_load_dwordx4 v247, s[24:27], s67 offen offset:1024 lds
    s_waitcnt lgkmcnt(8)
    v_mfma_f32_32x32x16_bf16 v[80:95], v[196:199], v[52:55], v[80:95]
    ds_read_b64_tr_b16 v[184:185], v219 offset:23552
    ds_read_b64_tr_b16 v[186:187], v219 offset:24576
    v_lshlrev_b32 v174, 16, v131
    v_and_b32 v175, s79, v131
    v_lshlrev_b32 v176, 16, v132
    s_waitcnt vmcnt(8)
    s_waitcnt lgkmcnt(8)
    v_mfma_f32_32x32x16_bf16 v[96:111], v[200:203], v[56:59], v[96:111]
    ds_read_b64_tr_b16 v[188:189], v219 offset:25088
    ds_read_b64_tr_b16 v[190:191], v219 offset:26112
    buffer_load_dwordx4 v248, s[24:27], s67 offen offset:2048 lds
    s_waitcnt lgkmcnt(8)
    v_mfma_f32_32x32x16_bf16 v[80:95], v[204:207], v[56:59], v[80:95]
    ds_read_b64_tr_b16 v[192:193], v219 offset:27136
    ds_read_b64_tr_b16 v[194:195], v219 offset:28160
    v_and_b32 v177, s79, v132
    v_lshlrev_b32 v178, 16, v133
    v_and_b32 v179, s79, v133
    s_waitcnt vmcnt(8)
    s_waitcnt lgkmcnt(8)
    v_mfma_f32_32x32x16_bf16 v[96:111], v[208:211], v[60:63], v[96:111]
    ds_read_b64_tr_b16 v[196:197], v218 offset:19968
    ds_read_b64_tr_b16 v[198:199], v218 offset:20992
    buffer_load_dwordx4 v249, s[24:27], s67 offen offset:3072 lds
    s_waitcnt vmcnt(8)
    s_waitcnt lgkmcnt(8)
    v_mfma_f32_32x32x16_bf16 v[96:111], v[212:215], v[64:67], v[96:111]
    ds_read_b64_tr_b16 v[200:201], v218 offset:21504
    ds_read_b64_tr_b16 v[202:203], v218 offset:22528
    v_lshlrev_b32 v180, 16, v134
    v_and_b32 v181, s79, v134
    v_lshlrev_b32 v182, 16, v135
    s_waitcnt vmcnt(6)
    s_waitcnt lgkmcnt(8)
    v_mfma_f32_32x32x16_bf16 v[96:111], v[184:187], v[68:71], v[96:111]
    ds_read_b64_tr_b16 v[204:205], v218 offset:23552
    ds_read_b64_tr_b16 v[206:207], v218 offset:24576
    s_add_u32 m0, s78, 131072
    s_mul_i32 s67, s71, 28672
    s_add_u32 s67, s67, s59
    buffer_load_dwordx4 v246, s[24:27], s67 offen offset:0 lds
    s_waitcnt vmcnt(6)
    s_waitcnt lgkmcnt(8)
    v_mfma_f32_32x32x16_bf16 v[96:111], v[188:191], v[72:75], v[96:111]
    ds_read_b64_tr_b16 v[208:209], v218 offset:25088
    ds_read_b64_tr_b16 v[210:211], v218 offset:26112
    v_and_b32 v183, s79, v135
    s_waitcnt vmcnt(5)
    s_waitcnt lgkmcnt(8)
    v_mfma_f32_32x32x16_bf16 v[96:111], v[192:195], v[76:79], v[96:111]
    ds_read_b64_tr_b16 v[212:213], v218 offset:27136
    ds_read_b64_tr_b16 v[214:215], v218 offset:28160
    buffer_load_dwordx4 v247, s[24:27], s67 offen offset:1024 lds
    s_waitcnt lgkmcnt(8)
    v_mfma_f32_32x32x16_bf16 v[80:95], v[196:199], v[60:63], v[80:95]
    s_waitcnt lgkmcnt(6)
    v_mfma_f32_32x32x16_bf16 v[80:95], v[200:203], v[64:67], v[80:95]
    buffer_load_dwordx4 v248, s[24:27], s67 offen offset:2048 lds
    s_waitcnt lgkmcnt(4)
    v_mfma_f32_32x32x16_bf16 v[80:95], v[204:207], v[68:71], v[80:95]
    s_nop 1
    ds_write_b128 v217, v[96:99] offset:16384
    ds_write_b128 v217, v[100:103] offset:17408
    s_waitcnt lgkmcnt(4)
    v_mfma_f32_32x32x16_bf16 v[80:95], v[208:211], v[72:75], v[80:95]
    buffer_load_dwordx4 v249, s[24:27], s67 offen offset:3072 lds
    ds_write_b128 v217, v[104:107] offset:18432
    ds_write_b128 v217, v[108:111] offset:19456
    s_waitcnt lgkmcnt(4)
    v_mfma_f32_32x32x16_bf16 v[80:95], v[212:215], v[76:79], v[80:95]
    s_waitcnt lgkmcnt(0)
    s_barrier
    ds_read_b128 v[0:3], v216 offset:16384
    ds_read_b128 v[4:7], v216 offset:17408
    ds_read_b128 v[8:11], v216 offset:18432
    ds_read_b128 v[12:15], v216 offset:19456
    s_add_u32 s98, s98, 114688
    s_add_u32 s44, s44, 14336
    s_add_u32 s99, s99, 256
    s_waitcnt lgkmcnt(3)
    .p2align 3
    s_nop 1
    v_pk_add_f32 v[0:1], v[80:81], v[0:1]
    v_pk_fma_f32 v[168:169], v[0:1], v[136:137], v[168:169]
    v_pk_mul_f32 v[0:1], v[168:169], v[152:153]
    v_cvt_pk_bf16_f32 v112, v0, v1
    v_pk_add_f32 v[2:3], v[82:83], v[2:3]
    v_pk_fma_f32 v[170:171], v[2:3], v[138:139], v[170:171]
    v_pk_mul_f32 v[2:3], v[170:171], v[154:155]
    v_cvt_pk_bf16_f32 v113, v2, v3
    s_waitcnt lgkmcnt(2)
    .p2align 3
    v_pk_add_f32 v[4:5], v[84:85], v[4:5]
    v_pk_fma_f32 v[172:173], v[4:5], v[140:141], v[172:173]
    v_pk_mul_f32 v[4:5], v[172:173], v[156:157]
    v_cvt_pk_bf16_f32 v114, v4, v5
    v_pk_add_f32 v[6:7], v[86:87], v[6:7]
    v_pk_fma_f32 v[174:175], v[6:7], v[142:143], v[174:175]
    v_pk_mul_f32 v[6:7], v[174:175], v[158:159]
    v_cvt_pk_bf16_f32 v115, v6, v7
    buffer_store_dwordx4 v[112:115], v254, s[32:35], s98 offen offset:0
    s_waitcnt lgkmcnt(1)
    .p2align 3
    v_pk_add_f32 v[8:9], v[88:89], v[8:9]
    v_pk_fma_f32 v[176:177], v[8:9], v[144:145], v[176:177]
    v_pk_mul_f32 v[8:9], v[176:177], v[160:161]
    v_cvt_pk_bf16_f32 v116, v8, v9
    v_pk_add_f32 v[10:11], v[90:91], v[10:11]
    v_pk_fma_f32 v[178:179], v[10:11], v[146:147], v[178:179]
    v_pk_mul_f32 v[10:11], v[178:179], v[162:163]
    v_cvt_pk_bf16_f32 v117, v10, v11
    s_waitcnt lgkmcnt(0)
    .p2align 3
    v_pk_add_f32 v[12:13], v[92:93], v[12:13]
    v_pk_fma_f32 v[180:181], v[12:13], v[148:149], v[180:181]
    v_pk_mul_f32 v[12:13], v[180:181], v[164:165]
    v_cvt_pk_bf16_f32 v118, v12, v13
    v_pk_add_f32 v[14:15], v[94:95], v[14:15]
    v_pk_fma_f32 v[182:183], v[14:15], v[150:151], v[182:183]
    v_pk_mul_f32 v[14:15], v[182:183], v[166:167]
    v_cvt_pk_bf16_f32 v119, v14, v15
    buffer_store_dwordx4 v[116:119], v254, s[32:35], s98 offen offset:1024
    v_pk_add_f32 v[120:121], v[168:169], v[170:171]
    v_pk_mul_f32 v[122:123], v[168:169], v[168:169]
    v_pk_fma_f32 v[122:123], v[170:171], v[170:171], v[122:123]
    v_pk_add_f32 v[120:121], v[120:121], v[172:173]
    v_pk_fma_f32 v[122:123], v[172:173], v[172:173], v[122:123]
    v_pk_add_f32 v[120:121], v[120:121], v[174:175]
    v_pk_fma_f32 v[122:123], v[174:175], v[174:175], v[122:123]
    v_pk_add_f32 v[120:121], v[120:121], v[176:177]
    v_pk_fma_f32 v[122:123], v[176:177], v[176:177], v[122:123]
    v_pk_add_f32 v[120:121], v[120:121], v[178:179]
    v_pk_fma_f32 v[122:123], v[178:179], v[178:179], v[122:123]
    v_pk_add_f32 v[120:121], v[120:121], v[180:181]
    v_pk_fma_f32 v[122:123], v[180:181], v[180:181], v[122:123]
    v_pk_add_f32 v[120:121], v[120:121], v[182:183]
    v_pk_fma_f32 v[122:123], v[182:183], v[182:183], v[122:123]
    v_add_f32 v120, v120, v121
    v_add_f32 v121, v122, v123
    v_mov_b32 v122, v120
    v_mov_b32 v123, v121
    s_nop 0
    v_permlane32_swap_b32 v120, v122
    v_permlane32_swap_b32 v121, v123
    v_add_f32 v120, v120, v122
    v_add_f32 v121, v121, v123
    s_mov_b32 exec_hi, 0
    buffer_store_dwordx2 v[120:121], v254, s[36:39], s44 offen
    s_mov_b64 exec, -1
    s_add_u32 m0, s78, 0
    s_mul_i32 s67, s72, 28672
    s_add_u32 s67, s67, s59
    buffer_load_dwordx4 v246, s[24:27], s67 offen offset:0 lds
    buffer_load_dwordx4 v247, s[24:27], s67 offen offset:1024 lds
    buffer_load_dwordx4 v248, s[24:27], s67 offen offset:2048 lds
    buffer_load_dwordx4 v249, s[24:27], s67 offen offset:3072 lds
    s_add_u32 m0, s78, 16384
    s_mul_i32 s67, s73, 28672
    s_add_u32 s67, s67, s59
    buffer_load_dwordx4 v246, s[24:27], s67 offen offset:0 lds
    buffer_load_dwordx4 v247, s[24:27], s67 offen offset:1024 lds
    buffer_load_dwordx4 v248, s[24:27], s67 offen offset:2048 lds
    buffer_load_dwordx4 v249, s[24:27], s67 offen offset:3072 lds
    ds_read_b128 v[192:195], v235 offset:256
    ds_read_b128 v[136:139], v235 offset:384
    ds_read_b128 v[196:199], v235 offset:288
    ds_read_b128 v[140:143], v235 offset:416
    ds_read_b128 v[200:203], v235 offset:320
    ds_read_b128 v[144:147], v235 offset:448
    ds_read_b128 v[204:207], v235 offset:352
    ds_read_b128 v[148:151], v235 offset:480
    s_waitcnt vmcnt(8)
    s_mov_b64 exec, 1
    s_cmp_eq_u32 s7, 0
    s_cbranch_scc1 L_fs43
    buffer_store_dword v245, off, s[36:39], s99
L_fj44:
    s_mov_b64 exec, -1
    s_add_u32 m0, s78, 32768
    s_mul_i32 s67, s74, 28672
    s_add_u32 s67, s67, s59
    buffer_load_dwordx4 v246, s[24:27], s67 offen offset:0 lds
    buffer_load_dwordx4 v247, s[24:27], s67 offen offset:1024 lds
    buffer_load_dwordx4 v248, s[24:27], s67 offen offset:2048 lds
    buffer_load_dwordx4 v249, s[24:27], s67 offen offset:3072 lds
    v_accvgpr_read_b32 v152, a224
    v_accvgpr_read_b32 v153, a225
    v_accvgpr_read_b32 v154, a226
    v_accvgpr_read_b32 v155, a227
    v_accvgpr_read_b32 v156, a228
    v_accvgpr_read_b32 v157, a229
    v_accvgpr_read_b32 v158, a230
    v_accvgpr_read_b32 v159, a231
    v_accvgpr_read_b32 v160, a232
    v_accvgpr_read_b32 v161, a233
    v_accvgpr_read_b32 v162, a234
    v_accvgpr_read_b32 v163, a235
    v_accvgpr_read_b32 v164, a236
    v_accvgpr_read_b32 v165, a237
    v_accvgpr_read_b32 v166, a238
    v_accvgpr_read_b32 v167, a239
    s_waitcnt lgkmcnt(0)
    v_pk_fma_f32 v[152:153], v[192:193], v[136:137], v[152:153]
    v_pk_fma_f32 v[168:169], v[192:193], v[136:137], v[168:169]
    v_pk_fma_f32 v[154:155], v[194:195], v[138:139], v[154:155]
    v_pk_fma_f32 v[170:171], v[194:195], v[138:139], v[170:171]
    v_pk_fma_f32 v[156:157], v[196:197], v[140:141], v[156:157]
    v_pk_fma_f32 v[172:173], v[196:197], v[140:141], v[172:173]
    v_pk_fma_f32 v[158:159], v[198:199], v[142:143], v[158:159]
    v_pk_fma_f32 v[174:175], v[198:199], v[142:143], v[174:175]
    v_pk_fma_f32 v[160:161], v[200:201], v[144:145], v[160:161]
    v_pk_fma_f32 v[176:177], v[200:201], v[144:145], v[176:177]
    v_pk_fma_f32 v[162:163], v[202:203], v[146:147], v[162:163]
    v_pk_fma_f32 v[178:179], v[202:203], v[146:147], v[178:179]
    v_pk_fma_f32 v[164:165], v[204:205], v[148:149], v[164:165]
    v_pk_fma_f32 v[180:181], v[204:205], v[148:149], v[180:181]
    v_pk_fma_f32 v[166:167], v[206:207], v[150:151], v[166:167]
    v_pk_fma_f32 v[182:183], v[206:207], v[150:151], v[182:183]
    v_accvgpr_write_b32 a224, v152
    v_accvgpr_write_b32 a240, v168
    v_accvgpr_write_b32 a225, v153
    v_accvgpr_write_b32 a241, v169
    v_accvgpr_write_b32 a226, v154
    v_accvgpr_write_b32 a242, v170
    v_accvgpr_write_b32 a227, v155
    v_accvgpr_write_b32 a243, v171
    v_accvgpr_write_b32 a228, v156
    v_accvgpr_write_b32 a244, v172
    v_accvgpr_write_b32 a229, v157
    v_accvgpr_write_b32 a245, v173
    v_accvgpr_write_b32 a230, v158
    v_accvgpr_write_b32 a246, v174
    v_accvgpr_write_b32 a231, v159
    v_accvgpr_write_b32 a247, v175
    v_accvgpr_write_b32 a232, v160
    v_accvgpr_write_b32 a248, v176
    v_accvgpr_write_b32 a233, v161
    v_accvgpr_write_b32 a249, v177
    v_accvgpr_write_b32 a234, v162
    v_accvgpr_write_b32 a250, v178
    v_accvgpr_write_b32 a235, v163
    v_accvgpr_write_b32 a251, v179
    v_accvgpr_write_b32 a236, v164
    v_accvgpr_write_b32 a252, v180
    v_accvgpr_write_b32 a237, v165
    v_accvgpr_write_b32 a253, v181
    v_accvgpr_write_b32 a238, v166
    v_accvgpr_write_b32 a254, v182
    v_accvgpr_write_b32 a239, v167
    v_accvgpr_write_b32 a255, v183
    s_add_u32 m0, s78, 49152
    s_mul_i32 s67, s75, 28672
    s_add_u32 s67, s67, s59
    buffer_load_dwordx4 v246, s[24:27], s67 offen offset:0 lds
    buffer_load_dwordx4 v247, s[24:27], s67 offen offset:1024 lds
    buffer_load_dwordx4 v248, s[24:27], s67 offen offset:2048 lds
    buffer_load_dwordx4 v249, s[24:27], s67 offen offset:3072 lds
    v_and_b32 v253, 3, v255
    v_lshlrev_b32 v253, 2, v253
    v_bfe_u32 v239, v255, 2, 1
    v_lshl_add_u32 v253, v239, 8, v253
    s_and_b32 s61, s54, 6
    s_lshl_b32 s61, s61, 8
    s_add_u32 s61, s61, s47
    s_mul_i32 s62, s3, 7
    s_lshr_b32 s62, s62, 1
    s_mul_i32 s58, s54, 14
    s_add_u32 s58, s58, s62
    s_lshl_b32 s58, s58, 7
    s_add_u32 s58, s58, 524288
    s_lshl_b32 s62, s62, 2
    s_add_u32 s61, s61, s62
    s_add_u32 s91, s61, 2048
    s_mul_i32 s61, s54, 114688
    s_add_u32 s61, s61, 7340032
    v_add_u32 v226, s61, v254
    s_xor_b32 s61, s54, 1
    s_mul_i32 s61, s61, 114688
    s_add_u32 s61, s61, 7340032
    v_add_u32 v227, s61, v254
    s_mul_i32 s61, s3, 12288
    v_add_u32 v231, s61, v254
    v_lshlrev_b32 v241, 2, v243
    s_xor_b32 s61, s3, 1
    s_mul_i32 s61, s61, 12288
    s_add_u32 s61, s61, 0
    v_add_u32 v228, s61, v254
    s_xor_b32 s61, s3, 2
    s_mul_i32 s61, s61, 12288
    s_add_u32 s61, s61, 4096
    v_add_u32 v229, s61, v254
    s_xor_b32 s61, s3, 3
    s_mul_i32 s61, s61, 12288
    s_add_u32 s61, s61, 8192
    v_add_u32 v230, s61, v254
    s_add_u32 m0, s78, 81920
    s_mul_i32 s67, s76, 28672
    s_add_u32 s67, s67, s59
    buffer_load_dwordx4 v246, s[24:27], s67 offen offset:0 lds
    buffer_load_dwordx4 v247, s[24:27], s67 offen offset:1024 lds
    buffer_load_dwordx4 v248, s[24:27], s67 offen offset:2048 lds
    buffer_load_dwordx4 v249, s[24:27], s67 offen offset:3072 lds
    ds_read_b64_tr_b16 a[0:1], v222 offset:0
    ds_read_b64_tr_b16 a[2:3], v222 offset:1024
    ds_read_b64_tr_b16 a[4:5], v223 offset:0
    ds_read_b64_tr_b16 a[6:7], v223 offset:1024
    ds_read_b64_tr_b16 a[8:9], v222 offset:2048
    ds_read_b64_tr_b16 a[10:11], v222 offset:3072
    ds_read_b64_tr_b16 a[12:13], v223 offset:2048
    ds_read_b64_tr_b16 a[14:15], v223 offset:3072
    s_add_u32 m0, s78, 98304
    s_xor_b32 s67, s70, 2
    s_mul_i32 s67, s67, 28672
    s_add_u32 s67, s67, s59
    buffer_load_dwordx4 v246, s[24:27], s67 offen offset:0 lds
    buffer_load_dwordx4 v247, s[24:27], s67 offen offset:1024 lds
    buffer_load_dwordx4 v248, s[24:27], s67 offen offset:2048 lds
    buffer_load_dwordx4 v249, s[24:27], s67 offen offset:3072 lds
    ds_read_b64_tr_b16 a[16:17], v224 offset:0
    ds_read_b64_tr_b16 a[18:19], v224 offset:1024
    ds_read_b64_tr_b16 a[20:21], v225 offset:0
    ds_read_b64_tr_b16 a[22:23], v225 offset:1024
    ds_read_b64_tr_b16 a[24:25], v224 offset:2048
    ds_read_b64_tr_b16 a[26:27], v224 offset:3072
    ds_read_b64_tr_b16 a[28:29], v225 offset:2048
    ds_read_b64_tr_b16 a[30:31], v225 offset:3072
    s_add_u32 m0, s78, 114688
    s_xor_b32 s67, s71, 2
    s_mul_i32 s67, s67, 28672
    s_add_u32 s67, s67, s59
    buffer_load_dwordx4 v246, s[24:27], s67 offen offset:0 lds
    buffer_load_dwordx4 v247, s[24:27], s67 offen offset:1024 lds
    buffer_load_dwordx4 v248, s[24:27], s67 offen offset:2048 lds
    buffer_load_dwordx4 v249, s[24:27], s67 offen offset:3072 lds
    s_waitcnt vmcnt(25)
    ds_read_b64_tr_b16 a[32:33], v220 offset:0
    ds_read_b64_tr_b16 a[34:35], v220 offset:1024
    ds_read_b64_tr_b16 a[36:37], v221 offset:0
    ds_read_b64_tr_b16 a[38:39], v221 offset:1024
    ds_read_b64_tr_b16 a[40:41], v220 offset:2048
    ds_read_b64_tr_b16 a[42:43], v220 offset:3072
    ds_read_b64_tr_b16 a[44:45], v221 offset:2048
    ds_read_b64_tr_b16 a[46:47], v221 offset:3072
    s_waitcnt lgkmcnt(15)
    s_add_u32 m0, s78, 65536
    s_xor_b32 s67, s72, 2
    s_mul_i32 s67, s67, 28672
    s_add_u32 s67, s67, s59
    buffer_load_dwordx4 v246, s[24:27], s67 offen offset:0 lds
    buffer_load_dwordx4 v247, s[24:27], s67 offen offset:1024 lds
    buffer_load_dwordx4 v248, s[24:27], s67 offen offset:2048 lds
    buffer_load_dwordx4 v249, s[24:27], s67 offen offset:3072 lds
    s_waitcnt vmcnt(25)
    ds_read_b64_tr_b16 a[48:49], v220 offset:16384
    ds_read_b64_tr_b16 a[50:51], v220 offset:17408
    ds_read_b64_tr_b16 a[52:53], v221 offset:16384
    ds_read_b64_tr_b16 a[54:55], v221 offset:17408
    ds_read_b64_tr_b16 a[56:57], v220 offset:18432
    ds_read_b64_tr_b16 a[58:59], v220 offset:19456
    ds_read_b64_tr_b16 a[60:61], v221 offset:18432
    ds_read_b64_tr_b16 a[62:63], v221 offset:19456
    s_waitcnt lgkmcnt(15)
    s_add_u32 m0, s78, 131072
    s_xor_b32 s67, s73, 2
    s_mul_i32 s67, s67, 28672
    s_add_u32 s67, s67, s59
    buffer_load_dwordx4 v246, s[24:27], s67 offen offset:0 lds
    buffer_load_dwordx4 v247, s[24:27], s67 offen offset:1024 lds
    buffer_load_dwordx4 v248, s[24:27], s67 offen offset:2048 lds
    buffer_load_dwordx4 v249, s[24:27], s67 offen offset:3072 lds
    s_waitcnt vmcnt(24)
    ds_read_b64_tr_b16 a[64:65], v220 offset:32768
    ds_read_b64_tr_b16 a[66:67], v220 offset:33792
    ds_read_b64_tr_b16 a[68:69], v221 offset:32768
    ds_read_b64_tr_b16 a[70:71], v221 offset:33792
    ds_read_b64_tr_b16 a[72:73], v220 offset:34816
    ds_read_b64_tr_b16 a[74:75], v220 offset:35840
    ds_read_b64_tr_b16 a[76:77], v221 offset:34816
    ds_read_b64_tr_b16 a[78:79], v221 offset:35840
    s_waitcnt lgkmcnt(15)
    s_add_u32 m0, s78, 0
    s_xor_b32 s67, s74, 2
    s_mul_i32 s67, s67, 28672
    s_add_u32 s67, s67, s59
    buffer_load_dwordx4 v246, s[24:27], s67 offen offset:0 lds
    buffer_load_dwordx4 v247, s[24:27], s67 offen offset:1024 lds
    buffer_load_dwordx4 v248, s[24:27], s67 offen offset:2048 lds
    buffer_load_dwordx4 v249, s[24:27], s67 offen offset:3072 lds
    s_waitcnt vmcnt(24)
    ds_read_b64_tr_b16 a[80:81], v220 offset:49152
    ds_read_b64_tr_b16 a[82:83], v220 offset:50176
    ds_read_b64_tr_b16 a[84:85], v221 offset:49152
    ds_read_b64_tr_b16 a[86:87], v221 offset:50176
    ds_read_b64_tr_b16 a[88:89], v220 offset:51200
    ds_read_b64_tr_b16 a[90:91], v220 offset:52224
    ds_read_b64_tr_b16 a[92:93], v221 offset:51200
    ds_read_b64_tr_b16 a[94:95], v221 offset:52224
    s_waitcnt lgkmcnt(15)
    s_add_u32 m0, s78, 16384
    s_xor_b32 s67, s75, 2
    s_mul_i32 s67, s67, 28672
    s_add_u32 s67, s67, s59
    buffer_load_dwordx4 v246, s[24:27], s67 offen offset:0 lds
    buffer_load_dwordx4 v247, s[24:27], s67 offen offset:1024 lds
    buffer_load_dwordx4 v248, s[24:27], s67 offen offset:2048 lds
    buffer_load_dwordx4 v249, s[24:27], s67 offen offset:3072 lds
    s_waitcnt vmcnt(24)
    ds_read_b64_tr_b16 a[96:97], v222 offset:16384
    ds_read_b64_tr_b16 a[98:99], v222 offset:17408
    ds_read_b64_tr_b16 a[100:101], v223 offset:16384
    ds_read_b64_tr_b16 a[102:103], v223 offset:17408
    ds_read_b64_tr_b16 a[104:105], v222 offset:18432
    ds_read_b64_tr_b16 a[106:107], v222 offset:19456
    ds_read_b64_tr_b16 a[108:109], v223 offset:18432
    ds_read_b64_tr_b16 a[110:111], v223 offset:19456
    s_waitcnt lgkmcnt(15)
    s_add_u32 m0, s78, 32768
    s_xor_b32 s67, s76, 2
    s_mul_i32 s67, s67, 28672
    s_add_u32 s67, s67, s59
    buffer_load_dwordx4 v246, s[24:27], s67 offen offset:0 lds
    buffer_load_dwordx4 v247, s[24:27], s67 offen offset:1024 lds
    buffer_load_dwordx4 v248, s[24:27], s67 offen offset:2048 lds
    buffer_load_dwordx4 v249, s[24:27], s67 offen offset:3072 lds
    s_waitcnt vmcnt(24)
    ds_read_b64_tr_b16 a[112:113], v222 offset:32768
    ds_read_b64_tr_b16 a[114:115], v222 offset:33792
    ds_read_b64_tr_b16 a[116:117], v223 offset:32768
    ds_read_b64_tr_b16 a[118:119], v223 offset:33792
    ds_read_b64_tr_b16 a[120:121], v222 offset:34816
    ds_read_b64_tr_b16 a[122:123], v222 offset:35840
    ds_read_b64_tr_b16 a[124:125], v223 offset:34816
    ds_read_b64_tr_b16 a[126:127], v223 offset:35840
    s_waitcnt vmcnt(20)
    ds_read_b64_tr_b16 a[128:129], v222 offset:49152
    ds_read_b64_tr_b16 a[130:131], v222 offset:50176
    ds_read_b64_tr_b16 a[132:133], v223 offset:49152
    ds_read_b64_tr_b16 a[134:135], v223 offset:50176
    ds_read_b64_tr_b16 a[136:137], v222 offset:51200
    ds_read_b64_tr_b16 a[138:139], v222 offset:52224
    ds_read_b64_tr_b16 a[140:141], v223 offset:51200
    ds_read_b64_tr_b16 a[142:143], v223 offset:52224
    s_waitcnt vmcnt(16)
    ds_read_b64_tr_b16 a[144:145], v222 offset:0
    ds_read_b64_tr_b16 a[146:147], v222 offset:1024
    ds_read_b64_tr_b16 a[148:149], v223 offset:0
    ds_read_b64_tr_b16 a[150:151], v223 offset:1024
    ds_read_b64_tr_b16 a[152:153], v222 offset:2048
    ds_read_b64_tr_b16 a[154:155], v222 offset:3072
    ds_read_b64_tr_b16 a[156:157], v223 offset:2048
    ds_read_b64_tr_b16 a[158:159], v223 offset:3072
    s_waitcnt vmcnt(12)
    ds_read_b64_tr_b16 a[160:161], v224 offset:0
    ds_read_b64_tr_b16 a[162:163], v224 offset:1024
    ds_read_b64_tr_b16 a[164:165], v225 offset:0
    ds_read_b64_tr_b16 a[166:167], v225 offset:1024
    ds_read_b64_tr_b16 a[168:169], v224 offset:2048
    ds_read_b64_tr_b16 a[170:171], v224 offset:3072
    ds_read_b64_tr_b16 a[172:173], v225 offset:2048
    ds_read_b64_tr_b16 a[174:175], v225 offset:3072
    s_waitcnt vmcnt(8)
    ds_read_b64_tr_b16 a[176:177], v220 offset:0
    ds_read_b64_tr_b16 a[178:179], v220 offset:1024
    ds_read_b64_tr_b16 a[180:181], v221 offset:0
    ds_read_b64_tr_b16 a[182:183], v221 offset:1024
    ds_read_b64_tr_b16 a[184:185], v220 offset:2048
    ds_read_b64_tr_b16 a[186:187], v220 offset:3072
    ds_read_b64_tr_b16 a[188:189], v221 offset:2048
    ds_read_b64_tr_b16 a[190:191], v221 offset:3072
    s_waitcnt vmcnt(4)
    ds_read_b64_tr_b16 a[192:193], v220 offset:16384
    ds_read_b64_tr_b16 a[194:195], v220 offset:17408
    ds_read_b64_tr_b16 a[196:197], v221 offset:16384
    ds_read_b64_tr_b16 a[198:199], v221 offset:17408
    ds_read_b64_tr_b16 a[200:201], v220 offset:18432
    ds_read_b64_tr_b16 a[202:203], v220 offset:19456
    ds_read_b64_tr_b16 a[204:205], v221 offset:18432
    ds_read_b64_tr_b16 a[206:207], v221 offset:19456
    s_waitcnt vmcnt(0)
    ds_read_b64_tr_b16 a[208:209], v220 offset:32768
    ds_read_b64_tr_b16 a[210:211], v220 offset:33792
    ds_read_b64_tr_b16 a[212:213], v221 offset:32768
    ds_read_b64_tr_b16 a[214:215], v221 offset:33792
    ds_read_b64_tr_b16 a[216:217], v220 offset:34816
    ds_read_b64_tr_b16 a[218:219], v220 offset:35840
    ds_read_b64_tr_b16 a[220:221], v221 offset:34816
    ds_read_b64_tr_b16 a[222:223], v221 offset:35840
L_sb16:
    s_cbranch_execz L_wzc
    s_lshl_b32 s70, s70, 11
    s_lshl_b32 s71, s71, 11
    s_lshl_b32 s72, s72, 11
    s_lshl_b32 s73, s73, 11
    s_lshl_b32 s74, s74, 11
    s_lshl_b32 s75, s75, 11
    s_lshl_b32 s76, s76, 11
    s_waitcnt lgkmcnt(0)
    s_barrier
    s_mov_b32 s60, 0
L_p45:
    buffer_load_dword v238, v253, s[36:39], s91 offen sc1
    s_add_u32 s60, s60, 1
    s_cmp_ge_u32 s60, 60000
    s_cbranch_scc1 L_pd46
    s_cmp_eq_u32 s7, 0
    s_waitcnt vmcnt(0)
    v_cmp_ne_u32 vcc, s6, v238
    s_cbranch_vccnz L_p45
L_pd46:
    s_cbranch_scc1 L_pi47
L_pj48:
    buffer_load_dwordx4 v[128:131], v226, s[36:39], s70 offen offset:0 sc1
    buffer_load_dwordx4 v[132:135], v227, s[36:39], s70 offen offset:0 sc1
    buffer_load_dwordx4 v[136:139], v226, s[36:39], s70 offen offset:1024 sc1
    buffer_load_dwordx4 v[140:143], v227, s[36:39], s70 offen offset:1024 sc1
    buffer_load_dwordx4 v[144:147], v226, s[36:39], s71 offen offset:0 sc1
    buffer_load_dwordx4 v[148:151], v227, s[36:39], s71 offen offset:0 sc1
    buffer_load_dwordx4 v[152:155], v226, s[36:39], s71 offen offset:1024 sc1
    buffer_load_dwordx4 v[156:159], v227, s[36:39], s71 offen offset:1024 sc1
    buffer_load_dwordx4 v[160:163], v226, s[36:39], s72 offen offset:0 sc1
    buffer_load_dwordx4 v[164:167], v227, s[36:39], s72 offen offset:0 sc1
    buffer_load_dword v239, v241, s[36:39], s58 offen sc1
    s_waitcnt vmcnt(10)
    v_mfma_f32_32x32x16_bf16 v[0:15], a[0:3], v[128:131], 0
    buffer_load_dwordx4 v[168:171], v226, s[36:39], s72 offen offset:1024 sc1
    v_mfma_f32_32x32x16_bf16 v[32:47], a[4:7], v[128:131], 0
    s_waitcnt vmcnt(10)
    v_mfma_f32_32x32x16_bf16 v[16:31], a[0:3], v[132:135], 0
    buffer_load_dwordx4 v[172:175], v227, s[36:39], s72 offen offset:1024 sc1
    v_mfma_f32_32x32x16_bf16 v[48:63], a[4:7], v[132:135], 0
    s_waitcnt vmcnt(10)
    v_mfma_f32_32x32x16_bf16 v[0:15], a[8:11], v[136:139], v[0:15]
    buffer_load_dwordx4 v[176:179], v226, s[36:39], s73 offen offset:0 sc1
    v_mfma_f32_32x32x16_bf16 v[32:47], a[12:15], v[136:139], v[32:47]
    s_waitcnt vmcnt(10)
    v_mfma_f32_32x32x16_bf16 v[16:31], a[8:11], v[140:143], v[16:31]
    buffer_load_dwordx4 v[180:183], v227, s[36:39], s73 offen offset:0 sc1
    v_mfma_f32_32x32x16_bf16 v[48:63], a[12:15], v[140:143], v[48:63]
    s_waitcnt vmcnt(10)
    v_mfma_f32_32x32x16_bf16 v[0:15], a[16:19], v[144:147], v[0:15]
    buffer_load_dwordx4 v[184:187], v226, s[36:39], s73 offen offset:1024 sc1
    v_mfma_f32_32x32x16_bf16 v[32:47], a[20:23], v[144:147], v[32:47]
    s_waitcnt vmcnt(10)
    v_mfma_f32_32x32x16_bf16 v[16:31], a[16:19], v[148:151], v[16:31]
    buffer_load_dwordx4 v[188:191], v227, s[36:39], s73 offen offset:1024 sc1
    v_mfma_f32_32x32x16_bf16 v[48:63], a[20:23], v[148:151], v[48:63]
    s_waitcnt vmcnt(10)
    v_mfma_f32_32x32x16_bf16 v[0:15], a[24:27], v[152:155], v[0:15]
    buffer_load_dwordx4 v[128:131], v226, s[36:39], s74 offen offset:0 sc1
    v_mfma_f32_32x32x16_bf16 v[32:47], a[28:31], v[152:155], v[32:47]
    s_waitcnt vmcnt(10)
    v_mfma_f32_32x32x16_bf16 v[16:31], a[24:27], v[156:159], v[16:31]
    buffer_load_dwordx4 v[132:135], v227, s[36:39], s74 offen offset:0 sc1
    v_mfma_f32_32x32x16_bf16 v[48:63], a[28:31], v[156:159], v[48:63]
    s_waitcnt vmcnt(10)
    v_mfma_f32_32x32x16_bf16 v[0:15], a[32:35], v[160:163], v[0:15]
    buffer_load_dwordx4 v[136:139], v226, s[36:39], s74 offen offset:1024 sc1
    v_mfma_f32_32x32x16_bf16 v[32:47], a[36:39], v[160:163], v[32:47]
    s_waitcnt vmcnt(10)
    v_mfma_f32_32x32x16_bf16 v[16:31], a[32:35], v[164:167], v[16:31]
    buffer_load_dwordx4 v[140:143], v227, s[36:39], s74 offen offset:1024 sc1
    v_mfma_f32_32x32x16_bf16 v[48:63], a[36:39], v[164:167], v[48:63]
    s_waitcnt vmcnt(9)
    v_mfma_f32_32x32x16_bf16 v[0:15], a[40:43], v[168:171], v[0:15]
    buffer_load_dwordx4 v[144:147], v226, s[36:39], s75 offen offset:0 sc1
    v_mfma_f32_32x32x16_bf16 v[32:47], a[44:47], v[168:171], v[32:47]
    s_waitcnt vmcnt(9)
    v_mfma_f32_32x32x16_bf16 v[16:31], a[40:43], v[172:175], v[16:31]
    buffer_load_dwordx4 v[148:151], v227, s[36:39], s75 offen offset:0 sc1
    v_mfma_f32_32x32x16_bf16 v[48:63], a[44:47], v[172:175], v[48:63]
    s_waitcnt vmcnt(9)
    v_mfma_f32_32x32x16_bf16 v[0:15], a[48:51], v[176:179], v[0:15]
    buffer_load_dwordx4 v[152:155], v226, s[36:39], s75 offen offset:1024 sc1
    v_mfma_f32_32x32x16_bf16 v[32:47], a[52:55], v[176:179], v[32:47]
    s_waitcnt vmcnt(9)
    v_mfma_f32_32x32x16_bf16 v[16:31], a[48:51], v[180:183], v[16:31]
    buffer_load_dwordx4 v[156:159], v227, s[36:39], s75 offen offset:1024 sc1
    v_mfma_f32_32x32x16_bf16 v[48:63], a[52:55], v[180:183], v[48:63]
    s_waitcnt vmcnt(9)
    v_mfma_f32_32x32x16_bf16 v[0:15], a[56:59], v[184:187], v[0:15]
    buffer_load_dwordx4 v[160:163], v226, s[36:39], s76 offen offset:0 sc1
    v_mfma_f32_32x32x16_bf16 v[32:47], a[60:63], v[184:187], v[32:47]
    s_waitcnt vmcnt(9)
    v_mfma_f32_32x32x16_bf16 v[16:31], a[56:59], v[188:191], v[16:31]
    buffer_load_dwordx4 v[164:167], v227, s[36:39], s76 offen offset:0 sc1
    v_mfma_f32_32x32x16_bf16 v[48:63], a[60:63], v[188:191], v[48:63]
    buffer_load_dword v238, v253, s[36:39], s91 offen offset:64 sc1
    s_waitcnt vmcnt(10)
    v_mfma_f32_32x32x16_bf16 v[0:15], a[64:67], v[128:131], v[0:15]
    buffer_load_dwordx4 v[168:171], v226, s[36:39], s76 offen offset:1024 sc1
    v_mfma_f32_32x32x16_bf16 v[32:47], a[68:71], v[128:131], v[32:47]
    s_waitcnt vmcnt(10)
    v_mfma_f32_32x32x16_bf16 v[16:31], a[64:67], v[132:135], v[16:31]
    buffer_load_dwordx4 v[172:175], v227, s[36:39], s76 offen offset:1024 sc1
    v_mfma_f32_32x32x16_bf16 v[48:63], a[68:71], v[132:135], v[48:63]
    s_waitcnt vmcnt(10)
    v_mfma_f32_32x32x16_bf16 v[0:15], a[72:75], v[136:139], v[0:15]
    v_mfma_f32_32x32x16_bf16 v[32:47], a[76:79], v[136:139], v[32:47]
    s_waitcnt vmcnt(9)
    v_mfma_f32_32x32x16_bf16 v[16:31], a[72:75], v[140:143], v[16:31]
    v_mfma_f32_32x32x16_bf16 v[48:63], a[76:79], v[140:143], v[48:63]
    s_waitcnt vmcnt(8)
    v_mfma_f32_32x32x16_bf16 v[0:15], a[80:83], v[144:147], v[0:15]
    v_mfma_f32_32x32x16_bf16 v[32:47], a[84:87], v[144:147], v[32:47]
    s_waitcnt vmcnt(7)
    v_mfma_f32_32x32x16_bf16 v[16:31], a[80:83], v[148:151], v[16:31]
    v_mfma_f32_32x32x16_bf16 v[48:63], a[84:87], v[148:151], v[48:63]
    s_waitcnt vmcnt(2)
    v_cmp_ne_u32 vcc, s6, v238
    s_cmp_eq_u32 s7, 0
    s_cbranch_scc1 L_lr49
    s_cbranch_vccnz L_lr49
L_lj50:
    s_xor_b32 s70, s70, 4096
    buffer_load_dwordx4 v[176:179], v226, s[36:39], s70 offen offset:0 sc1
    buffer_load_dwordx4 v[180:183], v227, s[36:39], s70 offen offset:0 sc1
    buffer_load_dwordx4 v[184:187], v226, s[36:39], s70 offen offset:1024 sc1
    buffer_load_dwordx4 v[188:191], v227, s[36:39], s70 offen offset:1024 sc1
    v_mfma_f32_32x32x16_bf16 v[0:15], a[88:91], v[152:155], v[0:15]
    s_xor_b32 s71, s71, 4096
    buffer_load_dwordx4 v[128:131], v226, s[36:39], s71 offen offset:0 sc1
    v_mfma_f32_32x32x16_bf16 v[32:47], a[92:95], v[152:155], v[32:47]
    v_mfma_f32_32x32x16_bf16 v[16:31], a[88:91], v[156:159], v[16:31]
    buffer_load_dwordx4 v[132:135], v227, s[36:39], s71 offen offset:0 sc1
    v_mfma_f32_32x32x16_bf16 v[48:63], a[92:95], v[156:159], v[48:63]
    v_mfma_f32_32x32x16_bf16 v[0:15], a[96:99], v[160:163], v[0:15]
    buffer_load_dwordx4 v[136:139], v226, s[36:39], s71 offen offset:1024 sc1
    v_mfma_f32_32x32x16_bf16 v[32:47], a[100:103], v[160:163], v[32:47]
    v_mfma_f32_32x32x16_bf16 v[16:31], a[96:99], v[164:167], v[16:31]
    buffer_load_dwordx4 v[140:143], v227, s[36:39], s71 offen offset:1024 sc1
    v_mfma_f32_32x32x16_bf16 v[48:63], a[100:103], v[164:167], v[48:63]
    s_waitcnt vmcnt(9)
    v_mfma_f32_32x32x16_bf16 v[0:15], a[104:107], v[168:171], v[0:15]
    s_xor_b32 s72, s72, 4096
    buffer_load_dwordx4 v[144:147], v226, s[36:39], s72 offen offset:0 sc1
    v_mfma_f32_32x32x16_bf16 v[32:47], a[108:111], v[168:171], v[32:47]
    s_waitcnt vmcnt(9)
    v_mfma_f32_32x32x16_bf16 v[16:31], a[104:107], v[172:175], v[16:31]
    buffer_load_dwordx4 v[148:151], v227, s[36:39], s72 offen offset:0 sc1
    v_mfma_f32_32x32x16_bf16 v[48:63], a[108:111], v[172:175], v[48:63]
    s_waitcnt vmcnt(9)
    v_mfma_f32_32x32x16_bf16 v[0:15], a[112:115], v[176:179], v[0:15]
    buffer_load_dwordx4 v[152:155], v226, s[36:39], s72 offen offset:1024 sc1
    v_mfma_f32_32x32x16_bf16 v[32:47], a[116:119], v[176:179], v[32:47]
    s_waitcnt vmcnt(9)
    v_mfma_f32_32x32x16_bf16 v[16:31], a[112:115], v[180:183], v[16:31]
    buffer_load_dwordx4 v[156:159], v227, s[36:39], s72 offen offset:1024 sc1
    v_mfma_f32_32x32x16_bf16 v[48:63], a[116:119], v[180:183], v[48:63]
    s_waitcnt vmcnt(9)
    v_mfma_f32_32x32x16_bf16 v[0:15], a[120:123], v[184:187], v[0:15]
    s_xor_b32 s73, s73, 4096
    buffer_load_dwordx4 v[160:163], v226, s[36:39], s73 offen offset:0 sc1
    v_mfma_f32_32x32x16_bf16 v[32:47], a[124:127], v[184:187], v[32:47]
    s_waitcnt vmcnt(9)
    v_mfma_f32_32x32x16_bf16 v[16:31], a[120:123], v[188:191], v[16:31]
    buffer_load_dwordx4 v[164:167], v227, s[36:39], s73 offen offset:0 sc1
    v_mfma_f32_32x32x16_bf16 v[48:63], a[124:127], v[188:191], v[48:63]
    s_waitcnt vmcnt(9)
    v_mfma_f32_32x32x16_bf16 v[0:15], a[128:131], v[128:131], v[0:15]
    buffer_load_dwordx4 v[168:171], v226, s[36:39], s73 offen offset:1024 sc1
    v_mfma_f32_32x32x16_bf16 v[32:47], a[132:135], v[128:131], v[32:47]
    s_waitcnt vmcnt(9)
    v_mfma_f32_32x32x16_bf16 v[16:31], a[128:131], v[132:135], v[16:31]
    buffer_load_dwordx4 v[172:175], v227, s[36:39], s73 offen offset:1024 sc1
    v_mfma_f32_32x32x16_bf16 v[48:63], a[132:135], v[132:135], v[48:63]
    s_waitcnt vmcnt(9)
    v_mfma_f32_32x32x16_bf16 v[0:15], a[136:139], v[136:139], v[0:15]
    s_xor_b32 s74, s74, 4096
    buffer_load_dwordx4 v[176:179], v226, s[36:39], s74 offen offset:0 sc1
    v_mfma_f32_32x32x16_bf16 v[32:47], a[140:143], v[136:139], v[32:47]
    s_waitcnt vmcnt(9)
    v_mfma_f32_32x32x16_bf16 v[16:31], a[136:139], v[140:143], v[16:31]
    buffer_load_dwordx4 v[180:183], v227, s[36:39], s74 offen offset:0 sc1
    v_mfma_f32_32x32x16_bf16 v[48:63], a[140:143], v[140:143], v[48:63]
    s_waitcnt vmcnt(9)
    v_mfma_f32_32x32x16_bf16 v[0:15], a[144:147], v[144:147], v[0:15]
    buffer_load_dwordx4 v[184:187], v226, s[36:39], s74 offen offset:1024 sc1
    v_mfma_f32_32x32x16_bf16 v[32:47], a[148:151], v[144:147], v[32:47]
    s_waitcnt vmcnt(9)
    v_mfma_f32_32x32x16_bf16 v[16:31], a[144:147], v[148:151], v[16:31]
    buffer_load_dwordx4 v[188:191], v227, s[36:39], s74 offen offset:1024 sc1
    v_mfma_f32_32x32x16_bf16 v[48:63], a[148:151], v[148:151], v[48:63]
    s_waitcnt vmcnt(9)
    v_mfma_f32_32x32x16_bf16 v[0:15], a[152:155], v[152:155], v[0:15]
    s_xor_b32 s75, s75, 4096
    buffer_load_dwordx4 v[128:131], v226, s[36:39], s75 offen offset:0 sc1
    v_mfma_f32_32x32x16_bf16 v[32:47], a[156:159], v[152:155], v[32:47]
    s_waitcnt vmcnt(9)
    v_mfma_f32_32x32x16_bf16 v[16:31], a[152:155], v[156:159], v[16:31]
    buffer_load_dwordx4 v[132:135], v227, s[36:39], s75 offen offset:0 sc1
    v_mfma_f32_32x32x16_bf16 v[48:63], a[156:159], v[156:159], v[48:63]
    s_waitcnt vmcnt(9)
    v_mfma_f32_32x32x16_bf16 v[0:15], a[160:163], v[160:163], v[0:15]
    buffer_load_dwordx4 v[136:139], v226, s[36:39], s75 offen offset:1024 sc1
    v_mfma_f32_32x32x16_bf16 v[32:47], a[164:167], v[160:163], v[32:47]
    s_waitcnt vmcnt(9)
    v_mfma_f32_32x32x16_bf16 v[16:31], a[160:163], v[164:167], v[16:31]
    buffer_load_dwordx4 v[140:143], v227, s[36:39], s75 offen offset:1024 sc1
    v_mfma_f32_32x32x16_bf16 v[48:63], a[164:167], v[164:167], v[48:63]
    s_waitcnt vmcnt(9)
    v_mfma_f32_32x32x16_bf16 v[0:15], a[168:171], v[168:171], v[0:15]
    s_xor_b32 s76, s76, 4096
    buffer_load_dwordx4 v[144:147], v226, s[36:39], s76 offen offset:0 sc1
    v_mfma_f32_32x32x16_bf16 v[32:47], a[172:175], v[168:171], v[32:47]
    s_waitcnt vmcnt(9)
    v_mfma_f32_32x32x16_bf16 v[16:31], a[168:171], v[172:175], v[16:31]
    buffer_load_dwordx4 v[148:151], v227, s[36:39], s76 offen offset:0 sc1
    v_mfma_f32_32x32x16_bf16 v[48:63], a[172:175], v[172:175], v[48:63]
    buffer_load_dword v238, v253, s[36:39], s91 offen offset:1024 sc1
    s_waitcnt vmcnt(10)
    v_mfma_f32_32x32x16_bf16 v[0:15], a[176:179], v[176:179], v[0:15]
    buffer_load_dwordx4 v[152:155], v226, s[36:39], s76 offen offset:1024 sc1
    v_mfma_f32_32x32x16_bf16 v[32:47], a[180:183], v[176:179], v[32:47]
    s_waitcnt vmcnt(10)
    v_mfma_f32_32x32x16_bf16 v[16:31], a[176:179], v[180:183], v[16:31]
    buffer_load_dwordx4 v[156:159], v227, s[36:39], s76 offen offset:1024 sc1
    v_mfma_f32_32x32x16_bf16 v[48:63], a[180:183], v[180:183], v[48:63]
    s_waitcnt vmcnt(10)
    v_mfma_f32_32x32x16_bf16 v[0:15], a[184:187], v[184:187], v[0:15]
    v_mfma_f32_32x32x16_bf16 v[32:47], a[188:191], v[184:187], v[32:47]
    s_waitcnt vmcnt(9)
    v_mfma_f32_32x32x16_bf16 v[16:31], a[184:187], v[188:191], v[16:31]
    v_mfma_f32_32x32x16_bf16 v[48:63], a[188:191], v[188:191], v[48:63]
    s_waitcnt vmcnt(8)
    v_mfma_f32_32x32x16_bf16 v[0:15], a[192:195], v[128:131], v[0:15]
    v_mfma_f32_32x32x16_bf16 v[32:47], a[196:199], v[128:131], v[32:47]
    s_waitcnt vmcnt(7)
    v_mfma_f32_32x32x16_bf16 v[16:31], a[192:195], v[132:135], v[16:31]
    v_mfma_f32_32x32x16_bf16 v[48:63], a[196:199], v[132:135], v[48:63]
    s_waitcnt vmcnt(2)
    v_cmp_ne_u32 vcc, s6, v238
    s_cmp_eq_u32 s7, 0
    s_cbranch_scc1 L_lr51
    s_cbranch_vccnz L_lr51
L_lj52:
    v_add_u32 v226, 458752, v226
    v_add_u32 v227, 458752, v227
    s_xor_b32 s70, s70, 4096
    buffer_load_dwordx4 v[160:163], v226, s[36:39], s70 offen offset:0 sc1
    buffer_load_dwordx4 v[164:167], v227, s[36:39], s70 offen offset:0 sc1
    buffer_load_dwordx4 v[168:171], v226, s[36:39], s70 offen offset:1024 sc1
    buffer_load_dwordx4 v[172:175], v227, s[36:39], s70 offen offset:1024 sc1
    s_add_u32 s58, s58, 7168
    buffer_load_dword v240, v241, s[36:39], s58 offen sc1
    v_mfma_f32_32x32x16_bf16 v[0:15], a[200:203], v[136:139], v[0:15]
    s_xor_b32 s71, s71, 4096
    buffer_load_dwordx4 v[176:179], v226, s[36:39], s71 offen offset:0 sc1
    v_mfma_f32_32x32x16_bf16 v[32:47], a[204:207], v[136:139], v[32:47]
    v_mfma_f32_32x32x16_bf16 v[16:31], a[200:203], v[140:143], v[16:31]
    buffer_load_dwordx4 v[180:183], v227, s[36:39], s71 offen offset:0 sc1
    v_mfma_f32_32x32x16_bf16 v[48:63], a[204:207], v[140:143], v[48:63]
    v_mfma_f32_32x32x16_bf16 v[0:15], a[208:211], v[144:147], v[0:15]
    buffer_load_dwordx4 v[184:187], v226, s[36:39], s71 offen offset:1024 sc1
    v_mfma_f32_32x32x16_bf16 v[32:47], a[212:215], v[144:147], v[32:47]
    v_mfma_f32_32x32x16_bf16 v[16:31], a[208:211], v[148:151], v[16:31]
    buffer_load_dwordx4 v[188:191], v227, s[36:39], s71 offen offset:1024 sc1
    v_mfma_f32_32x32x16_bf16 v[48:63], a[212:215], v[148:151], v[48:63]
    s_waitcnt vmcnt(10)
    v_mfma_f32_32x32x16_bf16 v[0:15], a[216:219], v[152:155], v[0:15]
    s_xor_b32 s72, s72, 4096
    buffer_load_dwordx4 v[128:131], v226, s[36:39], s72 offen offset:0 sc1
    v_mfma_f32_32x32x16_bf16 v[32:47], a[220:223], v[152:155], v[32:47]
    s_waitcnt vmcnt(10)
    v_mfma_f32_32x32x16_bf16 v[16:31], a[216:219], v[156:159], v[16:31]
    buffer_load_dwordx4 v[132:135], v227, s[36:39], s72 offen offset:0 sc1
    v_mfma_f32_32x32x16_bf16 v[48:63], a[220:223], v[156:159], v[48:63]
    s_waitcnt vmcnt(10)
    v_mfma_f32_32x32x16_bf16 v[64:79], a[0:3], v[160:163], 0
    buffer_load_dwordx4 v[136:139], v226, s[36:39], s72 offen offset:1024 sc1
    v_mfma_f32_32x32x16_bf16 v[96:111], a[4:7], v[160:163], 0
    s_waitcnt vmcnt(10)
    v_mfma_f32_32x32x16_bf16 v[80:95], a[0:3], v[164:167], 0
    buffer_load_dwordx4 v[140:143], v227, s[36:39], s72 offen offset:1024 sc1
    v_mfma_f32_32x32x16_bf16 v[112:127], a[4:7], v[164:167], 0
    s_waitcnt vmcnt(10)
    v_mfma_f32_32x32x16_bf16 v[64:79], a[8:11], v[168:171], v[64:79]
    s_xor_b32 s73, s73, 4096
    buffer_load_dwordx4 v[144:147], v226, s[36:39], s73 offen offset:0 sc1
    v_mfma_f32_32x32x16_bf16 v[96:111], a[12:15], v[168:171], v[96:111]
    ds_write_b128 v228, v[16:19] offset:0
    s_waitcnt vmcnt(10)
    v_mfma_f32_32x32x16_bf16 v[80:95], a[8:11], v[172:175], v[80:95]
    buffer_load_dwordx4 v[148:151], v227, s[36:39], s73 offen offset:0 sc1
    v_mfma_f32_32x32x16_bf16 v[112:127], a[12:15], v[172:175], v[112:127]
    ds_write_b128 v228, v[20:23] offset:1024
    s_waitcnt vmcnt(9)
    v_mfma_f32_32x32x16_bf16 v[64:79], a[16:19], v[176:179], v[64:79]
    buffer_load_dwordx4 v[152:155], v226, s[36:39], s73 offen offset:1024 sc1
    v_mfma_f32_32x32x16_bf16 v[96:111], a[20:23], v[176:179], v[96:111]
    ds_write_b128 v228, v[24:27] offset:2048
    s_waitcnt vmcnt(9)
    v_mfma_f32_32x32x16_bf16 v[80:95], a[16:19], v[180:183], v[80:95]
    buffer_load_dwordx4 v[156:159], v227, s[36:39], s73 offen offset:1024 sc1
    v_mfma_f32_32x32x16_bf16 v[112:127], a[20:23], v[180:183], v[112:127]
    ds_write_b128 v228, v[28:31] offset:3072
    s_waitcnt vmcnt(9)
    v_mfma_f32_32x32x16_bf16 v[64:79], a[24:27], v[184:187], v[64:79]
    s_xor_b32 s74, s74, 4096
    buffer_load_dwordx4 v[160:163], v226, s[36:39], s74 offen offset:0 sc1
    v_mfma_f32_32x32x16_bf16 v[96:111], a[28:31], v[184:187], v[96:111]
    ds_write_b128 v229, v[32:35] offset:0
    s_waitcnt vmcnt(9)
    v_mfma_f32_32x32x16_bf16 v[80:95], a[24:27], v[188:191], v[80:95]
    buffer_load_dwordx4 v[164:167], v227, s[36:39], s74 offen offset:0 sc1
    v_mfma_f32_32x32x16_bf16 v[112:127], a[28:31], v[188:191], v[112:127]
    ds_write_b128 v229, v[36:39] offset:1024
    s_waitcnt vmcnt(9)
    v_mfma_f32_32x32x16_bf16 v[64:79], a[32:35], v[128:131], v[64:79]
    buffer_load_dwordx4 v[168:171], v226, s[36:39], s74 offen offset:1024 sc1
    v_mfma_f32_32x32x16_bf16 v[96:111], a[36:39], v[128:131], v[96:111]
    ds_write_b128 v229, v[40:43] offset:2048
    s_waitcnt vmcnt(9)
    v_mfma_f32_32x32x16_bf16 v[80:95], a[32:35], v[132:135], v[80:95]
    buffer_load_dwordx4 v[172:175], v227, s[36:39], s74 offen offset:1024 sc1
    v_mfma_f32_32x32x16_bf16 v[112:127], a[36:39], v[132:135], v[112:127]
    ds_write_b128 v229, v[44:47] offset:3072
    s_waitcnt vmcnt(9)
    v_mfma_f32_32x32x16_bf16 v[64:79], a[40:43], v[136:139], v[64:79]
    s_xor_b32 s75, s75, 4096
    buffer_load_dwordx4 v[176:179], v226, s[36:39], s75 offen offset:0 sc1
    v_mfma_f32_32x32x16_bf16 v[96:111], a[44:47], v[136:139], v[96:111]
    ds_write_b128 v230, v[48:51] offset:0
    s_waitcnt vmcnt(9)
    v_mfma_f32_32x32x16_bf16 v[80:95], a[40:43], v[140:143], v[80:95]
    buffer_load_dwordx4 v[180:183], v227, s[36:39], s75 offen offset:0 sc1
    v_mfma_f32_32x32x16_bf16 v[112:127], a[44:47], v[140:143], v[112:127]
    ds_write_b128 v230, v[52:55] offset:1024
    s_waitcnt vmcnt(9)
    v_mfma_f32_32x32x16_bf16 v[64:79], a[48:51], v[144:147], v[64:79]
    buffer_load_dwordx4 v[184:187], v226, s[36:39], s75 offen offset:1024 sc1
    v_mfma_f32_32x32x16_bf16 v[96:111], a[52:55], v[144:147], v[96:111]
    ds_write_b128 v230, v[56:59] offset:2048
    s_waitcnt vmcnt(9)
    v_mfma_f32_32x32x16_bf16 v[80:95], a[48:51], v[148:151], v[80:95]
    buffer_load_dwordx4 v[188:191], v227, s[36:39], s75 offen offset:1024 sc1
    v_mfma_f32_32x32x16_bf16 v[112:127], a[52:55], v[148:151], v[112:127]
    ds_write_b128 v230, v[60:63] offset:3072
    s_waitcnt vmcnt(9)
    v_mfma_f32_32x32x16_bf16 v[64:79], a[56:59], v[152:155], v[64:79]
    s_xor_b32 s76, s76, 4096
    buffer_load_dwordx4 v[128:131], v226, s[36:39], s76 offen offset:0 sc1
    v_mfma_f32_32x32x16_bf16 v[96:111], a[60:63], v[152:155], v[96:111]
    s_waitcnt lgkmcnt(0)
    s_barrier
    s_waitcnt vmcnt(9)
    v_mfma_f32_32x32x16_bf16 v[80:95], a[56:59], v[156:159], v[80:95]
    buffer_load_dwordx4 v[132:135], v227, s[36:39], s76 offen offset:0 sc1
    v_mfma_f32_32x32x16_bf16 v[112:127], a[60:63], v[156:159], v[112:127]
    ds_read_b128 v[16:19], v231 offset:0
    ds_read_b128 v[20:23], v231 offset:1024
    ds_read_b128 v[24:27], v231 offset:2048
    ds_read_b128 v[28:31], v231 offset:3072
    ds_read_b128 v[32:35], v231 offset:4096
    buffer_load_dword v238, v253, s[36:39], s91 offen offset:1088 sc1
    s_waitcnt vmcnt(10)
    v_mfma_f32_32x32x16_bf16 v[64:79], a[64:67], v[160:163], v[64:79]
    buffer_load_dwordx4 v[136:139], v226, s[36:39], s76 offen offset:1024 sc1
    v_mfma_f32_32x32x16_bf16 v[96:111], a[68:71], v[160:163], v[96:111]
    ds_read_b128 v[36:39], v231 offset:5120
    ds_read_b128 v[40:43], v231 offset:6144
    ds_read_b128 v[44:47], v231 offset:7168
    ds_read_b128 v[48:51], v231 offset:8192
    ds_read_b128 v[52:55], v231 offset:9216
    s_waitcnt vmcnt(10)
    v_mfma_f32_32x32x16_bf16 v[80:95], a[64:67], v[164:167], v[80:95]
    buffer_load_dwordx4 v[140:143], v227, s[36:39], s76 offen offset:1024 sc1
    v_mfma_f32_32x32x16_bf16 v[112:127], a[68:71], v[164:167], v[112:127]
    ds_read_b128 v[56:59], v231 offset:10240
    ds_read_b128 v[60:63], v231 offset:11264
    v_accvgpr_read_b32 v208, a224
    v_accvgpr_read_b32 v209, a225
    v_accvgpr_read_b32 v210, a226
    s_waitcnt vmcnt(10)
    v_mfma_f32_32x32x16_bf16 v[64:79], a[72:75], v[168:171], v[64:79]
    v_mfma_f32_32x32x16_bf16 v[96:111], a[76:79], v[168:171], v[96:111]
    v_accvgpr_read_b32 v211, a227
    v_accvgpr_read_b32 v212, a228
    v_accvgpr_read_b32 v213, a229
    v_accvgpr_read_b32 v214, a230
    v_accvgpr_read_b32 v215, a231
    s_waitcnt vmcnt(9)
    v_mfma_f32_32x32x16_bf16 v[80:95], a[72:75], v[172:175], v[80:95]
    v_mfma_f32_32x32x16_bf16 v[112:127], a[76:79], v[172:175], v[112:127]
    v_accvgpr_read_b32 v216, a232
    v_accvgpr_read_b32 v217, a233
    v_accvgpr_read_b32 v218, a234
    v_accvgpr_read_b32 v219, a235
    v_accvgpr_read_b32 v220, a236
    s_waitcnt vmcnt(8)
    v_mfma_f32_32x32x16_bf16 v[64:79], a[80:83], v[176:179], v[64:79]
    v_mfma_f32_32x32x16_bf16 v[96:111], a[84:87], v[176:179], v[96:111]
    v_accvgpr_read_b32 v221, a237
    v_accvgpr_read_b32 v222, a238
    v_accvgpr_read_b32 v223, a239
    s_waitcnt lgkmcnt(0)
    v_add_f32 v0, v0, v16
    s_waitcnt vmcnt(7)
    v_mfma_f32_32x32x16_bf16 v[80:95], a[80:83], v[180:183], v[80:95]
    v_mfma_f32_32x32x16_bf16 v[112:127], a[84:87], v[180:183], v[112:127]
    v_add_f32 v32, v32, v48
    v_add_f32 v0, v0, v32
    v_mul_f32 v0, v0, v239
    v_fmac_f32 v208, v0, v192
    v_add_f32 v1, v1, v17
    s_waitcnt vmcnt(2)
    v_cmp_ne_u32 vcc, s6, v238
    s_cmp_eq_u32 s7, 0
    s_cbranch_scc1 L_lr53
    s_cbranch_vccnz L_lr53
L_lj54:
    s_xor_b32 s70, s70, 4096
    buffer_load_dwordx4 v[144:147], v226, s[36:39], s70 offen offset:0 sc1
    buffer_load_dwordx4 v[148:151], v227, s[36:39], s70 offen offset:0 sc1
    buffer_load_dwordx4 v[152:155], v226, s[36:39], s70 offen offset:1024 sc1
    buffer_load_dwordx4 v[156:159], v227, s[36:39], s70 offen offset:1024 sc1
    v_mfma_f32_32x32x16_bf16 v[64:79], a[88:91], v[184:187], v[64:79]
    s_xor_b32 s71, s71, 4096
    buffer_load_dwordx4 v[160:163], v226, s[36:39], s71 offen offset:0 sc1
    v_mfma_f32_32x32x16_bf16 v[96:111], a[92:95], v[184:187], v[96:111]
    v_add_f32 v33, v33, v49
    v_add_f32 v1, v1, v33
    v_mul_f32 v1, v1, v239
    v_fmac_f32 v209, v1, v193
    v_add_f32 v2, v2, v18
    v_mfma_f32_32x32x16_bf16 v[80:95], a[88:91], v[188:191], v[80:95]
    buffer_load_dwordx4 v[164:167], v227, s[36:39], s71 offen offset:0 sc1
    v_mfma_f32_32x32x16_bf16 v[112:127], a[92:95], v[188:191], v[112:127]
    v_add_f32 v34, v34, v50
    v_add_f32 v2, v2, v34
    v_mul_f32 v2, v2, v239
    v_fmac_f32 v210, v2, v194
    v_add_f32 v3, v3, v19
    v_mfma_f32_32x32x16_bf16 v[64:79], a[96:99], v[128:131], v[64:79]
    buffer_load_dwordx4 v[168:171], v226, s[36:39], s71 offen offset:1024 sc1
    v_mfma_f32_32x32x16_bf16 v[96:111], a[100:103], v[128:131], v[96:111]
    v_add_f32 v35, v35, v51
    v_add_f32 v3, v3, v35
    v_mul_f32 v3, v3, v239
    v_fmac_f32 v211, v3, v195
    v_add_f32 v4, v4, v20
    v_mfma_f32_32x32x16_bf16 v[80:95], a[96:99], v[132:135], v[80:95]
    buffer_load_dwordx4 v[172:175], v227, s[36:39], s71 offen offset:1024 sc1
    v_mfma_f32_32x32x16_bf16 v[112:127], a[100:103], v[132:135], v[112:127]
    v_add_f32 v36, v36, v52
    v_add_f32 v4, v4, v36
    v_mul_f32 v4, v4, v239
    v_fmac_f32 v212, v4, v196
    v_add_f32 v5, v5, v21
    s_waitcnt vmcnt(9)
    v_mfma_f32_32x32x16_bf16 v[64:79], a[104:107], v[136:139], v[64:79]
    s_xor_b32 s72, s72, 4096
    buffer_load_dwordx4 v[176:179], v226, s[36:39], s72 offen offset:0 sc1
    v_mfma_f32_32x32x16_bf16 v[96:111], a[108:111], v[136:139], v[96:111]
    v_add_f32 v37, v37, v53
    v_add_f32 v5, v5, v37
    v_mul_f32 v5, v5, v239
    v_fmac_f32 v213, v5, v197
    v_add_f32 v6, v6, v22
    s_waitcnt vmcnt(9)
    v_mfma_f32_32x32x16_bf16 v[80:95], a[104:107], v[140:143], v[80:95]
    buffer_load_dwordx4 v[180:183], v227, s[36:39], s72 offen offset:0 sc1
    v_mfma_f32_32x32x16_bf16 v[112:127], a[108:111], v[140:143], v[112:127]
    v_add_f32 v38, v38, v54
    v_add_f32 v6, v6, v38
    v_mul_f32 v6, v6, v239
    v_fmac_f32 v214, v6, v198
    v_add_f32 v7, v7, v23
    s_waitcnt vmcnt(9)
    v_mfma_f32_32x32x16_bf16 v[64:79], a[112:115], v[144:147], v[64:79]
    buffer_load_dwordx4 v[184:187], v226, s[36:39], s72 offen offset:1024 sc1
    v_mfma_f32_32x32x16_bf16 v[96:111], a[116:119], v[144:147], v[96:111]
    v_add_f32 v39, v39, v55
    v_add_f32 v7, v7, v39
    v_mul_f32 v7, v7, v239
    v_fmac_f32 v215, v7, v199
    v_add_f32 v8, v8, v24
    s_waitcnt vmcnt(9)
    v_mfma_f32_32x32x16_bf16 v[80:95], a[112:115], v[148:151], v[80:95]
    buffer_load_dwordx4 v[188:191], v227, s[36:39], s72 offen offset:1024 sc1
    v_mfma_f32_32x32x16_bf16 v[112:127], a[116:119], v[148:151], v[112:127]
    v_add_f32 v40, v40, v56
    v_add_f32 v8, v8, v40
    v_mul_f32 v8, v8, v239
    v_fmac_f32 v216, v8, v200
    v_add_f32 v9, v9, v25
    s_waitcnt vmcnt(9)
    v_mfma_f32_32x32x16_bf16 v[64:79], a[120:123], v[152:155], v[64:79]
    s_xor_b32 s73, s73, 4096
    buffer_load_dwordx4 v[128:131], v227, s[36:39], s73 offen offset:0 sc1
    v_mfma_f32_32x32x16_bf16 v[96:111], a[124:127], v[152:155], v[96:111]
    v_add_f32 v41, v41, v57
    v_add_f32 v9, v9, v41
    v_mul_f32 v9, v9, v239
    v_fmac_f32 v217, v9, v201
    v_add_f32 v10, v10, v26
    s_waitcnt vmcnt(9)
    v_mfma_f32_32x32x16_bf16 v[80:95], a[120:123], v[156:159], v[80:95]
    buffer_load_dwordx4 v[132:135], v227, s[36:39], s73 offen offset:1024 sc1
    v_mfma_f32_32x32x16_bf16 v[112:127], a[124:127], v[156:159], v[112:127]
    v_add_f32 v42, v42, v58
    v_add_f32 v10, v10, v42
    v_mul_f32 v10, v10, v239
    v_fmac_f32 v218, v10, v202
    v_add_f32 v11, v11, v27
    s_waitcnt vmcnt(9)
    v_mfma_f32_32x32x16_bf16 v[64:79], a[128:131], v[160:163], v[64:79]
    s_xor_b32 s74, s74, 4096
    buffer_load_dwordx4 v[136:139], v227, s[36:39], s74 offen offset:0 sc1
    v_mfma_f32_32x32x16_bf16 v[96:111], a[132:135], v[160:163], v[96:111]
    v_add_f32 v43, v43, v59
    v_add_f32 v11, v11, v43
    v_mul_f32 v11, v11, v239
    v_fmac_f32 v219, v11, v203
    v_add_f32 v12, v12, v28
    s_waitcnt vmcnt(9)
    v_mfma_f32_32x32x16_bf16 v[80:95], a[128:131], v[164:167], v[80:95]
    buffer_load_dwordx4 v[140:143], v227, s[36:39], s74 offen offset:1024 sc1
    v_mfma_f32_32x32x16_bf16 v[112:127], a[132:135], v[164:167], v[112:127]
    v_add_f32 v44, v44, v60
    v_add_f32 v12, v12, v44
    v_mul_f32 v12, v12, v239
    v_fmac_f32 v220, v12, v204
    v_add_f32 v13, v13, v29
    s_waitcnt vmcnt(9)
    v_mfma_f32_32x32x16_bf16 v[64:79], a[136:139], v[168:171], v[64:79]
    s_xor_b32 s75, s75, 4096
    buffer_load_dwordx4 v[144:147], v227, s[36:39], s75 offen offset:0 sc1
    v_mfma_f32_32x32x16_bf16 v[96:111], a[140:143], v[168:171], v[96:111]
    v_add_f32 v45, v45, v61
    v_add_f32 v13, v13, v45
    v_mul_f32 v13, v13, v239
    v_fmac_f32 v221, v13, v205
    v_add_f32 v14, v14, v30
    s_waitcnt vmcnt(9)
    v_mfma_f32_32x32x16_bf16 v[80:95], a[136:139], v[172:175], v[80:95]
    buffer_load_dwordx4 v[148:151], v227, s[36:39], s75 offen offset:1024 sc1
    v_mfma_f32_32x32x16_bf16 v[112:127], a[140:143], v[172:175], v[112:127]
    v_add_f32 v46, v46, v62
    v_add_f32 v14, v14, v46
    v_mul_f32 v14, v14, v239
    v_fmac_f32 v222, v14, v206
    v_add_f32 v15, v15, v31
    s_waitcnt vmcnt(9)
    v_mfma_f32_32x32x16_bf16 v[64:79], a[144:147], v[176:179], v[64:79]
    s_xor_b32 s76, s76, 4096
    buffer_load_dwordx4 v[152:155], v227, s[36:39], s76 offen offset:0 sc1
    v_mfma_f32_32x32x16_bf16 v[96:111], a[148:151], v[176:179], v[96:111]
    v_add_f32 v47, v47, v63
    v_add_f32 v15, v15, v47
    v_mul_f32 v15, v15, v239
    v_fmac_f32 v223, v15, v207
    v_cvt_pk_bf16_f32 v0, v208, v209
    s_waitcnt vmcnt(9)
    v_mfma_f32_32x32x16_bf16 v[80:95], a[144:147], v[180:183], v[80:95]
    buffer_load_dwordx4 v[156:159], v227, s[36:39], s76 offen offset:1024 sc1
    v_mfma_f32_32x32x16_bf16 v[112:127], a[148:151], v[180:183], v[112:127]
    v_cvt_pk_bf16_f32 v1, v210, v211
    v_cvt_pk_bf16_f32 v2, v212, v213
    v_cvt_pk_bf16_f32 v3, v214, v215
    v_cvt_pk_bf16_f32 v4, v216, v217
    v_cvt_pk_bf16_f32 v5, v218, v219
    s_waitcnt vmcnt(9)
    v_mfma_f32_32x32x16_bf16 v[64:79], a[152:155], v[184:187], v[64:79]
    buffer_load_dwordx4 v[160:163], v226, s[36:39], s73 offen offset:0 sc1
    v_mfma_f32_32x32x16_bf16 v[96:111], a[156:159], v[184:187], v[96:111]
    v_cvt_pk_bf16_f32 v6, v220, v221
    v_cvt_pk_bf16_f32 v7, v222, v223
    v_permlane32_swap_b32 v0, v2
    v_permlane32_swap_b32 v1, v3
    v_permlane32_swap_b32 v4, v6
    s_waitcnt vmcnt(9)
    v_mfma_f32_32x32x16_bf16 v[80:95], a[152:155], v[188:191], v[80:95]
    buffer_load_dwordx4 v[164:167], v226, s[36:39], s73 offen offset:1024 sc1
    v_mfma_f32_32x32x16_bf16 v[112:127], a[156:159], v[188:191], v[112:127]
    v_permlane32_swap_b32 v5, v7
    v_accvgpr_read_b32 v208, a240
    v_accvgpr_read_b32 v209, a241
    v_accvgpr_read_b32 v210, a242
    v_accvgpr_read_b32 v211, a243
    s_waitcnt vmcnt(9)
    v_mfma_f32_32x32x16_bf16 v[80:95], a[160:163], v[128:131], v[80:95]
    buffer_load_dwordx4 v[168:171], v226, s[36:39], s74 offen offset:0 sc1
    v_mfma_f32_32x32x16_bf16 v[112:127], a[164:167], v[128:131], v[112:127]
    v_accvgpr_read_b32 v212, a244
    v_accvgpr_read_b32 v213, a245
    v_accvgpr_read_b32 v214, a246
    v_accvgpr_read_b32 v215, a247
    v_accvgpr_read_b32 v216, a248
    s_waitcnt vmcnt(9)
    v_mfma_f32_32x32x16_bf16 v[80:95], a[168:171], v[132:135], v[80:95]
    buffer_load_dwordx4 v[172:175], v226, s[36:39], s74 offen offset:1024 sc1
    v_mfma_f32_32x32x16_bf16 v[112:127], a[172:175], v[132:135], v[112:127]
    v_accvgpr_read_b32 v217, a249
    v_accvgpr_read_b32 v218, a250
    v_accvgpr_read_b32 v219, a251
    v_accvgpr_read_b32 v220, a252
    v_accvgpr_read_b32 v221, a253
    s_waitcnt vmcnt(9)
    v_mfma_f32_32x32x16_bf16 v[80:95], a[176:179], v[136:139], v[80:95]
    buffer_load_dwordx4 v[176:179], v226, s[36:39], s75 offen offset:0 sc1
    v_mfma_f32_32x32x16_bf16 v[112:127], a[180:183], v[136:139], v[112:127]
    v_accvgpr_read_b32 v222, a254
    v_accvgpr_read_b32 v223, a255
    v_mul_f32 v192, v192, v240
    v_mul_f32 v193, v193, v240
    v_mul_f32 v194, v194, v240
    s_waitcnt vmcnt(9)
    v_mfma_f32_32x32x16_bf16 v[80:95], a[184:187], v[140:143], v[80:95]
    buffer_load_dwordx4 v[180:183], v226, s[36:39], s75 offen offset:1024 sc1
    v_mfma_f32_32x32x16_bf16 v[112:127], a[188:191], v[140:143], v[112:127]
    v_mul_f32 v195, v195, v240
    v_mul_f32 v196, v196, v240
L_sb17:
    s_cbranch_execz L_wzc
    v_mul_f32 v197, v197, v240
    v_mul_f32 v198, v198, v240
    v_mul_f32 v199, v199, v240
    s_waitcnt vmcnt(9)
    v_mfma_f32_32x32x16_bf16 v[80:95], a[192:195], v[144:147], v[80:95]
    buffer_load_dwordx4 v[184:187], v226, s[36:39], s76 offen offset:0 sc1
    v_mfma_f32_32x32x16_bf16 v[112:127], a[196:199], v[144:147], v[112:127]
    v_mul_f32 v200, v200, v240
    v_mul_f32 v201, v201, v240
    v_mul_f32 v202, v202, v240
    v_mul_f32 v203, v203, v240
    v_mul_f32 v204, v204, v240
    s_waitcnt vmcnt(9)
    v_mfma_f32_32x32x16_bf16 v[80:95], a[200:203], v[148:151], v[80:95]
    buffer_load_dwordx4 v[188:191], v226, s[36:39], s76 offen offset:1024 sc1
    v_mfma_f32_32x32x16_bf16 v[112:127], a[204:207], v[148:151], v[112:127]
    v_mul_f32 v205, v205, v240
    v_mul_f32 v206, v206, v240
    v_mul_f32 v207, v207, v240
    s_waitcnt vmcnt(9)
    v_mfma_f32_32x32x16_bf16 v[80:95], a[208:211], v[152:155], v[80:95]
    v_mfma_f32_32x32x16_bf16 v[112:127], a[212:215], v[152:155], v[112:127]
    buffer_store_dwordx4 v[0:3], v236, s[32:35], s77 offen offset:0
    s_waitcnt vmcnt(9)
    v_mfma_f32_32x32x16_bf16 v[80:95], a[216:219], v[156:159], v[80:95]
    v_mfma_f32_32x32x16_bf16 v[112:127], a[220:223], v[156:159], v[112:127]
    buffer_store_dwordx4 v[4:7], v236, s[32:35], s77 offen offset:32
    s_waitcnt vmcnt(9)
    v_mfma_f32_32x32x16_bf16 v[96:111], a[164:167], v[160:163], v[96:111]
    v_mfma_f32_32x32x16_bf16 v[64:79], a[160:163], v[160:163], v[64:79]
    s_waitcnt vmcnt(8)
    v_mfma_f32_32x32x16_bf16 v[96:111], a[172:175], v[164:167], v[96:111]
    s_nop 4
    ds_write_b128 v228, v[80:83] offset:49152
    v_mfma_f32_32x32x16_bf16 v[64:79], a[168:171], v[164:167], v[64:79]
    ds_write_b128 v228, v[84:87] offset:50176
    s_waitcnt vmcnt(7)
    v_mfma_f32_32x32x16_bf16 v[96:111], a[180:183], v[168:171], v[96:111]
    v_mfma_f32_32x32x16_bf16 v[64:79], a[176:179], v[168:171], v[64:79]
    ds_write_b128 v228, v[88:91] offset:51200
    s_waitcnt vmcnt(6)
    v_mfma_f32_32x32x16_bf16 v[96:111], a[188:191], v[172:175], v[96:111]
    ds_write_b128 v228, v[92:95] offset:52224
    s_waitcnt vmcnt(5)
    v_mfma_f32_32x32x16_bf16 v[96:111], a[196:199], v[176:179], v[96:111]
    s_waitcnt vmcnt(4)
    v_mfma_f32_32x32x16_bf16 v[96:111], a[204:207], v[180:183], v[96:111]
    ds_write_b128 v230, v[112:115] offset:49152
    s_waitcnt vmcnt(3)
    v_mfma_f32_32x32x16_bf16 v[96:111], a[212:215], v[184:187], v[96:111]
    ds_write_b128 v230, v[116:119] offset:50176
    s_waitcnt vmcnt(2)
    v_mfma_f32_32x32x16_bf16 v[96:111], a[220:223], v[188:191], v[96:111]
    v_mfma_f32_32x32x16_bf16 v[64:79], a[184:187], v[172:175], v[64:79]
    ds_write_b128 v230, v[120:123] offset:51200
    v_mfma_f32_32x32x16_bf16 v[64:79], a[192:195], v[176:179], v[64:79]
    ds_write_b128 v230, v[124:127] offset:52224
    v_mfma_f32_32x32x16_bf16 v[64:79], a[200:203], v[180:183], v[64:79]
    v_mfma_f32_32x32x16_bf16 v[64:79], a[208:211], v[184:187], v[64:79]
    s_nop 5
    ds_write_b128 v229, v[96:99] offset:49152
    v_mfma_f32_32x32x16_bf16 v[64:79], a[216:219], v[188:191], v[64:79]
    ds_write_b128 v229, v[100:103] offset:50176
    ds_write_b128 v229, v[104:107] offset:51200
    ds_write_b128 v229, v[108:111] offset:52224
    s_add_u32 s77, s77, 114688
    s_waitcnt lgkmcnt(0)
    s_barrier
    ds_read_b128 v[16:19], v231 offset:49152
    ds_read_b128 v[32:35], v231 offset:53248
    ds_read_b128 v[48:51], v231 offset:57344
    ds_read_b128 v[20:23], v231 offset:50176
    ds_read_b128 v[36:39], v231 offset:54272
    ds_read_b128 v[52:55], v231 offset:58368
    ds_read_b128 v[24:27], v231 offset:51200
    ds_read_b128 v[40:43], v231 offset:55296
    ds_read_b128 v[56:59], v231 offset:59392
    ds_read_b128 v[28:31], v231 offset:52224
    ds_read_b128 v[44:47], v231 offset:56320
    ds_read_b128 v[60:63], v231 offset:60416
    s_waitcnt lgkmcnt(9)
    .p2align 3
    v_pk_add_f32 v[16:17], v[16:17], v[32:33]
    v_pk_add_f32 v[48:49], v[48:49], v[64:65]
    v_pk_add_f32 v[16:17], v[16:17], v[48:49]
    v_pk_fma_f32 v[208:209], v[16:17], v[192:193], v[208:209]
    v_cvt_pk_bf16_f32 v8, v208, v209
    v_pk_add_f32 v[18:19], v[18:19], v[34:35]
    v_pk_add_f32 v[50:51], v[50:51], v[66:67]
    v_pk_add_f32 v[18:19], v[18:19], v[50:51]
    v_pk_fma_f32 v[210:211], v[18:19], v[194:195], v[210:211]
    v_cvt_pk_bf16_f32 v9, v210, v211
    s_waitcnt lgkmcnt(6)
    .p2align 3
    v_pk_add_f32 v[20:21], v[20:21], v[36:37]
    v_pk_add_f32 v[52:53], v[52:53], v[68:69]
    v_pk_add_f32 v[20:21], v[20:21], v[52:53]
    v_pk_fma_f32 v[212:213], v[20:21], v[196:197], v[212:213]
    v_cvt_pk_bf16_f32 v10, v212, v213
    v_pk_add_f32 v[22:23], v[22:23], v[38:39]
    v_pk_add_f32 v[54:55], v[54:55], v[70:71]
    v_pk_add_f32 v[22:23], v[22:23], v[54:55]
    v_pk_fma_f32 v[214:215], v[22:23], v[198:199], v[214:215]
    v_cvt_pk_bf16_f32 v11, v214, v215
    v_permlane32_swap_b32 v8, v10
    s_nop 0
    v_permlane32_swap_b32 v9, v11
    buffer_store_dwordx4 v[8:11], v236, s[32:35], s77 offen offset:0
    s_waitcnt lgkmcnt(3)
    .p2align 3
    v_pk_add_f32 v[24:25], v[24:25], v[40:41]
    v_pk_add_f32 v[56:57], v[56:57], v[72:73]
    v_pk_add_f32 v[24:25], v[24:25], v[56:57]
    v_pk_fma_f32 v[216:217], v[24:25], v[200:201], v[216:217]
    v_cvt_pk_bf16_f32 v12, v216, v217
    v_pk_add_f32 v[26:27], v[26:27], v[42:43]
    v_pk_add_f32 v[58:59], v[58:59], v[74:75]
    v_pk_add_f32 v[26:27], v[26:27], v[58:59]
    v_pk_fma_f32 v[218:219], v[26:27], v[202:203], v[218:219]
    v_cvt_pk_bf16_f32 v13, v218, v219
    s_waitcnt lgkmcnt(0)
    .p2align 3
    v_pk_add_f32 v[28:29], v[28:29], v[44:45]
    v_pk_add_f32 v[60:61], v[60:61], v[76:77]
    v_pk_add_f32 v[28:29], v[28:29], v[60:61]
    v_pk_fma_f32 v[220:221], v[28:29], v[204:205], v[220:221]
    v_cvt_pk_bf16_f32 v14, v220, v221
    v_pk_add_f32 v[30:31], v[30:31], v[46:47]
    v_pk_add_f32 v[62:63], v[62:63], v[78:79]
    v_pk_add_f32 v[30:31], v[30:31], v[62:63]
    v_pk_fma_f32 v[222:223], v[30:31], v[206:207], v[222:223]
    v_cvt_pk_bf16_f32 v15, v222, v223
    v_permlane32_swap_b32 v12, v14
    s_nop 0
    v_permlane32_swap_b32 v13, v15
    buffer_store_dwordx4 v[12:15], v236, s[32:35], s77 offen offset:32
L_fin:
    s_endpgm
L_tail:
L_h2:
    v_lshrrev_b32 v20, 2, v255
    v_bfe_u32 v21, v255, 3, 2
    v_xor_b32 v21, s3, v21
    v_lshlrev_b32 v21, 5, v21
    v_lshl_add_u32 v20, v20, 7, v21
    v_and_b32 v21, 3, v255
    v_lshl_add_u32 v20, v21, 3, v20
    v_add_u32 v20, 57344, v20
    v_and_b32 v22, 48, v255
    v_and_b32 v23, 1, v255
    v_lshl_add_u32 v23, v23, 6, v22
    s_and_b32 s61, s95, 1
    s_mul_i32 s62, s61, 448
    s_add_u32 s62, s62, 158720
    v_add_u32 v21, s62, v22
    s_mul_i32 s61, s61, 56
    s_lshr_b32 s62, s95, 1
    s_lshl_b32 s62, s62, 2
    s_add_u32 s61, s61, s62
    s_add_u32 s61, s61, s3
    s_lshl_b32 s61, s61, 7
    s_add_u32 s84, s61, 65536
    s_cmp_ge_u32 s95, 28
    s_cselect_b32 s84, 1073741824, s84
    s_lshl_b32 s58, s4, 2
    s_add_u32 s58, s58, s5
    s_sub_u32 s58, s58, 28
    v_bfe_u32 v24, v2, 1, 2
    v_and_b32 v25, 0xf1, v2
    v_lshl_add_u32 v25, v24, 2, v25
    v_bfe_u32 v24, v2, 3, 1
    v_lshl_add_u32 v25, v24, 1, v25
    v_lshlrev_b32 v25, 2, v25
    v_add_u32 v25, 158720, v25
    s_waitcnt vmcnt(10)
    v_lshlrev_b32 v26, 16, v8
    v_and_b32 v27, 0xffff0000, v8
    v_mul_f32 v28, 0xbfb8aa3b, v26
    v_mul_f32 v29, 0xbfb8aa3b, v27
    v_exp_f32 v28, v28
    v_exp_f32 v29, v29
    v_add_f32 v28, 1.0, v28
    v_add_f32 v29, 1.0, v29
    v_rcp_f32 v28, v28
    v_rcp_f32 v29, v29
    v_mul_f32 v26, v26, v28
    v_mul_f32 v27, v27, v29
    v_cvt_pk_bf16_f32 v26, v26, v27
    ds_write_b32 v25, v26
    s_waitcnt lgkmcnt(0)
    s_mul_i32 s6, s6, 0x9E3779B1
    s_add_u32 s6, s6, 0x7F4A7C15
    v_mov_b32 v245, s6
    s_waitcnt vmcnt(3)
    s_barrier
    ds_read_b128 v[140:143], v21 offset:0
    ds_read_b64_tr_b16 v[168:169], v20 offset:0
    ds_read_b64_tr_b16 v[170:171], v20 offset:2048
    ds_read_b128 v[144:147], v21 offset:64
    ds_read_b64_tr_b16 v[172:173], v20 offset:4096
    ds_read_b64_tr_b16 v[174:175], v20 offset:6144
    ds_read_b128 v[148:151], v21 offset:128
    ds_read_b64_tr_b16 v[176:177], v20 offset:8192
    ds_read_b64_tr_b16 v[178:179], v20 offset:10240
    ds_read_b128 v[152:155], v21 offset:192
    ds_read_b64_tr_b16 v[180:181], v20 offset:12288
    ds_read_b64_tr_b16 v[182:183], v20 offset:14336
    ds_read_b128 v[156:159], v21 offset:256
    ds_read_b64_tr_b16 v[184:185], v20 offset:16384
    ds_read_b64_tr_b16 v[186:187], v20 offset:18432
    ds_read_b128 v[160:163], v21 offset:320
    ds_read_b64_tr_b16 v[188:189], v20 offset:20480
    ds_read_b64_tr_b16 v[190:191], v20 offset:22528
    ds_read_b128 v[164:167], v21 offset:384
    ds_read_b64_tr_b16 v[192:193], v20 offset:24576
    ds_read_b64_tr_b16 v[194:195], v20 offset:26624
    s_waitcnt lgkmcnt(15)
    v_mfma_f32_16x16x32_bf16 v[24:27], v[168:171], v[140:143], 0
    v_mfma_f32_16x16x32_bf16 v[24:27], v[172:175], v[144:147], v[24:27]
    s_waitcnt lgkmcnt(12)
    v_mfma_f32_16x16x32_bf16 v[24:27], v[176:179], v[148:151], v[24:27]
    s_waitcnt lgkmcnt(9)
    v_mfma_f32_16x16x32_bf16 v[24:27], v[180:183], v[152:155], v[24:27]
    s_waitcnt lgkmcnt(6)
    v_mfma_f32_16x16x32_bf16 v[24:27], v[184:187], v[156:159], v[24:27]
    s_waitcnt lgkmcnt(3)
    v_mfma_f32_16x16x32_bf16 v[24:27], v[188:191], v[160:163], v[24:27]
    s_waitcnt lgkmcnt(0)
    v_mfma_f32_16x16x32_bf16 v[24:27], v[192:195], v[164:167], v[24:27]
    s_mov_b32 exec_lo, 65537
    s_mov_b32 exec_hi, exec_lo
    s_nop 5
    v_perm_b32 v24, v24, v245, s86
    v_perm_b32 v25, v25, v245, s87
    v_perm_b32 v26, v26, v245, s88
    v_perm_b32 v27, v27, v245, s89
    buffer_store_dwordx4 v[24:27], v23, s[36:39], s84 offen sc1
    s_mov_b64 exec, -1
    s_cmp_lg_u32 s3, 0
    s_cbranch_scc1 L_nx1
    v_perm_b32 v136, v18, v245, s86
    v_perm_b32 v137, v18, v245, s87
    v_perm_b32 v138, v18, v245, s88
    v_perm_b32 v139, v18, v245, s89
    s_mov_b64 exec, 1
    buffer_store_dwordx4 v[136:139], v254, s[36:39], s90 offen sc1
    s_mov_b64 exec, -1
L_nx1:
    s_lshl_b32 s85, s58, 2
    s_add_u32 s85, s85, s3
    s_lshl_b32 s61, s85, 8
    s_add_u32 s61, s61, 16384
    v_and_b32 v11, 1, v255
    v_lshlrev_b32 v11, 7, v11
    buffer_load_dword v238, v11, s[36:39], s61 offen sc1
    buffer_load_dword v238, v77, s[32:35], s98 offen sc1
    s_cmp_eq_u32 s3, 0
    s_cbranch_scc1 L_hx
    s_waitcnt vmcnt(3)
L_hx:
    s_waitcnt vmcnt(4)
    s_barrier
    s_branch L_w3
L_fs1:
    buffer_wbl2 sc1
    s_waitcnt vmcnt(0)
    buffer_store_dword v245, off, s[36:39], s46 sc1
    s_branch L_fj2
L_pi5:
    s_waitcnt vmcnt(0)
    buffer_inv sc1
    s_waitcnt vmcnt(0)
    s_branch L_pj6
L_fs7:
    buffer_wbl2 sc1
    s_waitcnt vmcnt(0)
    buffer_store_dword v245, off, s[36:39], s84 sc1
    s_branch L_fj8
L_fs9:
    buffer_wbl2 sc1
    s_waitcnt vmcnt(0)
    buffer_store_dword v245, off, s[36:39], s84 sc1
    s_branch L_fj10
L_fs11:
    buffer_wbl2 sc1
    s_waitcnt vmcnt(0)
    buffer_store_dword v245, off, s[36:39], s46 sc1
    s_branch L_fj12
L_pi15:
    s_waitcnt vmcnt(0)
    buffer_inv sc1
    s_waitcnt vmcnt(0)
    s_branch L_pj16
L_fs17:
    buffer_wbl2 sc1
    s_waitcnt vmcnt(0)
    buffer_store_dword v245, off, s[36:39], s91 sc1
    s_branch L_fj18
L_hu0:
    s_waitcnt vmcnt(0)
    s_mov_b64 exec, 1
    s_cmp_eq_u32 s7, 0
    s_cbranch_scc1 L_fs17
    buffer_store_dword v245, off, s[36:39], s91
L_fj18:
    s_mov_b64 exec, -1
    s_lshl_b32 s61, s3, 6
    v_add_u32 v4, s61, v255
    v_add_u32 v5, 256, v4
    v_min_u32 v5, 447, v5
    s_lshl_b32 s85, s58, 2
    s_add_u32 s85, s85, s3
    s_min_u32 s62, s85, 111
    s_lshl_b32 s62, s62, 5
    v_and_b32 v16, 15, v255
    v_lshl_add_u32 v17, v16, 1, s62
    global_load_ushort v18, v17, s[40:41]
    v_and_b32 v6, 0x1f8, v4
    v_and_b32 v239, 3, v4
    v_lshl_add_u32 v6, v239, 1, v6
    v_bfe_u32 v239, v4, 2, 1
    v_add_lshl_u32 v6, v6, v239, 3
    v_add_u32 v6, 159744, v6
    v_lshlrev_b32 v4, 4, v4
    v_and_b32 v7, 0x1f8, v5
    v_and_b32 v239, 3, v5
    v_lshl_add_u32 v7, v239, 1, v7
    v_bfe_u32 v239, v5, 2, 1
    v_add_lshl_u32 v7, v7, v239, 3
    v_add_u32 v7, 159744, v7
    v_lshlrev_b32 v5, 4, v5
    s_mov_b32 s60, 0
    s_mov_b32 s61, 458752
L_nu:
    buffer_load_dwordx4 v[8:11], v4, s[36:39], s61 offen sc1
    buffer_load_dwordx4 v[12:15], v5, s[36:39], s61 offen sc1
    s_add_u32 s60, s60, 1
    s_waitcnt vmcnt(0)
    v_cmp_ne_u32 vcc, s6, v9
    v_cmp_ne_u32 s[62:63], s6, v11
    v_cmp_ne_u32 s[64:65], s6, v13
    v_cmp_ne_u32 s[82:83], s6, v15
    s_or_b64 vcc, vcc, s[62:63]
    s_or_b64 s[64:65], s[64:65], s[82:83]
    s_or_b64 vcc, vcc, s[64:65]
    s_cbranch_vccz L_nud
    s_cmp_lt_u32 s60, 60000
    s_cbranch_scc1 L_nu
L_nud:
    v_mov_b32 v9, v10
    v_mov_b32 v13, v14
    ds_write_b64 v6, v[8:9]
    ds_write_b64 v7, v[12:13]
    v_lshrrev_b32 v20, 2, v255
    v_bfe_u32 v21, v255, 3, 2
    v_xor_b32 v21, s3, v21
    v_lshlrev_b32 v21, 5, v21
    v_lshl_add_u32 v20, v20, 7, v21
    v_and_b32 v21, 3, v255
    v_lshl_add_u32 v20, v21, 3, v20
    v_add_u32 v20, 0, v20
    v_and_b32 v21, 1, v255
    v_mul_u32_u24 v21, 896, v21
    v_and_b32 v22, 48, v255
    v_sub_u32 v21, v22, v21
    v_add_u32 v21, 161536, v21
    s_waitcnt lgkmcnt(0)
    s_barrier
    s_cmp_lg_u32 s4, 7
    s_cbranch_scc1 L_hu
    s_cmp_lg_u32 s85, 112
    s_cbranch_scc1 L_hz
    s_mov_b64 exec, 1
    buffer_store_dword v245, off, s[36:39], 0 sc1
    s_mov_b64 exec, -1
    s_branch L_hz
L_hu:
    ds_read_b128 v[32:35], v21 offset:0
    ds_read_b64_tr_b16 v[36:37], v20 offset:0
    ds_read_b64_tr_b16 v[38:39], v20 offset:2048
    ds_read_b128 v[40:43], v21 offset:64
    ds_read_b64_tr_b16 v[44:45], v20 offset:4096
    ds_read_b64_tr_b16 v[46:47], v20 offset:6144
    ds_read_b128 v[48:51], v21 offset:128
    ds_read_b64_tr_b16 v[52:53], v20 offset:8192
    ds_read_b64_tr_b16 v[54:55], v20 offset:10240
    ds_read_b128 v[56:59], v21 offset:192
    ds_read_b64_tr_b16 v[60:61], v20 offset:12288
    ds_read_b64_tr_b16 v[62:63], v20 offset:14336
    s_waitcnt lgkmcnt(9)
    v_mfma_f32_16x16x32_bf16 v[24:27], v[32:35], v[36:39], 0
    ds_read_b128 v[64:67], v21 offset:256
    ds_read_b64_tr_b16 v[68:69], v20 offset:16384
    ds_read_b64_tr_b16 v[70:71], v20 offset:18432
    s_waitcnt lgkmcnt(9)
    v_mfma_f32_16x16x32_bf16 v[24:27], v[40:43], v[44:47], v[24:27]
    ds_read_b128 v[32:35], v21 offset:320
    ds_read_b64_tr_b16 v[36:37], v20 offset:20480
    ds_read_b64_tr_b16 v[38:39], v20 offset:22528
    s_waitcnt lgkmcnt(9)
    v_mfma_f32_16x16x32_bf16 v[24:27], v[48:51], v[52:55], v[24:27]
    ds_read_b128 v[40:43], v21 offset:384
    ds_read_b64_tr_b16 v[44:45], v20 offset:24576
    ds_read_b64_tr_b16 v[46:47], v20 offset:26624
    s_waitcnt lgkmcnt(9)
    v_mfma_f32_16x16x32_bf16 v[24:27], v[56:59], v[60:63], v[24:27]
    ds_read_b128 v[48:51], v21 offset:448
    ds_read_b64_tr_b16 v[52:53], v20 offset:28672
    ds_read_b64_tr_b16 v[54:55], v20 offset:30720
    s_waitcnt lgkmcnt(9)
    v_mfma_f32_16x16x32_bf16 v[24:27], v[64:67], v[68:71], v[24:27]
    ds_read_b128 v[56:59], v21 offset:512
    ds_read_b64_tr_b16 v[60:61], v20 offset:32768
    ds_read_b64_tr_b16 v[62:63], v20 offset:34816
    s_waitcnt lgkmcnt(9)
    v_mfma_f32_16x16x32_bf16 v[24:27], v[32:35], v[36:39], v[24:27]
    ds_read_b128 v[64:67], v21 offset:576
    ds_read_b64_tr_b16 v[68:69], v20 offset:36864
    ds_read_b64_tr_b16 v[70:71], v20 offset:38912
    s_waitcnt lgkmcnt(9)
    v_mfma_f32_16x16x32_bf16 v[24:27], v[40:43], v[44:47], v[24:27]
    ds_read_b128 v[32:35], v21 offset:640
    ds_read_b64_tr_b16 v[36:37], v20 offset:40960
    ds_read_b64_tr_b16 v[38:39], v20 offset:43008
    s_waitcnt lgkmcnt(9)
    v_mfma_f32_16x16x32_bf16 v[24:27], v[48:51], v[52:55], v[24:27]
    ds_read_b128 v[40:43], v21 offset:704
    ds_read_b64_tr_b16 v[44:45], v20 offset:45056
    ds_read_b64_tr_b16 v[46:47], v20 offset:47104
    s_waitcnt lgkmcnt(9)
    v_mfma_f32_16x16x32_bf16 v[24:27], v[56:59], v[60:63], v[24:27]
    ds_read_b128 v[48:51], v21 offset:768
    ds_read_b64_tr_b16 v[52:53], v20 offset:49152
    ds_read_b64_tr_b16 v[54:55], v20 offset:51200
    s_waitcnt lgkmcnt(9)
    v_mfma_f32_16x16x32_bf16 v[24:27], v[64:67], v[68:71], v[24:27]
    ds_read_b128 v[56:59], v21 offset:832
    ds_read_b64_tr_b16 v[60:61], v20 offset:53248
    ds_read_b64_tr_b16 v[62:63], v20 offset:55296
    s_waitcnt lgkmcnt(9)
    v_mfma_f32_16x16x32_bf16 v[24:27], v[32:35], v[36:39], v[24:27]
    s_waitcnt lgkmcnt(6)
    v_mfma_f32_16x16x32_bf16 v[24:27], v[40:43], v[44:47], v[24:27]
    s_waitcnt lgkmcnt(3)
    v_mfma_f32_16x16x32_bf16 v[24:27], v[48:51], v[52:55], v[24:27]
    s_waitcnt lgkmcnt(0)
    v_mfma_f32_16x16x32_bf16 v[24:27], v[56:59], v[60:63], v[24:27]
    v_lshlrev_b32 v18, 16, v18
    s_lshl_b32 s61, s85, 8
    s_add_u32 s61, s61, 114688
    v_mov_b32 v31, s6
    s_nop 3
    v_add_f32 v25, v25, v18
    v_cvt_pk_bf16_f32 v29, v24, v25
    v_lshlrev_b32 v26, 16, v29
    v_and_b32 v27, 0xffff0000, v29
    v_sub_f32 v24, v24, v26
    v_sub_f32 v25, v25, v27
    v_cvt_pk_bf16_f32 v28, v26, v24
    v_cvt_pk_bf16_f32 v30, v25, v27
    s_mov_b64 exec, 0xffff
    buffer_store_dwordx4 v[28:31], v254, s[36:39], s61 offen sc1
    s_mov_b64 exec, -1
L_hz:
    s_lshl_b32 s65, s58, 2
    s_add_u32 s65, s65, s3
    s_and_b32 s65, s65, 15
    s_add_u32 s66, s4, 0
    s_cmp_ge_u32 s66, 7
    s_cselect_b32 s64, 7, 0
    s_sub_u32 s66, s66, s64
    s_lshl_b32 s66, s66, 4
    s_add_u32 s65, s65, s66
    s_and_b32 s66, s65, 7
    s_lshr_b32 s65, s65, 3
    v_min_u32 v239, 55, v255
    s_bitcmp0_b32 s65, 1
    s_cselect_b32 s64, 57344, 0
    s_mul_i32 s65, s65, 114688
    s_add_u32 s65, s65, s64
    s_mul_i32 s66, s66, 7168
    s_add_u32 s65, s65, s66
    v_lshlrev_b32 v239, 7, v239
    buffer_load_dword v238, v239, s[24:27], s65 offen
    s_lshl_b32 s65, s58, 2
    s_add_u32 s65, s65, s3
    s_and_b32 s65, s65, 15
    s_add_u32 s66, s4, 1
    s_cmp_ge_u32 s66, 7
    s_cselect_b32 s64, 7, 0
    s_sub_u32 s66, s66, s64
    s_lshl_b32 s66, s66, 4
    s_add_u32 s65, s65, s66
    s_and_b32 s66, s65, 7
    s_lshr_b32 s65, s65, 3
    v_min_u32 v239, 55, v255
    s_bitcmp0_b32 s65, 1
    s_cselect_b32 s64, 57344, 0
    s_mul_i32 s65, s65, 114688
    s_add_u32 s65, s65, s64
    s_mul_i32 s66, s66, 7168
    s_add_u32 s65, s65, s66
    v_lshlrev_b32 v239, 7, v239
    buffer_load_dword v238, v239, s[24:27], s65 offen
    s_lshl_b32 s65, s58, 2
    s_add_u32 s65, s65, s3
    s_and_b32 s65, s65, 15
    s_add_u32 s66, s4, 2
    s_cmp_ge_u32 s66, 7
    s_cselect_b32 s64, 7, 0
    s_sub_u32 s66, s66, s64
    s_lshl_b32 s66, s66, 4
    s_add_u32 s65, s65, s66
    s_and_b32 s66, s65, 7
    s_lshr_b32 s65, s65, 3
    v_min_u32 v239, 55, v255
    s_bitcmp0_b32 s65, 1
    s_cselect_b32 s64, 57344, 0
    s_mul_i32 s65, s65, 114688
    s_add_u32 s65, s65, s64
    s_mul_i32 s66, s66, 7168
    s_add_u32 s65, s65, s66
    v_lshlrev_b32 v239, 7, v239
    buffer_load_dword v238, v239, s[24:27], s65 offen
    s_lshl_b32 s65, s58, 2
    s_add_u32 s65, s65, s3
    s_and_b32 s65, s65, 15
    s_add_u32 s66, s4, 3
    s_cmp_ge_u32 s66, 7
    s_cselect_b32 s64, 7, 0
    s_sub_u32 s66, s66, s64
    s_lshl_b32 s66, s66, 4
    s_add_u32 s65, s65, s66
    s_and_b32 s66, s65, 7
    s_lshr_b32 s65, s65, 3
    v_min_u32 v239, 55, v255
    s_bitcmp0_b32 s65, 1
    s_cselect_b32 s64, 57344, 0
    s_mul_i32 s65, s65, 114688
    s_add_u32 s65, s65, s64
    s_mul_i32 s66, s66, 7168
    s_add_u32 s65, s65, s66
    v_lshlrev_b32 v239, 7, v239
    buffer_load_dword v238, v239, s[24:27], s65 offen
    s_lshl_b32 s65, s58, 2
    s_add_u32 s65, s65, s3
    s_and_b32 s65, s65, 15
    s_add_u32 s66, s4, 4
    s_cmp_ge_u32 s66, 7
    s_cselect_b32 s64, 7, 0
    s_sub_u32 s66, s66, s64
    s_lshl_b32 s66, s66, 4
    s_add_u32 s65, s65, s66
    s_and_b32 s66, s65, 7
    s_lshr_b32 s65, s65, 3
    v_min_u32 v239, 55, v255
    s_bitcmp0_b32 s65, 1
    s_cselect_b32 s64, 57344, 0
    s_mul_i32 s65, s65, 114688
    s_add_u32 s65, s65, s64
    s_mul_i32 s66, s66, 7168
    s_add_u32 s65, s65, s66
    v_lshlrev_b32 v239, 7, v239
    buffer_load_dword v238, v239, s[24:27], s65 offen
    s_lshl_b32 s65, s58, 2
    s_add_u32 s65, s65, s3
    s_and_b32 s65, s65, 15
    s_add_u32 s66, s4, 5
    s_cmp_ge_u32 s66, 7
    s_cselect_b32 s64, 7, 0
    s_sub_u32 s66, s66, s64
    s_lshl_b32 s66, s66, 4
    s_add_u32 s65, s65, s66
    s_and_b32 s66, s65, 7
    s_lshr_b32 s65, s65, 3
    v_min_u32 v239, 55, v255
    s_bitcmp0_b32 s65, 1
    s_cselect_b32 s64, 57344, 0
    s_mul_i32 s65, s65, 114688
    s_add_u32 s65, s65, s64
    s_mul_i32 s66, s66, 7168
    s_add_u32 s65, s65, s66
    v_lshlrev_b32 v239, 7, v239
    buffer_load_dword v238, v239, s[24:27], s65 offen
    s_lshl_b32 s65, s58, 2
    s_add_u32 s65, s65, s3
    s_and_b32 s65, s65, 15
    s_add_u32 s66, s4, 6
    s_cmp_ge_u32 s66, 7
    s_cselect_b32 s64, 7, 0
    s_sub_u32 s66, s66, s64
    s_lshl_b32 s66, s66, 4
    s_add_u32 s65, s65, s66
    s_and_b32 s66, s65, 7
    s_lshr_b32 s65, s65, 3
    v_min_u32 v239, 55, v255
    s_bitcmp0_b32 s65, 1
    s_cselect_b32 s64, 57344, 0
    s_mul_i32 s65, s65, 114688
    s_add_u32 s65, s65, s64
    s_mul_i32 s66, s66, 7168
    s_add_u32 s65, s65, s66
    v_lshlrev_b32 v239, 7, v239
    buffer_load_dword v238, v239, s[24:27], s65 offen
    s_branch L_fin
L_fs19:
    buffer_wbl2 sc1
    s_waitcnt vmcnt(0)
    buffer_store_dword v245, off, s[36:39], s91 sc1
    s_branch L_fj20
L_pi23:
    s_waitcnt vmcnt(0)
    buffer_inv sc1
    s_waitcnt vmcnt(0)
    s_branch L_pj24
L_aur:
    s_add_u32 s60, s60, 1
    s_cmp_ge_u32 s60, 60000
    s_cbranch_scc1 L_aud
    buffer_load_dwordx4 v[144:147], v254, s[36:39], s89 offen sc1
    buffer_load_dwordx4 v[148:151], v254, s[36:39], s90 offen sc1
    s_waitcnt vmcnt(0)
    s_branch L_au
L_lr25:
    s_mov_b32 s60, 0
L_lr25a:
    buffer_load_dword v238, v228, s[36:39], s82 offen offset:256 sc1
    s_add_u32 s60, s60, 1
    s_waitcnt vmcnt(0)
    v_cmp_ne_u32 vcc, s6, v238
    s_cbranch_vccz L_lr25b
    s_cmp_lt_u32 s60, 60000
    s_cbranch_scc1 L_lr25a
L_lr25b:
    s_cmp_eq_u32 s7, 1
    s_cbranch_scc1 L_lj26
    buffer_inv sc1
    s_waitcnt vmcnt(0)
    s_branch L_lj26
L_fs27:
    buffer_wbl2 sc1
    s_waitcnt vmcnt(0)
    buffer_store_dword v245, off, s[36:39], s79 sc1
    s_branch L_fj28
L_fs29:
    buffer_wbl2 sc1
    s_waitcnt vmcnt(0)
    buffer_store_dword v245, off, s[36:39], s79 sc1
    s_branch L_fj30
L_fs31:
    buffer_wbl2 sc1
    s_waitcnt vmcnt(0)
    buffer_store_dword v245, off, s[36:39], s79 sc1
    s_branch L_fj32
L_fs33:
    buffer_wbl2 sc1
    s_waitcnt vmcnt(0)
    buffer_store_dword v245, off, s[36:39], s79 sc1
    s_branch L_fj34
L_fs35:
    buffer_wbl2 sc1
    s_waitcnt vmcnt(0)
    buffer_store_dword v245, off, s[36:39], s91 sc1
    s_branch L_fj36
L_pi39:
    s_waitcnt vmcnt(0)
    buffer_inv sc1
    s_waitcnt vmcnt(0)
    s_branch L_pj40
L_nvr:
    s_add_u32 s60, s60, 1
    s_cmp_ge_u32 s60, 60000
    s_cbranch_scc1 L_nvd
    buffer_load_dwordx4 v[228:231], v232, s[36:39], s45 offen sc1
    s_waitcnt vmcnt(0)
    s_branch L_nv
L_fs41:
    buffer_wbl2 sc1
    s_waitcnt vmcnt(0)
    buffer_store_dword v245, off, s[36:39], s99 sc1
    s_branch L_fj42
L_fs43:
    buffer_wbl2 sc1
    s_waitcnt vmcnt(0)
    buffer_store_dword v245, off, s[36:39], s99 sc1
    s_branch L_fj44
L_pi47:
    s_waitcnt vmcnt(0)
    buffer_inv sc1
    s_waitcnt vmcnt(0)
    s_branch L_pj48
L_lr49:
    s_mov_b32 s60, 0
L_lr49a:
    buffer_load_dword v238, v253, s[36:39], s91 offen offset:64 sc1
    s_add_u32 s60, s60, 1
    s_waitcnt vmcnt(0)
    v_cmp_ne_u32 vcc, s6, v238
    s_cbranch_vccz L_lr49b
    s_cmp_lt_u32 s60, 60000
    s_cbranch_scc1 L_lr49a
L_lr49b:
    s_cmp_eq_u32 s7, 1
    s_cbranch_scc1 L_lj50
    buffer_inv sc1
    s_waitcnt vmcnt(0)
    s_branch L_lj50
L_lr51:
    s_mov_b32 s60, 0
L_lr51a:
    buffer_load_dword v238, v253, s[36:39], s91 offen offset:1024 sc1
    s_add_u32 s60, s60, 1
    s_waitcnt vmcnt(0)
    v_cmp_ne_u32 vcc, s6, v238
    s_cbranch_vccz L_lr51b
    s_cmp_lt_u32 s60, 60000
    s_cbranch_scc1 L_lr51a
L_lr51b:
    s_cmp_eq_u32 s7, 1
    s_cbranch_scc1 L_lj52
    buffer_inv sc1
    s_waitcnt vmcnt(0)
    s_branch L_lj52
L_lr53:
    s_mov_b32 s60, 0
L_lr53a:
    buffer_load_dword v238, v253, s[36:39], s91 offen offset:1088 sc1
    s_add_u32 s60, s60, 1
    s_waitcnt vmcnt(0)
    v_cmp_ne_u32 vcc, s6, v238
    s_cbranch_vccz L_lr53b
    s_cmp_lt_u32 s60, 60000
    s_cbranch_scc1 L_lr53a
L_lr53b:
    s_cmp_eq_u32 s7, 1
    s_cbranch_scc1 L_lj54
    buffer_inv sc1
    s_waitcnt vmcnt(0)
L_sb18:
    s_nop 0
    s_branch L_lj54
L_exit:
    s_endpgm
CODE_END:
.section .rodata,"a"
.p2align 6
.amdhsa_kernel adaLN_cond__sliding_block__dense_activation_squared_relu__prompt_kernel
  .amdhsa_next_free_vgpr 512
  .amdhsa_next_free_sgpr 102
  .amdhsa_accum_offset 256
  .amdhsa_group_segment_fixed_size 0
  .amdhsa_kernarg_size 104
  .amdhsa_user_sgpr_count 2
  .amdhsa_user_sgpr_kernarg_segment_ptr 1
  .amdhsa_system_sgpr_workgroup_id_x 1
  .amdhsa_float_denorm_mode_32 3
.end_amdhsa_kernel
```
